```python
import torch

def _softmax(x, axis=-1):
    return torch.softmax(x, dim=axis)
def _gelu(x):
    return torch.nn.functional.gelu(x, approximate="tanh")
def _silu(x):
    return torch.nn.functional.silu(x)
def _sigmoid(x):
    return torch.sigmoid(x)
def _layernorm(x, axis=-1, eps=1e-5):
    m = x.mean(dim=axis, keepdim=True)
    v = x.var(dim=axis, keepdim=True, unbiased=False)
    return (x - m) / torch.sqrt(v + eps)
def _scatter_add(tgt, idx, src, axis=0):
    return tgt.clone().index_add_(axis, idx, src)
def _segment_sum(src, seg, n):
    out = torch.zeros((n,) + src.shape[1:], dtype=src.dtype)
    return out.index_add_(0, seg, src)
def _pad(x, pw):
    flat = tuple(v for pair in reversed(pw) for v in pair)
    return torch.nn.functional.pad(x, flat)

kernel_name = 'interleave_layers__linear_kernel_hedgehog__dense_activation_silu__prompt'

def setup_inputs():

    _w = (lambda a: (lambda t: t.to(torch.bfloat16) if t.is_floating_point() else t)(torch.as_tensor(a)))
    def _A_setup():
        B, S, D, H = 1, 2048, 512, 32
        Dh = D // H
        return {
            "x": _w((lambda *s: torch.randn(*s, dtype=torch.bfloat16) * 0.05)(B, S, D)),
            "wqkv": _w((lambda *s: torch.randn(*s, dtype=torch.bfloat16) * 0.4)(D, 3 * D)),
            "w_phi": _w((lambda *s: torch.randn(*s, dtype=torch.bfloat16) * 0.4)(H, Dh, Dh) * (Dh ** -0.5)),
            "wo": _w((lambda *s: torch.randn(*s, dtype=torch.bfloat16) * 0.05)(D, D)),
        }
    _A_in = _A_setup()

    def _B_setup():
        B, S, D, F = 1, 2048, 512, 1792
        return {
            "x": _w((lambda *s: torch.randn(*s, dtype=torch.bfloat16) * 0.05)(B, S, D)),
            "w1": _w((lambda *s: torch.randn(*s, dtype=torch.bfloat16) * 1.6)(D, F) * (D ** -0.5)),
            "w2": _w((lambda *s: torch.randn(*s, dtype=torch.bfloat16) * 1.6)(F, D) * (F ** -0.5)),
        }
    _B_in = _B_setup()

    return {
        "A_x": _A_in["x"],
        "A_wqkv": _A_in["wqkv"],
        "A_w_phi": _A_in["w_phi"],
        "A_wo": _A_in["wo"],
        "B_x": _B_in["x"],
        "B_w1": _B_in["w1"],
        "B_w2": _B_in["w2"],
    }

def reference(A_x, A_wqkv, A_w_phi, A_wo, B_x, B_w1, B_w2):
    def _A_ref(x, wqkv, w_phi, wo):
        B, S, D = x.shape
        H = 32; Dh = D // H
        qkv = (lambda x, *d: x.permute(*d))((x @ wqkv).reshape(B, S, 3, H, Dh), 2, 0, 3, 1, 4)
        q, k, v = qkv[0], qkv[1], qkv[2]
        pq = torch.einsum("bhsd,hdf->bhsf", q, w_phi)
        pk = torch.einsum("bhsd,hdf->bhsf", k, w_phi)
        phi_q = torch.concatenate([_softmax(pq, axis=-1), _softmax(-pq, axis=-1)], axis=-1)
        phi_k = torch.concatenate([_softmax(pk, axis=-1), _softmax(-pk, axis=-1)], axis=-1)
        kv = torch.einsum("bhsf,bhsd->bhfd", phi_k, v)
        z  = torch.einsum("bhsf->bhf", phi_k)
        num = torch.einsum("bhqf,bhfd->bhqd", phi_q, kv)
        den = torch.einsum("bhqf,bhf->bhq", phi_q, z)[..., None] + 1e-6
        o = num / den
        return (lambda x, *d: x.permute(*d))(o, 0, 2, 1, 3).reshape(B, S, D) @ wo

    def _B_ref(x, w1, w2):
        h = torch.einsum("bsd,df->bsf", x, w1)
        h = _silu(h)
        out = torch.einsum("bsf,fd->bsd", h, w2)
        return out

    x = A_x
    x = x + _A_ref(_layernorm(x, axis=-1), A_wqkv, A_w_phi, A_wo)
    x = x + _B_ref(_layernorm(x, axis=-1), B_w1, B_w2)
    x = x + _A_ref(_layernorm(x, axis=-1), A_wqkv, A_w_phi, A_wo)
    x = x + _B_ref(_layernorm(x, axis=-1), B_w1, B_w2)
    return x
```

```asm
; @launch grid=(256,1,1) block=(256,1,1) lds=163840
.amdgcn_target "amdgcn-amd-amdhsa--gfx950"
.text
.globl interleave_layers__linear_kernel_hedgehog__dense_activation_silu__prompt_kernel
.p2align 8
.type interleave_layers__linear_kernel_hedgehog__dense_activation_silu__prompt_kernel,@function
interleave_layers__linear_kernel_hedgehog__dense_activation_silu__prompt_kernel:
  s_cmp_ge_u32 s2, 256
  s_cbranch_scc1 L_end
  s_load_dwordx8 s[52:59], s[0:1], 0
  s_load_dwordx8 s[60:67], s[0:1], 32
  s_load_dwordx4 s[68:71], s[0:1], 64
  s_memrealtime s[72:73]
  v_and_b32 v244, 63, v0
  v_lshrrev_b32 v1, 6, v0
  s_nop 0
  v_readfirstlane_b32 s40, v1
  s_and_b32 s74, s2, 7
  s_lshr_b32 s75, s2, 3
  s_and_b32 s42, s75, 15
  s_lshr_b32 s75, s75, 4
  s_lshl_b32 s74, s74, 1
  s_add_u32 s41, s74, s75
  s_lshr_b32 s74, s42, 3
  s_lshl_b32 s95, s75, 1
  s_or_b32 s95, s95, s74
  s_lshl_b32 s92, s95, 1
  s_lshl_b32 s93, s75, 2
  s_and_b32 s74, s42, 1
  s_lshl_b32 s94, s75, 1
  s_or_b32 s94, s94, s74
  s_lshl_b32 s94, s94, 1
  s_mov_b64 s[48:49], 0xffffffff
  s_mov_b32 s50, 0x0000ffff
  s_mov_b32 s51, 0x0000ffff
  v_lshlrev_b32 v255, 4, v244
  v_lshlrev_b32 v248, 3, v244
  v_lshrrev_b32 v1, 5, v244
  v_bfe_u32 v2, v244, 2, 2
  v_and_b32 v3, 3, v244
  v_bfe_u32 v4, v244, 4, 1
  v_lshlrev_b32 v243, 4, v1
  v_lshrrev_b32 v5, 2, v244
  s_movk_i32 s74, 3072
  v_mul_lo_u32 v8, v5, s74
  v_lshl_add_u32 v245, v3, 4, v8
  v_lshl_add_u32 v5, v1, 4, v2
  v_lshlrev_b32 v6, 6, v5
  v_lshl_add_u32 v6, v4, 5, v6
  v_lshl_add_u32 v254, v3, 3, v6
  v_add_u32 v253, 0x10000, v254
  v_and_b32 v7, 1, v3
  v_lshlrev_b32 v7, 5, v7
  v_lshl_add_u32 v7, v4, 4, v7
  v_lshrrev_b32 v8, 1, v3
  v_lshl_add_u32 v7, v8, 3, v7
  v_lshrrev_b32 v8, 1, v2
  v_lshl_add_u32 v7, v8, 6, v7
  v_lshl_add_u32 v252, v5, 7, v7
  v_xor_b32 v251, 64, v252
  v_lshl_add_u32 v5, v1, 2, v2
  v_lshl_add_u32 v250, v5, 7, v7
  v_xor_b32 v249, 64, v250
  v_lshrrev_b32 v5, 3, v244
  v_and_b32 v6, 7, v244
  v_lshlrev_b32 v8, 2, v4
  v_xor_b32 v6, v6, v8
  v_lshlrev_b32 v6, 4, v6
  v_lshl_add_u32 v247, v5, 10, v6
  s_movk_i32 s74, 3584
  v_mul_lo_u32 v8, v5, s74
  v_add_u32 v246, v8, v6
  s_waitcnt lgkmcnt(0)
  s_mov_b32 s4, s52
  s_mov_b32 s5, s53
  s_mov_b32 s6, 2097152
  s_mov_b32 s7, 0x00020000
  s_mov_b32 s8, s54
  s_mov_b32 s9, s55
  s_mov_b32 s10, 1572864
  s_mov_b32 s11, 0x00020000
  s_mov_b32 s12, s56
  s_mov_b32 s13, s57
  s_mov_b32 s14, 16384
  s_mov_b32 s15, 0x00020000
  s_mov_b32 s16, s58
  s_mov_b32 s17, s59
  s_mov_b32 s18, 524288
  s_mov_b32 s19, 0x00020000
  s_mov_b32 s20, s62
  s_mov_b32 s21, s63
  s_mov_b32 s22, 1835008
  s_mov_b32 s23, 0x00020000
  s_mov_b32 s24, s64
  s_mov_b32 s25, s65
  s_mov_b32 s26, 1835008
  s_mov_b32 s27, 0x00020000
  s_mov_b32 s28, s66
  s_mov_b32 s29, s67
  s_mov_b32 s30, 2097152
  s_mov_b32 s31, 0x00020000
  s_mov_b32 s32, s68
  s_mov_b32 s33, s69
  s_mov_b32 s34, 256
  s_mov_b32 s35, 0x00020000
  s_mov_b32 s36, s70
  s_mov_b32 s37, s71
  s_mov_b32 s38, 268435456
  s_mov_b32 s39, 0x00020000
  s_lshl_b64 s[44:45], s[72:73], 8
  s_or_b32 s44, s44, 0x80
  s_or_b32 s74, s2, s40
  s_cmp_eq_u32 s74, 0
  s_cbranch_scc0 L_notag
  v_mov_b32 v2, s44
  v_mov_b32 v3, s45
  v_mov_b32 v1, 0
  buffer_store_dwordx2 v[2:3], v1, s[32:35], 0 offen sc0 sc1
L_notag:
  v_and_b32 v1, 15, v244
  v_lshlrev_b32 v1, 1, v1
  v_lshrrev_b32 v2, 5, v244
  v_lshl_add_u32 v1, v2, 7, v1
  s_lshl_b32 s74, s42, 10
  buffer_load_ushort v160, v1, s[12:15], s74 offen offset:0
  buffer_load_ushort v161, v1, s[12:15], s74 offen offset:32
  buffer_load_ushort v162, v1, s[12:15], s74 offen offset:64
  buffer_load_ushort v163, v1, s[12:15], s74 offen offset:96
  buffer_load_ushort v164, v1, s[12:15], s74 offen offset:256
  buffer_load_ushort v165, v1, s[12:15], s74 offen offset:288
  buffer_load_ushort v166, v1, s[12:15], s74 offen offset:320
  buffer_load_ushort v167, v1, s[12:15], s74 offen offset:352
  buffer_load_ushort v168, v1, s[12:15], s74 offen offset:512
  buffer_load_ushort v169, v1, s[12:15], s74 offen offset:544
  buffer_load_ushort v170, v1, s[12:15], s74 offen offset:576
  buffer_load_ushort v171, v1, s[12:15], s74 offen offset:608
  buffer_load_ushort v172, v1, s[12:15], s74 offen offset:768
  buffer_load_ushort v173, v1, s[12:15], s74 offen offset:800
  buffer_load_ushort v174, v1, s[12:15], s74 offen offset:832
  buffer_load_ushort v175, v1, s[12:15], s74 offen offset:864
  s_lshl_b32 s74, s42, 6
  s_mul_i32 s75, s40, 49152
  s_add_u32 s74, s74, s75
  s_lshl_b32 s75, s40, 10
  s_add_u32 s77, s94, 0
  s_and_b32 s77, s77, 7
  s_lshl_b32 s76, s77, 12
  s_add_u32 s76, s76, s75
  s_add_u32 m0, s76, 0
  s_mul_i32 s76, s77, 196608
  s_add_u32 s76, s76, s74
  s_add_u32 s76, s76, 1024
  buffer_load_dwordx4 v245, s[8:11], s76 offen lds
  s_add_u32 s77, s94, 1
  s_and_b32 s77, s77, 7
  s_lshl_b32 s76, s77, 12
  s_add_u32 s76, s76, s75
  s_add_u32 m0, s76, 0
  s_mul_i32 s76, s77, 196608
  s_add_u32 s76, s76, s74
  s_add_u32 s76, s76, 1024
  buffer_load_dwordx4 v245, s[8:11], s76 offen lds
  s_add_u32 s77, s94, 2
  s_and_b32 s77, s77, 7
  s_lshl_b32 s76, s77, 12
  s_add_u32 s76, s76, s75
  s_add_u32 m0, s76, 0
  s_mul_i32 s76, s77, 196608
  s_add_u32 s76, s76, s74
  s_add_u32 s76, s76, 1024
  buffer_load_dwordx4 v245, s[8:11], s76 offen lds
  s_add_u32 s77, s94, 3
  s_and_b32 s77, s77, 7
  s_lshl_b32 s76, s77, 12
  s_add_u32 s76, s76, s75
  s_add_u32 m0, s76, 0
  s_mul_i32 s76, s77, 196608
  s_add_u32 s76, s76, s74
  s_add_u32 s76, s76, 1024
  buffer_load_dwordx4 v245, s[8:11], s76 offen lds
  s_add_u32 s77, s94, 4
  s_and_b32 s77, s77, 7
  s_lshl_b32 s76, s77, 12
  s_add_u32 s76, s76, s75
  s_add_u32 m0, s76, 0
  s_mul_i32 s76, s77, 196608
  s_add_u32 s76, s76, s74
  s_add_u32 s76, s76, 1024
  buffer_load_dwordx4 v245, s[8:11], s76 offen lds
  s_add_u32 s77, s94, 5
  s_and_b32 s77, s77, 7
  s_lshl_b32 s76, s77, 12
  s_add_u32 s76, s76, s75
  s_add_u32 m0, s76, 0
  s_mul_i32 s76, s77, 196608
  s_add_u32 s76, s76, s74
  s_add_u32 s76, s76, 1024
  buffer_load_dwordx4 v245, s[8:11], s76 offen lds
  s_add_u32 s77, s94, 6
  s_and_b32 s77, s77, 7
  s_lshl_b32 s76, s77, 12
  s_add_u32 s76, s76, s75
  s_add_u32 m0, s76, 0
  s_mul_i32 s76, s77, 196608
  s_add_u32 s76, s76, s74
  s_add_u32 s76, s76, 1024
  buffer_load_dwordx4 v245, s[8:11], s76 offen lds
  s_add_u32 s77, s94, 7
  s_and_b32 s77, s77, 7
  s_lshl_b32 s76, s77, 12
  s_add_u32 s76, s76, s75
  s_add_u32 m0, s76, 0
  s_mul_i32 s76, s77, 196608
  s_add_u32 s76, s76, s74
  s_add_u32 s76, s76, 1024
  buffer_load_dwordx4 v245, s[8:11], s76 offen lds
  s_add_u32 s77, s94, 0
  s_and_b32 s77, s77, 7
  s_lshl_b32 s76, s77, 12
  s_add_u32 s76, s76, s75
  s_add_u32 m0, s76, 32768
  s_mul_i32 s76, s77, 196608
  s_add_u32 s76, s76, s74
  s_add_u32 s76, s76, 2048
  buffer_load_dwordx4 v245, s[8:11], s76 offen lds
  s_add_u32 s77, s94, 1
  s_and_b32 s77, s77, 7
  s_lshl_b32 s76, s77, 12
  s_add_u32 s76, s76, s75
  s_add_u32 m0, s76, 32768
  s_mul_i32 s76, s77, 196608
  s_add_u32 s76, s76, s74
  s_add_u32 s76, s76, 2048
  buffer_load_dwordx4 v245, s[8:11], s76 offen lds
  s_add_u32 s77, s94, 2
  s_and_b32 s77, s77, 7
  s_lshl_b32 s76, s77, 12
  s_add_u32 s76, s76, s75
  s_add_u32 m0, s76, 32768
  s_mul_i32 s76, s77, 196608
  s_add_u32 s76, s76, s74
  s_add_u32 s76, s76, 2048
  buffer_load_dwordx4 v245, s[8:11], s76 offen lds
  s_add_u32 s77, s94, 3
  s_and_b32 s77, s77, 7
  s_lshl_b32 s76, s77, 12
  s_add_u32 s76, s76, s75
  s_add_u32 m0, s76, 32768
  s_mul_i32 s76, s77, 196608
  s_add_u32 s76, s76, s74
  s_add_u32 s76, s76, 2048
  buffer_load_dwordx4 v245, s[8:11], s76 offen lds
  s_add_u32 s77, s94, 4
  s_and_b32 s77, s77, 7
  s_lshl_b32 s76, s77, 12
  s_add_u32 s76, s76, s75
  s_add_u32 m0, s76, 32768
  s_mul_i32 s76, s77, 196608
  s_add_u32 s76, s76, s74
  s_add_u32 s76, s76, 2048
  buffer_load_dwordx4 v245, s[8:11], s76 offen lds
  s_add_u32 s77, s94, 5
  s_and_b32 s77, s77, 7
  s_lshl_b32 s76, s77, 12
  s_add_u32 s76, s76, s75
  s_add_u32 m0, s76, 32768
  s_mul_i32 s76, s77, 196608
  s_add_u32 s76, s76, s74
  s_add_u32 s76, s76, 2048
  buffer_load_dwordx4 v245, s[8:11], s76 offen lds
  s_add_u32 s77, s94, 6
  s_and_b32 s77, s77, 7
  s_lshl_b32 s76, s77, 12
  s_add_u32 s76, s76, s75
  s_add_u32 m0, s76, 32768
  s_mul_i32 s76, s77, 196608
  s_add_u32 s76, s76, s74
  s_add_u32 s76, s76, 2048
  buffer_load_dwordx4 v245, s[8:11], s76 offen lds
  s_add_u32 s77, s94, 7
  s_and_b32 s77, s77, 7
  s_lshl_b32 s76, s77, 12
  s_add_u32 s76, s76, s75
  s_add_u32 m0, s76, 32768
  s_mul_i32 s76, s77, 196608
  s_add_u32 s76, s76, s74
  s_add_u32 s76, s76, 2048
  buffer_load_dwordx4 v245, s[8:11], s76 offen lds
  s_add_u32 s77, s94, 0
  s_and_b32 s77, s77, 7
  s_lshl_b32 s76, s77, 12
  s_add_u32 s76, s76, s75
  s_add_u32 m0, s76, 65536
  s_mul_i32 s76, s77, 196608
  s_add_u32 s76, s76, s74
  s_add_u32 s76, s76, 0
  buffer_load_dwordx4 v245, s[8:11], s76 offen lds
  s_add_u32 s77, s94, 1
  s_and_b32 s77, s77, 7
  s_lshl_b32 s76, s77, 12
  s_add_u32 s76, s76, s75
  s_add_u32 m0, s76, 65536
  s_mul_i32 s76, s77, 196608
  s_add_u32 s76, s76, s74
  s_add_u32 s76, s76, 0
  buffer_load_dwordx4 v245, s[8:11], s76 offen lds
  s_add_u32 s77, s94, 2
  s_and_b32 s77, s77, 7
  s_lshl_b32 s76, s77, 12
  s_add_u32 s76, s76, s75
  s_add_u32 m0, s76, 65536
  s_mul_i32 s76, s77, 196608
  s_add_u32 s76, s76, s74
  s_add_u32 s76, s76, 0
  buffer_load_dwordx4 v245, s[8:11], s76 offen lds
  s_add_u32 s77, s94, 3
  s_and_b32 s77, s77, 7
  s_lshl_b32 s76, s77, 12
  s_add_u32 s76, s76, s75
  s_add_u32 m0, s76, 65536
  s_mul_i32 s76, s77, 196608
  s_add_u32 s76, s76, s74
  s_add_u32 s76, s76, 0
  buffer_load_dwordx4 v245, s[8:11], s76 offen lds
  s_add_u32 s77, s94, 4
  s_and_b32 s77, s77, 7
  s_lshl_b32 s76, s77, 12
  s_add_u32 s76, s76, s75
  s_add_u32 m0, s76, 65536
  s_mul_i32 s76, s77, 196608
  s_add_u32 s76, s76, s74
  s_add_u32 s76, s76, 0
  buffer_load_dwordx4 v245, s[8:11], s76 offen lds
  s_add_u32 s77, s94, 5
  s_and_b32 s77, s77, 7
  s_lshl_b32 s76, s77, 12
  s_add_u32 s76, s76, s75
  s_add_u32 m0, s76, 65536
  s_mul_i32 s76, s77, 196608
  s_add_u32 s76, s76, s74
  s_add_u32 s76, s76, 0
  buffer_load_dwordx4 v245, s[8:11], s76 offen lds
  s_add_u32 s77, s94, 6
  s_and_b32 s77, s77, 7
  s_lshl_b32 s76, s77, 12
  s_add_u32 s76, s76, s75
  s_add_u32 m0, s76, 65536
  s_mul_i32 s76, s77, 196608
  s_add_u32 s76, s76, s74
  s_add_u32 s76, s76, 0
  buffer_load_dwordx4 v245, s[8:11], s76 offen lds
  s_add_u32 s77, s94, 7
  s_and_b32 s77, s77, 7
  s_lshl_b32 s76, s77, 12
  s_add_u32 s76, s76, s75
  s_add_u32 m0, s76, 65536
  s_mul_i32 s76, s77, 196608
  s_add_u32 s76, s76, s74
  s_add_u32 s76, s76, 0
  buffer_load_dwordx4 v245, s[8:11], s76 offen lds
  v_lshrrev_b32 v1, 5, v244
  v_and_b32 v2, 31, v244
  v_xor_b32 v2, v2, v1
  v_lshlrev_b32 v2, 4, v2
  v_lshl_add_u32 v208, v1, 10, v2
  s_lshl_b32 s78, s41, 17
  s_lshl_b32 s79, s40, 15
  s_add_u32 s78, s78, s79
  s_lshl_b32 s79, s40, 14
  s_add_u32 s79, s79, 98304
  s_add_u32 s77, s42, 0
  s_and_b32 s77, s77, 15
  s_lshl_b32 s76, s77, 5
  s_and_b32 s76, s76, 0xf0
  v_xor_b32 v209, s76, v208
  s_lshl_b32 s76, s77, 10
  s_add_u32 m0, s76, s79
  s_lshl_b32 s76, s77, 11
  s_add_u32 s76, s76, s78
  buffer_load_dwordx4 v209, s[4:7], s76 offen lds
  s_add_u32 s77, s42, 1
  s_and_b32 s77, s77, 15
  s_lshl_b32 s76, s77, 5
  s_and_b32 s76, s76, 0xf0
  v_xor_b32 v210, s76, v208
  s_lshl_b32 s76, s77, 10
  s_add_u32 m0, s76, s79
  s_lshl_b32 s76, s77, 11
  s_add_u32 s76, s76, s78
  buffer_load_dwordx4 v210, s[4:7], s76 offen lds
  s_add_u32 s77, s42, 2
  s_and_b32 s77, s77, 15
  s_lshl_b32 s76, s77, 5
  s_and_b32 s76, s76, 0xf0
  v_xor_b32 v209, s76, v208
  s_lshl_b32 s76, s77, 10
  s_add_u32 m0, s76, s79
  s_lshl_b32 s76, s77, 11
  s_add_u32 s76, s76, s78
  buffer_load_dwordx4 v209, s[4:7], s76 offen lds
  s_add_u32 s77, s42, 3
  s_and_b32 s77, s77, 15
  s_lshl_b32 s76, s77, 5
  s_and_b32 s76, s76, 0xf0
  v_xor_b32 v210, s76, v208
  s_lshl_b32 s76, s77, 10
  s_add_u32 m0, s76, s79
  s_lshl_b32 s76, s77, 11
  s_add_u32 s76, s76, s78
  buffer_load_dwordx4 v210, s[4:7], s76 offen lds
  s_add_u32 s77, s42, 4
  s_and_b32 s77, s77, 15
  s_lshl_b32 s76, s77, 5
  s_and_b32 s76, s76, 0xf0
  v_xor_b32 v209, s76, v208
  s_lshl_b32 s76, s77, 10
  s_add_u32 m0, s76, s79
  s_lshl_b32 s76, s77, 11
  s_add_u32 s76, s76, s78
  buffer_load_dwordx4 v209, s[4:7], s76 offen lds
  s_add_u32 s77, s42, 5
  s_and_b32 s77, s77, 15
  s_lshl_b32 s76, s77, 5
  s_and_b32 s76, s76, 0xf0
  v_xor_b32 v210, s76, v208
  s_lshl_b32 s76, s77, 10
  s_add_u32 m0, s76, s79
  s_lshl_b32 s76, s77, 11
  s_add_u32 s76, s76, s78
  buffer_load_dwordx4 v210, s[4:7], s76 offen lds
  s_add_u32 s77, s42, 6
  s_and_b32 s77, s77, 15
  s_lshl_b32 s76, s77, 5
  s_and_b32 s76, s76, 0xf0
  v_xor_b32 v209, s76, v208
  s_lshl_b32 s76, s77, 10
  s_add_u32 m0, s76, s79
  s_lshl_b32 s76, s77, 11
  s_add_u32 s76, s76, s78
  buffer_load_dwordx4 v209, s[4:7], s76 offen lds
  s_add_u32 s77, s42, 7
  s_and_b32 s77, s77, 15
  s_lshl_b32 s76, s77, 5
  s_and_b32 s76, s76, 0xf0
  v_xor_b32 v210, s76, v208
  s_lshl_b32 s76, s77, 10
  s_add_u32 m0, s76, s79
  s_lshl_b32 s76, s77, 11
  s_add_u32 s76, s76, s78
  buffer_load_dwordx4 v210, s[4:7], s76 offen lds
  s_add_u32 s77, s42, 8
  s_and_b32 s77, s77, 15
  s_lshl_b32 s76, s77, 5
  s_and_b32 s76, s76, 0xf0
  v_xor_b32 v209, s76, v208
  s_lshl_b32 s76, s77, 10
  s_add_u32 m0, s76, s79
  s_lshl_b32 s76, s77, 11
  s_add_u32 s76, s76, s78
  buffer_load_dwordx4 v209, s[4:7], s76 offen lds
  s_add_u32 s77, s42, 9
  s_and_b32 s77, s77, 15
  s_lshl_b32 s76, s77, 5
  s_and_b32 s76, s76, 0xf0
  v_xor_b32 v210, s76, v208
  s_lshl_b32 s76, s77, 10
  s_add_u32 m0, s76, s79
  s_lshl_b32 s76, s77, 11
  s_add_u32 s76, s76, s78
  buffer_load_dwordx4 v210, s[4:7], s76 offen lds
  s_add_u32 s77, s42, 10
  s_and_b32 s77, s77, 15
  s_lshl_b32 s76, s77, 5
  s_and_b32 s76, s76, 0xf0
  v_xor_b32 v209, s76, v208
  s_lshl_b32 s76, s77, 10
  s_add_u32 m0, s76, s79
  s_lshl_b32 s76, s77, 11
  s_add_u32 s76, s76, s78
  buffer_load_dwordx4 v209, s[4:7], s76 offen lds
  s_add_u32 s77, s42, 11
  s_and_b32 s77, s77, 15
  s_lshl_b32 s76, s77, 5
  s_and_b32 s76, s76, 0xf0
  v_xor_b32 v210, s76, v208
  s_lshl_b32 s76, s77, 10
  s_add_u32 m0, s76, s79
  s_lshl_b32 s76, s77, 11
  s_add_u32 s76, s76, s78
  buffer_load_dwordx4 v210, s[4:7], s76 offen lds
  s_add_u32 s77, s42, 12
  s_and_b32 s77, s77, 15
  s_lshl_b32 s76, s77, 5
  s_and_b32 s76, s76, 0xf0
  v_xor_b32 v209, s76, v208
  s_lshl_b32 s76, s77, 10
  s_add_u32 m0, s76, s79
  s_lshl_b32 s76, s77, 11
  s_add_u32 s76, s76, s78
  buffer_load_dwordx4 v209, s[4:7], s76 offen lds
  s_add_u32 s77, s42, 13
  s_and_b32 s77, s77, 15
  s_lshl_b32 s76, s77, 5
  s_and_b32 s76, s76, 0xf0
  v_xor_b32 v210, s76, v208
  s_lshl_b32 s76, s77, 10
  s_add_u32 m0, s76, s79
  s_lshl_b32 s76, s77, 11
  s_add_u32 s76, s76, s78
  buffer_load_dwordx4 v210, s[4:7], s76 offen lds
  s_add_u32 s77, s42, 14
  s_and_b32 s77, s77, 15
  s_lshl_b32 s76, s77, 5
  s_and_b32 s76, s76, 0xf0
  v_xor_b32 v209, s76, v208
  s_lshl_b32 s76, s77, 10
  s_add_u32 m0, s76, s79
  s_lshl_b32 s76, s77, 11
  s_add_u32 s76, s76, s78
  buffer_load_dwordx4 v209, s[4:7], s76 offen lds
  s_add_u32 s77, s42, 15
  s_and_b32 s77, s77, 15
  s_lshl_b32 s76, s77, 5
  s_and_b32 s76, s76, 0xf0
  v_xor_b32 v210, s76, v208
  s_lshl_b32 s76, s77, 10
  s_add_u32 m0, s76, s79
  s_lshl_b32 s76, s77, 11
  s_add_u32 s76, s76, s78
  buffer_load_dwordx4 v210, s[4:7], s76 offen lds
  v_lshrrev_b32 v1, 1, v244
  v_and_b32 v2, 1, v244
  v_lshlrev_b32 v1, 10, v1
  v_lshl_add_u32 v1, v2, 8, v1
  buffer_load_dword v214, v1, s[4:7], s78 offen offset:512
  buffer_load_dword v214, v1, s[4:7], s78 offen offset:640
  v_and_b32 v216, 3, v244
  v_bfe_u32 v217, v244, 3, 1
  v_lshl_add_u32 v216, v217, 2, v216
  v_bfe_u32 v217, v244, 2, 1
  v_lshrrev_b32 v218, 5, v244
  v_xor_b32 v217, v217, v218
  v_lshl_add_u32 v216, v217, 3, v216
  v_bfe_u32 v217, v244, 4, 1
  v_lshl_add_u32 v219, v217, 3, v216
  v_and_b32 v220, 1, v219
  v_lshlrev_b32 v220, 4, v220
  s_movk_i32 s74, 0x3f80
  v_lshlrev_b32 v220, v220, s74
  v_lshrrev_b32 v221, 1, v219
  v_cmp_eq_u32 vcc, 0, v221
  s_nop 1
  v_cndmask_b32 v222, 0, v220, vcc
  v_accvgpr_write_b32 a232, v222
  v_cmp_eq_u32 vcc, 1, v221
  s_nop 1
  v_cndmask_b32 v222, 0, v220, vcc
  v_accvgpr_write_b32 a233, v222
  v_cmp_eq_u32 vcc, 2, v221
  s_nop 1
  v_cndmask_b32 v222, 0, v220, vcc
  v_accvgpr_write_b32 a234, v222
  v_cmp_eq_u32 vcc, 3, v221
  s_nop 1
  v_cndmask_b32 v222, 0, v220, vcc
  v_accvgpr_write_b32 a235, v222
  v_xor_b32 v217, 1, v217
  v_lshl_add_u32 v219, v217, 3, v216
  v_and_b32 v220, 1, v219
  v_lshlrev_b32 v220, 4, v220
  s_movk_i32 s74, 0x3f80
  v_lshlrev_b32 v220, v220, s74
  v_lshrrev_b32 v221, 1, v219
  v_cmp_eq_u32 vcc, 0, v221
  s_nop 1
  v_cndmask_b32 v222, 0, v220, vcc
  v_accvgpr_write_b32 a236, v222
  v_cmp_eq_u32 vcc, 1, v221
  s_nop 1
  v_cndmask_b32 v222, 0, v220, vcc
  v_accvgpr_write_b32 a237, v222
  v_cmp_eq_u32 vcc, 2, v221
  s_nop 1
  v_cndmask_b32 v222, 0, v220, vcc
  v_accvgpr_write_b32 a238, v222
  v_cmp_eq_u32 vcc, 3, v221
  s_nop 1
  v_cndmask_b32 v222, 0, v220, vcc
  v_accvgpr_write_b32 a239, v222
  s_waitcnt vmcnt(42)
  v_bfe_u32 v216, v244, 4, 1
  v_cmp_eq_u32 vcc, 0, v216
  v_lshl_or_b32 v217, v161, 16, v160
  s_nop 0
  v_cndmask_b32 v217, 0, v217, vcc
  v_accvgpr_write_b32 a224, v217
  v_lshl_or_b32 v217, v163, 16, v162
  v_cndmask_b32 v217, 0, v217, vcc
  v_accvgpr_write_b32 a225, v217
  v_lshl_or_b32 v217, v165, 16, v164
  v_cndmask_b32 v217, 0, v217, vcc
  v_accvgpr_write_b32 a226, v217
  v_lshl_or_b32 v217, v167, 16, v166
  v_cndmask_b32 v217, 0, v217, vcc
  v_accvgpr_write_b32 a227, v217
  v_cmp_eq_u32 vcc, 1, v216
  v_lshl_or_b32 v217, v169, 16, v168
  s_nop 0
  v_cndmask_b32 v217, 0, v217, vcc
  v_accvgpr_write_b32 a228, v217
  v_lshl_or_b32 v217, v171, 16, v170
  v_cndmask_b32 v217, 0, v217, vcc
  v_accvgpr_write_b32 a229, v217
  v_lshl_or_b32 v217, v173, 16, v172
  v_cndmask_b32 v217, 0, v217, vcc
  v_accvgpr_write_b32 a230, v217
  v_lshl_or_b32 v217, v175, 16, v174
  v_cndmask_b32 v217, 0, v217, vcc
  v_accvgpr_write_b32 a231, v217
  s_waitcnt vmcnt(18)
  s_barrier
  v_mov_b32 v216, 0x3f803f80
  v_mov_b32 v217, 0x3f803f80
  v_mov_b32 v218, 0x3f803f80
  v_mov_b32 v219, 0x3f803f80
  s_cmp_ge_u32 s40, 3
  s_cbranch_scc1 L_cs_skip
  s_lshl_b32 s74, s40, 15
  v_add_u32 v220, s74, v254
  ds_read_b64_tr_b16 v[176:177], v220 offset:0
  ds_read_b64_tr_b16 v[178:179], v220 offset:256
  ds_read_b64_tr_b16 v[180:181], v220 offset:512
  ds_read_b64_tr_b16 v[182:183], v220 offset:768
  ds_read_b64_tr_b16 v[184:185], v220 offset:2048
  ds_read_b64_tr_b16 v[186:187], v220 offset:2304
  s_waitcnt lgkmcnt(4)
  v_mfma_f32_32x32x16_bf16 v[128:143], v[216:219], v[176:179], 0
  ds_read_b64_tr_b16 v[188:189], v220 offset:2560
  ds_read_b64_tr_b16 v[190:191], v220 offset:2816
  s_waitcnt lgkmcnt(4)
  v_mfma_f32_32x32x16_bf16 v[128:143], v[216:219], v[180:183], v[128:143]
  ds_read_b64_tr_b16 v[176:177], v220 offset:4096
  ds_read_b64_tr_b16 v[178:179], v220 offset:4352
  s_waitcnt lgkmcnt(4)
  v_mfma_f32_32x32x16_bf16 v[128:143], v[216:219], v[184:187], v[128:143]
  ds_read_b64_tr_b16 v[180:181], v220 offset:4608
  ds_read_b64_tr_b16 v[182:183], v220 offset:4864
  s_waitcnt lgkmcnt(4)
  v_mfma_f32_32x32x16_bf16 v[128:143], v[216:219], v[188:191], v[128:143]
  ds_read_b64_tr_b16 v[184:185], v220 offset:6144
  ds_read_b64_tr_b16 v[186:187], v220 offset:6400
  s_waitcnt lgkmcnt(4)
  v_mfma_f32_32x32x16_bf16 v[128:143], v[216:219], v[176:179], v[128:143]
  ds_read_b64_tr_b16 v[188:189], v220 offset:6656
  ds_read_b64_tr_b16 v[190:191], v220 offset:6912
  s_waitcnt lgkmcnt(4)
  v_mfma_f32_32x32x16_bf16 v[128:143], v[216:219], v[180:183], v[128:143]
  ds_read_b64_tr_b16 v[176:177], v220 offset:8192
  ds_read_b64_tr_b16 v[178:179], v220 offset:8448
  s_waitcnt lgkmcnt(4)
  v_mfma_f32_32x32x16_bf16 v[128:143], v[216:219], v[184:187], v[128:143]
  ds_read_b64_tr_b16 v[180:181], v220 offset:8704
  ds_read_b64_tr_b16 v[182:183], v220 offset:8960
  s_waitcnt lgkmcnt(4)
  v_mfma_f32_32x32x16_bf16 v[128:143], v[216:219], v[188:191], v[128:143]
  ds_read_b64_tr_b16 v[184:185], v220 offset:10240
  ds_read_b64_tr_b16 v[186:187], v220 offset:10496
  s_waitcnt lgkmcnt(4)
  v_mfma_f32_32x32x16_bf16 v[128:143], v[216:219], v[176:179], v[128:143]
  ds_read_b64_tr_b16 v[188:189], v220 offset:10752
  ds_read_b64_tr_b16 v[190:191], v220 offset:11008
  s_waitcnt lgkmcnt(4)
  v_mfma_f32_32x32x16_bf16 v[128:143], v[216:219], v[180:183], v[128:143]
  ds_read_b64_tr_b16 v[176:177], v220 offset:12288
  ds_read_b64_tr_b16 v[178:179], v220 offset:12544
  s_waitcnt lgkmcnt(4)
  v_mfma_f32_32x32x16_bf16 v[128:143], v[216:219], v[184:187], v[128:143]
  ds_read_b64_tr_b16 v[180:181], v220 offset:12800
  ds_read_b64_tr_b16 v[182:183], v220 offset:13056
  s_waitcnt lgkmcnt(4)
  v_mfma_f32_32x32x16_bf16 v[128:143], v[216:219], v[188:191], v[128:143]
  ds_read_b64_tr_b16 v[184:185], v220 offset:14336
  ds_read_b64_tr_b16 v[186:187], v220 offset:14592
  s_waitcnt lgkmcnt(4)
  v_mfma_f32_32x32x16_bf16 v[128:143], v[216:219], v[176:179], v[128:143]
  ds_read_b64_tr_b16 v[188:189], v220 offset:14848
  ds_read_b64_tr_b16 v[190:191], v220 offset:15104
  s_waitcnt lgkmcnt(4)
  v_mfma_f32_32x32x16_bf16 v[128:143], v[216:219], v[180:183], v[128:143]
  ds_read_b64_tr_b16 v[176:177], v220 offset:16384
  ds_read_b64_tr_b16 v[178:179], v220 offset:16640
  s_waitcnt lgkmcnt(4)
  v_mfma_f32_32x32x16_bf16 v[128:143], v[216:219], v[184:187], v[128:143]
  ds_read_b64_tr_b16 v[180:181], v220 offset:16896
  ds_read_b64_tr_b16 v[182:183], v220 offset:17152
  s_waitcnt lgkmcnt(4)
  v_mfma_f32_32x32x16_bf16 v[128:143], v[216:219], v[188:191], v[128:143]
  ds_read_b64_tr_b16 v[184:185], v220 offset:18432
  ds_read_b64_tr_b16 v[186:187], v220 offset:18688
  s_waitcnt lgkmcnt(4)
  v_mfma_f32_32x32x16_bf16 v[128:143], v[216:219], v[176:179], v[128:143]
  ds_read_b64_tr_b16 v[188:189], v220 offset:18944
  ds_read_b64_tr_b16 v[190:191], v220 offset:19200
  s_waitcnt lgkmcnt(4)
  v_mfma_f32_32x32x16_bf16 v[128:143], v[216:219], v[180:183], v[128:143]
  ds_read_b64_tr_b16 v[176:177], v220 offset:20480
  ds_read_b64_tr_b16 v[178:179], v220 offset:20736
  s_waitcnt lgkmcnt(4)
  v_mfma_f32_32x32x16_bf16 v[128:143], v[216:219], v[184:187], v[128:143]
  ds_read_b64_tr_b16 v[180:181], v220 offset:20992
  ds_read_b64_tr_b16 v[182:183], v220 offset:21248
  s_waitcnt lgkmcnt(4)
  v_mfma_f32_32x32x16_bf16 v[128:143], v[216:219], v[188:191], v[128:143]
  ds_read_b64_tr_b16 v[184:185], v220 offset:22528
  ds_read_b64_tr_b16 v[186:187], v220 offset:22784
  s_waitcnt lgkmcnt(4)
  v_mfma_f32_32x32x16_bf16 v[128:143], v[216:219], v[176:179], v[128:143]
  ds_read_b64_tr_b16 v[188:189], v220 offset:23040
  ds_read_b64_tr_b16 v[190:191], v220 offset:23296
  s_waitcnt lgkmcnt(4)
  v_mfma_f32_32x32x16_bf16 v[128:143], v[216:219], v[180:183], v[128:143]
  ds_read_b64_tr_b16 v[176:177], v220 offset:24576
  ds_read_b64_tr_b16 v[178:179], v220 offset:24832
  s_waitcnt lgkmcnt(4)
  v_mfma_f32_32x32x16_bf16 v[128:143], v[216:219], v[184:187], v[128:143]
  ds_read_b64_tr_b16 v[180:181], v220 offset:25088
  ds_read_b64_tr_b16 v[182:183], v220 offset:25344
  s_waitcnt lgkmcnt(4)
  v_mfma_f32_32x32x16_bf16 v[128:143], v[216:219], v[188:191], v[128:143]
  ds_read_b64_tr_b16 v[184:185], v220 offset:26624
  ds_read_b64_tr_b16 v[186:187], v220 offset:26880
  s_waitcnt lgkmcnt(4)
  v_mfma_f32_32x32x16_bf16 v[128:143], v[216:219], v[176:179], v[128:143]
  ds_read_b64_tr_b16 v[188:189], v220 offset:27136
  ds_read_b64_tr_b16 v[190:191], v220 offset:27392
  s_waitcnt lgkmcnt(4)
  v_mfma_f32_32x32x16_bf16 v[128:143], v[216:219], v[180:183], v[128:143]
  ds_read_b64_tr_b16 v[176:177], v220 offset:28672
  ds_read_b64_tr_b16 v[178:179], v220 offset:28928
  s_waitcnt lgkmcnt(4)
  v_mfma_f32_32x32x16_bf16 v[128:143], v[216:219], v[184:187], v[128:143]
  ds_read_b64_tr_b16 v[180:181], v220 offset:29184
  ds_read_b64_tr_b16 v[182:183], v220 offset:29440
  s_waitcnt lgkmcnt(4)
  v_mfma_f32_32x32x16_bf16 v[128:143], v[216:219], v[188:191], v[128:143]
  ds_read_b64_tr_b16 v[184:185], v220 offset:30720
  ds_read_b64_tr_b16 v[186:187], v220 offset:30976
  s_waitcnt lgkmcnt(4)
  v_mfma_f32_32x32x16_bf16 v[128:143], v[216:219], v[176:179], v[128:143]
  ds_read_b64_tr_b16 v[188:189], v220 offset:31232
  ds_read_b64_tr_b16 v[190:191], v220 offset:31488
  s_waitcnt lgkmcnt(4)
  v_mfma_f32_32x32x16_bf16 v[128:143], v[216:219], v[180:183], v[128:143]
  s_waitcnt lgkmcnt(2)
  v_mfma_f32_32x32x16_bf16 v[128:143], v[216:219], v[184:187], v[128:143]
  s_waitcnt lgkmcnt(0)
  v_mfma_f32_32x32x16_bf16 v[128:143], v[216:219], v[188:191], v[128:143]
  s_nop 11
  v_cvt_pk_bf16_f32 v220, v128, v128
  v_and_b32 v220, 0xffff0000, v220
  v_sub_f32 v221, v128, v220
  v_cvt_pk_bf16_f32 v222, v220, v221
  v_cvt_pk_bf16_f32 v223, v220, 0
L_cs_skip:
  s_waitcnt lgkmcnt(0)
  v_and_b32 v1, 31, v244
  v_lshrrev_b32 v2, 5, v244
  v_lshlrev_b32 v2, 1, v2
  v_and_b32 v3, 15, v1
  v_xor_b32 v2, v2, v3
  v_lshlrev_b32 v2, 4, v2
  v_lshl_add_u32 v211, v1, 9, v2
  v_add_u32 v211, s79, v211
  s_waitcnt vmcnt(2)
  v_xor_b32 v212, 0, v211
  ds_read_b128 v[0:3], v212 offset:0
  v_xor_b32 v213, 16, v211
  ds_read_b128 v[4:7], v213 offset:0
  v_xor_b32 v212, 64, v211
  ds_read_b128 v[8:11], v212 offset:0
  v_xor_b32 v213, 80, v211
  ds_read_b128 v[12:15], v213 offset:0
  v_xor_b32 v212, 128, v211
  ds_read_b128 v[16:19], v212 offset:0
  v_xor_b32 v213, 144, v211
  ds_read_b128 v[20:23], v213 offset:0
  v_xor_b32 v212, 192, v211
  ds_read_b128 v[24:27], v212 offset:0
  v_xor_b32 v213, 208, v211
  ds_read_b128 v[28:31], v213 offset:0
  v_xor_b32 v212, 0, v211
  ds_read_b128 v[32:35], v212 offset:256
  v_xor_b32 v213, 16, v211
  ds_read_b128 v[36:39], v213 offset:256
  v_xor_b32 v212, 64, v211
  ds_read_b128 v[40:43], v212 offset:256
  v_xor_b32 v213, 80, v211
  ds_read_b128 v[44:47], v213 offset:256
  v_xor_b32 v212, 128, v211
  ds_read_b128 v[48:51], v212 offset:256
  v_xor_b32 v213, 144, v211
  ds_read_b128 v[52:55], v213 offset:256
  v_xor_b32 v212, 192, v211
  ds_read_b128 v[56:59], v212 offset:256
  v_xor_b32 v213, 208, v211
  ds_read_b128 v[60:63], v213 offset:256
  s_waitcnt lgkmcnt(0)
  v_add_u32 v220, s79, v248
  ds_write_b64 v220, v[222:223]
  s_waitcnt lgkmcnt(0)
  s_barrier
  v_add_u32 v220, 98304, v248
  ds_read_b64 a[240:241], v220 offset:0
  ds_read_b64 a[242:243], v220 offset:16384
  ds_read_b64 a[244:245], v220 offset:32768
  v_mov_b32 v220, 0
  v_accvgpr_write_b32 a246, v220
  v_accvgpr_write_b32 a247, v220
  v_accvgpr_write_b32 a248, v220
  v_accvgpr_write_b32 a249, v220
  v_accvgpr_write_b32 a250, v220
  v_accvgpr_write_b32 a251, v220
  v_accvgpr_write_b32 a252, v220
  v_accvgpr_write_b32 a253, v220
  v_accvgpr_write_b32 a254, v220
  v_accvgpr_write_b32 a255, v220
  s_waitcnt lgkmcnt(0)
  s_barrier
  s_add_u32 s77, s42, 0
  s_and_b32 s77, s77, 15
  s_lshl_b32 s76, s77, 5
  s_and_b32 s76, s76, 0xf0
  v_xor_b32 v209, s76, v208
  s_lshl_b32 s76, s77, 10
  s_add_u32 m0, s76, s79
  s_lshl_b32 s76, s77, 11
  s_add_u32 s76, s76, s78
  s_add_u32 s76, s76, 512
  buffer_load_dwordx4 v209, s[4:7], s76 offen lds
  s_add_u32 s77, s42, 1
  s_and_b32 s77, s77, 15
  s_lshl_b32 s76, s77, 5
  s_and_b32 s76, s76, 0xf0
  v_xor_b32 v210, s76, v208
  s_lshl_b32 s76, s77, 10
  s_add_u32 m0, s76, s79
  s_lshl_b32 s76, s77, 11
  s_add_u32 s76, s76, s78
  s_add_u32 s76, s76, 512
  buffer_load_dwordx4 v210, s[4:7], s76 offen lds
  s_add_u32 s77, s42, 2
  s_and_b32 s77, s77, 15
  s_lshl_b32 s76, s77, 5
  s_and_b32 s76, s76, 0xf0
  v_xor_b32 v209, s76, v208
  s_lshl_b32 s76, s77, 10
  s_add_u32 m0, s76, s79
  s_lshl_b32 s76, s77, 11
  s_add_u32 s76, s76, s78
  s_add_u32 s76, s76, 512
  buffer_load_dwordx4 v209, s[4:7], s76 offen lds
  s_add_u32 s77, s42, 3
  s_and_b32 s77, s77, 15
  s_lshl_b32 s76, s77, 5
  s_and_b32 s76, s76, 0xf0
  v_xor_b32 v210, s76, v208
  s_lshl_b32 s76, s77, 10
  s_add_u32 m0, s76, s79
  s_lshl_b32 s76, s77, 11
  s_add_u32 s76, s76, s78
  s_add_u32 s76, s76, 512
  buffer_load_dwordx4 v210, s[4:7], s76 offen lds
  s_add_u32 s77, s42, 4
  s_and_b32 s77, s77, 15
  s_lshl_b32 s76, s77, 5
  s_and_b32 s76, s76, 0xf0
  v_xor_b32 v209, s76, v208
  s_lshl_b32 s76, s77, 10
  s_add_u32 m0, s76, s79
  s_lshl_b32 s76, s77, 11
  s_add_u32 s76, s76, s78
  s_add_u32 s76, s76, 512
  buffer_load_dwordx4 v209, s[4:7], s76 offen lds
  s_add_u32 s77, s42, 5
  s_and_b32 s77, s77, 15
  s_lshl_b32 s76, s77, 5
  s_and_b32 s76, s76, 0xf0
  v_xor_b32 v210, s76, v208
  s_lshl_b32 s76, s77, 10
  s_add_u32 m0, s76, s79
  s_lshl_b32 s76, s77, 11
  s_add_u32 s76, s76, s78
  s_add_u32 s76, s76, 512
  buffer_load_dwordx4 v210, s[4:7], s76 offen lds
  s_add_u32 s77, s42, 6
  s_and_b32 s77, s77, 15
  s_lshl_b32 s76, s77, 5
  s_and_b32 s76, s76, 0xf0
  v_xor_b32 v209, s76, v208
  s_lshl_b32 s76, s77, 10
  s_add_u32 m0, s76, s79
  s_lshl_b32 s76, s77, 11
  s_add_u32 s76, s76, s78
  s_add_u32 s76, s76, 512
  buffer_load_dwordx4 v209, s[4:7], s76 offen lds
  s_add_u32 s77, s42, 7
  s_and_b32 s77, s77, 15
  s_lshl_b32 s76, s77, 5
  s_and_b32 s76, s76, 0xf0
  v_xor_b32 v210, s76, v208
  s_lshl_b32 s76, s77, 10
  s_add_u32 m0, s76, s79
  s_lshl_b32 s76, s77, 11
  s_add_u32 s76, s76, s78
  s_add_u32 s76, s76, 512
  buffer_load_dwordx4 v210, s[4:7], s76 offen lds
  s_add_u32 s77, s42, 8
  s_and_b32 s77, s77, 15
  s_lshl_b32 s76, s77, 5
  s_and_b32 s76, s76, 0xf0
  v_xor_b32 v209, s76, v208
  s_lshl_b32 s76, s77, 10
  s_add_u32 m0, s76, s79
  s_lshl_b32 s76, s77, 11
  s_add_u32 s76, s76, s78
  s_add_u32 s76, s76, 512
  buffer_load_dwordx4 v209, s[4:7], s76 offen lds
  s_add_u32 s77, s42, 9
  s_and_b32 s77, s77, 15
  s_lshl_b32 s76, s77, 5
  s_and_b32 s76, s76, 0xf0
  v_xor_b32 v210, s76, v208
  s_lshl_b32 s76, s77, 10
  s_add_u32 m0, s76, s79
  s_lshl_b32 s76, s77, 11
  s_add_u32 s76, s76, s78
  s_add_u32 s76, s76, 512
  buffer_load_dwordx4 v210, s[4:7], s76 offen lds
  s_add_u32 s77, s42, 10
  s_and_b32 s77, s77, 15
  s_lshl_b32 s76, s77, 5
  s_and_b32 s76, s76, 0xf0
  v_xor_b32 v209, s76, v208
  s_lshl_b32 s76, s77, 10
  s_add_u32 m0, s76, s79
  s_lshl_b32 s76, s77, 11
  s_add_u32 s76, s76, s78
  s_add_u32 s76, s76, 512
  buffer_load_dwordx4 v209, s[4:7], s76 offen lds
  s_add_u32 s77, s42, 11
  s_and_b32 s77, s77, 15
  s_lshl_b32 s76, s77, 5
  s_and_b32 s76, s76, 0xf0
  v_xor_b32 v210, s76, v208
  s_lshl_b32 s76, s77, 10
  s_add_u32 m0, s76, s79
  s_lshl_b32 s76, s77, 11
  s_add_u32 s76, s76, s78
  s_add_u32 s76, s76, 512
  buffer_load_dwordx4 v210, s[4:7], s76 offen lds
  s_add_u32 s77, s42, 12
  s_and_b32 s77, s77, 15
  s_lshl_b32 s76, s77, 5
  s_and_b32 s76, s76, 0xf0
  v_xor_b32 v209, s76, v208
  s_lshl_b32 s76, s77, 10
  s_add_u32 m0, s76, s79
  s_lshl_b32 s76, s77, 11
  s_add_u32 s76, s76, s78
  s_add_u32 s76, s76, 512
  buffer_load_dwordx4 v209, s[4:7], s76 offen lds
  s_add_u32 s77, s42, 13
  s_and_b32 s77, s77, 15
  s_lshl_b32 s76, s77, 5
  s_and_b32 s76, s76, 0xf0
  v_xor_b32 v210, s76, v208
  s_lshl_b32 s76, s77, 10
  s_add_u32 m0, s76, s79
  s_lshl_b32 s76, s77, 11
  s_add_u32 s76, s76, s78
  s_add_u32 s76, s76, 512
  buffer_load_dwordx4 v210, s[4:7], s76 offen lds
  s_add_u32 s77, s42, 14
  s_and_b32 s77, s77, 15
  s_lshl_b32 s76, s77, 5
  s_and_b32 s76, s76, 0xf0
  v_xor_b32 v209, s76, v208
  s_lshl_b32 s76, s77, 10
  s_add_u32 m0, s76, s79
  s_lshl_b32 s76, s77, 11
  s_add_u32 s76, s76, s78
  s_add_u32 s76, s76, 512
  buffer_load_dwordx4 v209, s[4:7], s76 offen lds
  s_add_u32 s77, s42, 15
  s_and_b32 s77, s77, 15
  s_lshl_b32 s76, s77, 5
  s_and_b32 s76, s76, 0xf0
  v_xor_b32 v210, s76, v208
  s_lshl_b32 s76, s77, 10
  s_add_u32 m0, s76, s79
  s_lshl_b32 s76, s77, 11
  s_add_u32 s76, s76, s78
  s_add_u32 s76, s76, 512
  buffer_load_dwordx4 v210, s[4:7], s76 offen lds
  v_mov_b32 v230, 0
  v_mov_b32 v231, 0
  v_mov_b32 v234, 0x3f803f80
  v_dot2c_f32_bf16 v230, v0, v234
  v_dot2c_f32_bf16 v231, v0, v0
  v_dot2c_f32_bf16 v230, v1, v234
  v_dot2c_f32_bf16 v231, v1, v1
  v_dot2c_f32_bf16 v230, v2, v234
  v_dot2c_f32_bf16 v231, v2, v2
  v_dot2c_f32_bf16 v230, v3, v234
  v_dot2c_f32_bf16 v231, v3, v3
  v_dot2c_f32_bf16 v230, v4, v234
  v_dot2c_f32_bf16 v231, v4, v4
  v_dot2c_f32_bf16 v230, v5, v234
  v_dot2c_f32_bf16 v231, v5, v5
  v_dot2c_f32_bf16 v230, v6, v234
  v_dot2c_f32_bf16 v231, v6, v6
  v_dot2c_f32_bf16 v230, v7, v234
  v_dot2c_f32_bf16 v231, v7, v7
  v_dot2c_f32_bf16 v230, v8, v234
  v_dot2c_f32_bf16 v231, v8, v8
  v_dot2c_f32_bf16 v230, v9, v234
  v_dot2c_f32_bf16 v231, v9, v9
  v_dot2c_f32_bf16 v230, v10, v234
  v_dot2c_f32_bf16 v231, v10, v10
  v_dot2c_f32_bf16 v230, v11, v234
  v_dot2c_f32_bf16 v231, v11, v11
  v_dot2c_f32_bf16 v230, v12, v234
  v_dot2c_f32_bf16 v231, v12, v12
  v_dot2c_f32_bf16 v230, v13, v234
  v_dot2c_f32_bf16 v231, v13, v13
  v_dot2c_f32_bf16 v230, v14, v234
  v_dot2c_f32_bf16 v231, v14, v14
  v_dot2c_f32_bf16 v230, v15, v234
  v_dot2c_f32_bf16 v231, v15, v15
  v_dot2c_f32_bf16 v230, v16, v234
  v_dot2c_f32_bf16 v231, v16, v16
  v_dot2c_f32_bf16 v230, v17, v234
  v_dot2c_f32_bf16 v231, v17, v17
  v_dot2c_f32_bf16 v230, v18, v234
  v_dot2c_f32_bf16 v231, v18, v18
  v_dot2c_f32_bf16 v230, v19, v234
  v_dot2c_f32_bf16 v231, v19, v19
  v_dot2c_f32_bf16 v230, v20, v234
  v_dot2c_f32_bf16 v231, v20, v20
  v_dot2c_f32_bf16 v230, v21, v234
  v_dot2c_f32_bf16 v231, v21, v21
  v_dot2c_f32_bf16 v230, v22, v234
  v_dot2c_f32_bf16 v231, v22, v22
  v_dot2c_f32_bf16 v230, v23, v234
  v_dot2c_f32_bf16 v231, v23, v23
  v_dot2c_f32_bf16 v230, v24, v234
  v_dot2c_f32_bf16 v231, v24, v24
  v_dot2c_f32_bf16 v230, v25, v234
  v_dot2c_f32_bf16 v231, v25, v25
  v_dot2c_f32_bf16 v230, v26, v234
  v_dot2c_f32_bf16 v231, v26, v26
  v_dot2c_f32_bf16 v230, v27, v234
  v_dot2c_f32_bf16 v231, v27, v27
  v_dot2c_f32_bf16 v230, v28, v234
  v_dot2c_f32_bf16 v231, v28, v28
  v_dot2c_f32_bf16 v230, v29, v234
  v_dot2c_f32_bf16 v231, v29, v29
  v_dot2c_f32_bf16 v230, v30, v234
  v_dot2c_f32_bf16 v231, v30, v30
  v_dot2c_f32_bf16 v230, v31, v234
  v_dot2c_f32_bf16 v231, v31, v31
  v_dot2c_f32_bf16 v230, v32, v234
  v_dot2c_f32_bf16 v231, v32, v32
  v_dot2c_f32_bf16 v230, v33, v234
  v_dot2c_f32_bf16 v231, v33, v33
  v_dot2c_f32_bf16 v230, v34, v234
  v_dot2c_f32_bf16 v231, v34, v34
  v_dot2c_f32_bf16 v230, v35, v234
  v_dot2c_f32_bf16 v231, v35, v35
  v_dot2c_f32_bf16 v230, v36, v234
  v_dot2c_f32_bf16 v231, v36, v36
  v_dot2c_f32_bf16 v230, v37, v234
  v_dot2c_f32_bf16 v231, v37, v37
  v_dot2c_f32_bf16 v230, v38, v234
  v_dot2c_f32_bf16 v231, v38, v38
  v_dot2c_f32_bf16 v230, v39, v234
  v_dot2c_f32_bf16 v231, v39, v39
  v_dot2c_f32_bf16 v230, v40, v234
  v_dot2c_f32_bf16 v231, v40, v40
  v_dot2c_f32_bf16 v230, v41, v234
  v_dot2c_f32_bf16 v231, v41, v41
  v_dot2c_f32_bf16 v230, v42, v234
  v_dot2c_f32_bf16 v231, v42, v42
  v_dot2c_f32_bf16 v230, v43, v234
  v_dot2c_f32_bf16 v231, v43, v43
  v_dot2c_f32_bf16 v230, v44, v234
  v_dot2c_f32_bf16 v231, v44, v44
  v_dot2c_f32_bf16 v230, v45, v234
  v_dot2c_f32_bf16 v231, v45, v45
  v_dot2c_f32_bf16 v230, v46, v234
  v_dot2c_f32_bf16 v231, v46, v46
  v_dot2c_f32_bf16 v230, v47, v234
  v_dot2c_f32_bf16 v231, v47, v47
  v_dot2c_f32_bf16 v230, v48, v234
  v_dot2c_f32_bf16 v231, v48, v48
  v_dot2c_f32_bf16 v230, v49, v234
  v_dot2c_f32_bf16 v231, v49, v49
  v_dot2c_f32_bf16 v230, v50, v234
  v_dot2c_f32_bf16 v231, v50, v50
  v_dot2c_f32_bf16 v230, v51, v234
  v_dot2c_f32_bf16 v231, v51, v51
  v_dot2c_f32_bf16 v230, v52, v234
  v_dot2c_f32_bf16 v231, v52, v52
  v_dot2c_f32_bf16 v230, v53, v234
  v_dot2c_f32_bf16 v231, v53, v53
  v_dot2c_f32_bf16 v230, v54, v234
  v_dot2c_f32_bf16 v231, v54, v54
  v_dot2c_f32_bf16 v230, v55, v234
  v_dot2c_f32_bf16 v231, v55, v55
  v_dot2c_f32_bf16 v230, v56, v234
  v_dot2c_f32_bf16 v231, v56, v56
  v_dot2c_f32_bf16 v230, v57, v234
  v_dot2c_f32_bf16 v231, v57, v57
  v_dot2c_f32_bf16 v230, v58, v234
  v_dot2c_f32_bf16 v231, v58, v58
  v_dot2c_f32_bf16 v230, v59, v234
  v_dot2c_f32_bf16 v231, v59, v59
  v_dot2c_f32_bf16 v230, v60, v234
  v_dot2c_f32_bf16 v231, v60, v60
  v_dot2c_f32_bf16 v230, v61, v234
  v_dot2c_f32_bf16 v231, v61, v61
  v_dot2c_f32_bf16 v230, v62, v234
  v_dot2c_f32_bf16 v231, v62, v62
  v_dot2c_f32_bf16 v230, v63, v234
  v_dot2c_f32_bf16 v231, v63, v63
  ds_read_b64_tr_b16 v[176:177], v254 offset:0
  ds_read_b64_tr_b16 v[178:179], v254 offset:256
  ds_read_b64_tr_b16 v[180:181], v254 offset:32768
  ds_read_b64_tr_b16 v[182:183], v254 offset:33024
  ds_read_b64_tr_b16 v[184:185], v254 offset:512
  ds_read_b64_tr_b16 v[186:187], v254 offset:768
  ds_read_b64_tr_b16 v[188:189], v254 offset:33280
  ds_read_b64_tr_b16 v[190:191], v254 offset:33536
  ds_read_b64_tr_b16 v[192:193], v254 offset:2048
  ds_read_b64_tr_b16 v[194:195], v254 offset:2304
  ds_read_b64_tr_b16 v[196:197], v254 offset:34816
  ds_read_b64_tr_b16 v[198:199], v254 offset:35072
  s_waitcnt lgkmcnt(8)
  v_mfma_f32_32x32x16_bf16 v[128:143], v[176:179], v[0:3], 0
  ds_read_b64_tr_b16 v[200:201], v254 offset:2560
  ds_read_b64_tr_b16 v[202:203], v254 offset:2816
  ds_read_b64_tr_b16 v[204:205], v254 offset:35328
  ds_read_b64_tr_b16 v[206:207], v254 offset:35584
  v_mfma_f32_32x32x16_bf16 v[144:159], v[0:3], v[180:183], 0
  s_waitcnt lgkmcnt(8)
  v_mfma_f32_32x32x16_bf16 v[128:143], v[184:187], v[4:7], v[128:143]
  ds_read_b64_tr_b16 v[176:177], v254 offset:4096
  ds_read_b64_tr_b16 v[178:179], v254 offset:4352
  ds_read_b64_tr_b16 v[180:181], v254 offset:36864
  ds_read_b64_tr_b16 v[182:183], v254 offset:37120
  v_mfma_f32_32x32x16_bf16 v[144:159], v[4:7], v[188:191], v[144:159]
  s_waitcnt lgkmcnt(8)
  v_mfma_f32_32x32x16_bf16 v[128:143], v[192:195], v[8:11], v[128:143]
  ds_read_b64_tr_b16 v[184:185], v254 offset:4608
  ds_read_b64_tr_b16 v[186:187], v254 offset:4864
  ds_read_b64_tr_b16 v[188:189], v254 offset:37376
  ds_read_b64_tr_b16 v[190:191], v254 offset:37632
  v_mfma_f32_32x32x16_bf16 v[144:159], v[8:11], v[196:199], v[144:159]
  s_waitcnt lgkmcnt(8)
  v_mfma_f32_32x32x16_bf16 v[128:143], v[200:203], v[12:15], v[128:143]
  ds_read_b64_tr_b16 v[192:193], v254 offset:6144
  ds_read_b64_tr_b16 v[194:195], v254 offset:6400
  ds_read_b64_tr_b16 v[196:197], v254 offset:38912
  ds_read_b64_tr_b16 v[198:199], v254 offset:39168
  v_mfma_f32_32x32x16_bf16 v[144:159], v[12:15], v[204:207], v[144:159]
  s_waitcnt lgkmcnt(8)
  v_mfma_f32_32x32x16_bf16 v[128:143], v[176:179], v[16:19], v[128:143]
  ds_read_b64_tr_b16 v[200:201], v254 offset:6656
  ds_read_b64_tr_b16 v[202:203], v254 offset:6912
  ds_read_b64_tr_b16 v[204:205], v254 offset:39424
  ds_read_b64_tr_b16 v[206:207], v254 offset:39680
  v_mfma_f32_32x32x16_bf16 v[144:159], v[16:19], v[180:183], v[144:159]
  s_waitcnt lgkmcnt(8)
  v_mfma_f32_32x32x16_bf16 v[128:143], v[184:187], v[20:23], v[128:143]
  ds_read_b64_tr_b16 v[176:177], v254 offset:8192
  ds_read_b64_tr_b16 v[178:179], v254 offset:8448
  ds_read_b64_tr_b16 v[180:181], v254 offset:40960
  ds_read_b64_tr_b16 v[182:183], v254 offset:41216
  v_mfma_f32_32x32x16_bf16 v[144:159], v[20:23], v[188:191], v[144:159]
  s_waitcnt lgkmcnt(8)
  v_mfma_f32_32x32x16_bf16 v[128:143], v[192:195], v[24:27], v[128:143]
  ds_read_b64_tr_b16 v[184:185], v254 offset:8704
  ds_read_b64_tr_b16 v[186:187], v254 offset:8960
  ds_read_b64_tr_b16 v[188:189], v254 offset:41472
  ds_read_b64_tr_b16 v[190:191], v254 offset:41728
  v_mfma_f32_32x32x16_bf16 v[144:159], v[24:27], v[196:199], v[144:159]
  s_waitcnt lgkmcnt(8)
  v_mfma_f32_32x32x16_bf16 v[128:143], v[200:203], v[28:31], v[128:143]
  ds_read_b64_tr_b16 v[192:193], v254 offset:10240
  ds_read_b64_tr_b16 v[194:195], v254 offset:10496
  ds_read_b64_tr_b16 v[196:197], v254 offset:43008
  ds_read_b64_tr_b16 v[198:199], v254 offset:43264
  v_mfma_f32_32x32x16_bf16 v[144:159], v[28:31], v[204:207], v[144:159]
  s_waitcnt lgkmcnt(8)
  v_mfma_f32_32x32x16_bf16 v[128:143], v[176:179], v[32:35], v[128:143]
  ds_read_b64_tr_b16 v[200:201], v254 offset:10752
  ds_read_b64_tr_b16 v[202:203], v254 offset:11008
  ds_read_b64_tr_b16 v[204:205], v254 offset:43520
  ds_read_b64_tr_b16 v[206:207], v254 offset:43776
  v_mfma_f32_32x32x16_bf16 v[144:159], v[32:35], v[180:183], v[144:159]
  s_waitcnt lgkmcnt(8)
  v_mfma_f32_32x32x16_bf16 v[128:143], v[184:187], v[36:39], v[128:143]
  ds_read_b64_tr_b16 v[176:177], v254 offset:12288
  ds_read_b64_tr_b16 v[178:179], v254 offset:12544
  ds_read_b64_tr_b16 v[180:181], v254 offset:45056
  ds_read_b64_tr_b16 v[182:183], v254 offset:45312
  v_mfma_f32_32x32x16_bf16 v[144:159], v[36:39], v[188:191], v[144:159]
  s_waitcnt lgkmcnt(8)
  v_mfma_f32_32x32x16_bf16 v[128:143], v[192:195], v[40:43], v[128:143]
  ds_read_b64_tr_b16 v[184:185], v254 offset:12800
  ds_read_b64_tr_b16 v[186:187], v254 offset:13056
  ds_read_b64_tr_b16 v[188:189], v254 offset:45568
  ds_read_b64_tr_b16 v[190:191], v254 offset:45824
  v_mfma_f32_32x32x16_bf16 v[144:159], v[40:43], v[196:199], v[144:159]
  s_waitcnt lgkmcnt(8)
  v_mfma_f32_32x32x16_bf16 v[128:143], v[200:203], v[44:47], v[128:143]
  ds_read_b64_tr_b16 v[192:193], v254 offset:14336
  ds_read_b64_tr_b16 v[194:195], v254 offset:14592
  ds_read_b64_tr_b16 v[196:197], v254 offset:47104
  ds_read_b64_tr_b16 v[198:199], v254 offset:47360
  v_mfma_f32_32x32x16_bf16 v[144:159], v[44:47], v[204:207], v[144:159]
  s_waitcnt lgkmcnt(8)
  v_mfma_f32_32x32x16_bf16 v[128:143], v[176:179], v[48:51], v[128:143]
  ds_read_b64_tr_b16 v[200:201], v254 offset:14848
  ds_read_b64_tr_b16 v[202:203], v254 offset:15104
  ds_read_b64_tr_b16 v[204:205], v254 offset:47616
  ds_read_b64_tr_b16 v[206:207], v254 offset:47872
  v_mfma_f32_32x32x16_bf16 v[144:159], v[48:51], v[180:183], v[144:159]
  s_waitcnt lgkmcnt(8)
  v_mfma_f32_32x32x16_bf16 v[128:143], v[184:187], v[52:55], v[128:143]
  v_mfma_f32_32x32x16_bf16 v[144:159], v[52:55], v[188:191], v[144:159]
  s_waitcnt lgkmcnt(4)
  v_mfma_f32_32x32x16_bf16 v[128:143], v[192:195], v[56:59], v[128:143]
  v_mfma_f32_32x32x16_bf16 v[144:159], v[56:59], v[196:199], v[144:159]
  s_waitcnt lgkmcnt(0)
  v_mfma_f32_32x32x16_bf16 v[128:143], v[200:203], v[60:63], v[128:143]
  v_mfma_f32_32x32x16_bf16 v[144:159], v[60:63], v[204:207], v[144:159]
  s_waitcnt vmcnt(0)
  v_xor_b32 v212, 0, v211
  ds_read_b128 v[64:67], v212 offset:0
  v_xor_b32 v213, 16, v211
  ds_read_b128 v[68:71], v213 offset:0
  v_xor_b32 v212, 64, v211
  ds_read_b128 v[72:75], v212 offset:0
  v_xor_b32 v213, 80, v211
  ds_read_b128 v[76:79], v213 offset:0
  v_xor_b32 v212, 128, v211
  ds_read_b128 v[80:83], v212 offset:0
  v_xor_b32 v213, 144, v211
  ds_read_b128 v[84:87], v213 offset:0
  v_xor_b32 v212, 192, v211
  ds_read_b128 v[88:91], v212 offset:0
  v_xor_b32 v213, 208, v211
  ds_read_b128 v[92:95], v213 offset:0
  v_xor_b32 v212, 0, v211
  ds_read_b128 v[96:99], v212 offset:256
  v_xor_b32 v213, 16, v211
  ds_read_b128 v[100:103], v213 offset:256
  v_xor_b32 v212, 64, v211
  ds_read_b128 v[104:107], v212 offset:256
  v_xor_b32 v213, 80, v211
  ds_read_b128 v[108:111], v213 offset:256
  v_xor_b32 v212, 128, v211
  ds_read_b128 v[112:115], v212 offset:256
  v_xor_b32 v213, 144, v211
  ds_read_b128 v[116:119], v213 offset:256
  v_xor_b32 v212, 192, v211
  ds_read_b128 v[120:123], v212 offset:256
  v_xor_b32 v213, 208, v211
  ds_read_b128 v[124:127], v213 offset:256
  s_waitcnt lgkmcnt(0)
  v_dot2c_f32_bf16 v230, v64, v234
  v_dot2c_f32_bf16 v231, v64, v64
  v_dot2c_f32_bf16 v230, v65, v234
  v_dot2c_f32_bf16 v231, v65, v65
  v_dot2c_f32_bf16 v230, v66, v234
  v_dot2c_f32_bf16 v231, v66, v66
  v_dot2c_f32_bf16 v230, v67, v234
  v_dot2c_f32_bf16 v231, v67, v67
  v_dot2c_f32_bf16 v230, v68, v234
  v_dot2c_f32_bf16 v231, v68, v68
  v_dot2c_f32_bf16 v230, v69, v234
  v_dot2c_f32_bf16 v231, v69, v69
  v_dot2c_f32_bf16 v230, v70, v234
  v_dot2c_f32_bf16 v231, v70, v70
  v_dot2c_f32_bf16 v230, v71, v234
  v_dot2c_f32_bf16 v231, v71, v71
  v_dot2c_f32_bf16 v230, v72, v234
  v_dot2c_f32_bf16 v231, v72, v72
  v_dot2c_f32_bf16 v230, v73, v234
  v_dot2c_f32_bf16 v231, v73, v73
  v_dot2c_f32_bf16 v230, v74, v234
  v_dot2c_f32_bf16 v231, v74, v74
  v_dot2c_f32_bf16 v230, v75, v234
  v_dot2c_f32_bf16 v231, v75, v75
  v_dot2c_f32_bf16 v230, v76, v234
  v_dot2c_f32_bf16 v231, v76, v76
  v_dot2c_f32_bf16 v230, v77, v234
  v_dot2c_f32_bf16 v231, v77, v77
  v_dot2c_f32_bf16 v230, v78, v234
  v_dot2c_f32_bf16 v231, v78, v78
  v_dot2c_f32_bf16 v230, v79, v234
  v_dot2c_f32_bf16 v231, v79, v79
  v_dot2c_f32_bf16 v230, v80, v234
  v_dot2c_f32_bf16 v231, v80, v80
  v_dot2c_f32_bf16 v230, v81, v234
  v_dot2c_f32_bf16 v231, v81, v81
  v_dot2c_f32_bf16 v230, v82, v234
  v_dot2c_f32_bf16 v231, v82, v82
  v_dot2c_f32_bf16 v230, v83, v234
  v_dot2c_f32_bf16 v231, v83, v83
  v_dot2c_f32_bf16 v230, v84, v234
  v_dot2c_f32_bf16 v231, v84, v84
  v_dot2c_f32_bf16 v230, v85, v234
  v_dot2c_f32_bf16 v231, v85, v85
  v_dot2c_f32_bf16 v230, v86, v234
  v_dot2c_f32_bf16 v231, v86, v86
  v_dot2c_f32_bf16 v230, v87, v234
  v_dot2c_f32_bf16 v231, v87, v87
  v_dot2c_f32_bf16 v230, v88, v234
  v_dot2c_f32_bf16 v231, v88, v88
  v_dot2c_f32_bf16 v230, v89, v234
  v_dot2c_f32_bf16 v231, v89, v89
  v_dot2c_f32_bf16 v230, v90, v234
  v_dot2c_f32_bf16 v231, v90, v90
  v_dot2c_f32_bf16 v230, v91, v234
  v_dot2c_f32_bf16 v231, v91, v91
  v_dot2c_f32_bf16 v230, v92, v234
  v_dot2c_f32_bf16 v231, v92, v92
  v_dot2c_f32_bf16 v230, v93, v234
  v_dot2c_f32_bf16 v231, v93, v93
  v_dot2c_f32_bf16 v230, v94, v234
  v_dot2c_f32_bf16 v231, v94, v94
  v_dot2c_f32_bf16 v230, v95, v234
  v_dot2c_f32_bf16 v231, v95, v95
  v_dot2c_f32_bf16 v230, v96, v234
  v_dot2c_f32_bf16 v231, v96, v96
  v_dot2c_f32_bf16 v230, v97, v234
  v_dot2c_f32_bf16 v231, v97, v97
  v_dot2c_f32_bf16 v230, v98, v234
  v_dot2c_f32_bf16 v231, v98, v98
  v_dot2c_f32_bf16 v230, v99, v234
  v_dot2c_f32_bf16 v231, v99, v99
  v_dot2c_f32_bf16 v230, v100, v234
  v_dot2c_f32_bf16 v231, v100, v100
  v_dot2c_f32_bf16 v230, v101, v234
  v_dot2c_f32_bf16 v231, v101, v101
  v_dot2c_f32_bf16 v230, v102, v234
  v_dot2c_f32_bf16 v231, v102, v102
  v_dot2c_f32_bf16 v230, v103, v234
  v_dot2c_f32_bf16 v231, v103, v103
  v_dot2c_f32_bf16 v230, v104, v234
  v_dot2c_f32_bf16 v231, v104, v104
  v_dot2c_f32_bf16 v230, v105, v234
  v_dot2c_f32_bf16 v231, v105, v105
  v_dot2c_f32_bf16 v230, v106, v234
  v_dot2c_f32_bf16 v231, v106, v106
  v_dot2c_f32_bf16 v230, v107, v234
  v_dot2c_f32_bf16 v231, v107, v107
  v_dot2c_f32_bf16 v230, v108, v234
  v_dot2c_f32_bf16 v231, v108, v108
  v_dot2c_f32_bf16 v230, v109, v234
  v_dot2c_f32_bf16 v231, v109, v109
  v_dot2c_f32_bf16 v230, v110, v234
  v_dot2c_f32_bf16 v231, v110, v110
  v_dot2c_f32_bf16 v230, v111, v234
  v_dot2c_f32_bf16 v231, v111, v111
  v_dot2c_f32_bf16 v230, v112, v234
  v_dot2c_f32_bf16 v231, v112, v112
  v_dot2c_f32_bf16 v230, v113, v234
  v_dot2c_f32_bf16 v231, v113, v113
  v_dot2c_f32_bf16 v230, v114, v234
  v_dot2c_f32_bf16 v231, v114, v114
  v_dot2c_f32_bf16 v230, v115, v234
  v_dot2c_f32_bf16 v231, v115, v115
  v_dot2c_f32_bf16 v230, v116, v234
  v_dot2c_f32_bf16 v231, v116, v116
  v_dot2c_f32_bf16 v230, v117, v234
  v_dot2c_f32_bf16 v231, v117, v117
  v_dot2c_f32_bf16 v230, v118, v234
  v_dot2c_f32_bf16 v231, v118, v118
  v_dot2c_f32_bf16 v230, v119, v234
  v_dot2c_f32_bf16 v231, v119, v119
  v_dot2c_f32_bf16 v230, v120, v234
  v_dot2c_f32_bf16 v231, v120, v120
  v_dot2c_f32_bf16 v230, v121, v234
  v_dot2c_f32_bf16 v231, v121, v121
  v_dot2c_f32_bf16 v230, v122, v234
  v_dot2c_f32_bf16 v231, v122, v122
  v_dot2c_f32_bf16 v230, v123, v234
  v_dot2c_f32_bf16 v231, v123, v123
  v_dot2c_f32_bf16 v230, v124, v234
  v_dot2c_f32_bf16 v231, v124, v124
  v_dot2c_f32_bf16 v230, v125, v234
  v_dot2c_f32_bf16 v231, v125, v125
  v_dot2c_f32_bf16 v230, v126, v234
  v_dot2c_f32_bf16 v231, v126, v126
  v_dot2c_f32_bf16 v230, v127, v234
  v_dot2c_f32_bf16 v231, v127, v127
  s_nop 2
  v_permlane32_swap_b32 v230, v231
  v_add_f32 v230, v230, v231
  v_mov_b32 v231, v230
  s_nop 1
  v_permlane32_swap_b32 v230, v231
  v_mul_f32 v230, 0x3b000000, v230
  v_mul_f32 v231, 0x3b000000, v231
  v_fma_f32 v231, -v230, v230, v231
  v_max_f32 v231, 0, v231
  v_add_f32 v231, 0x3727c5ac, v231
  v_rsq_f32 v233, v231
  s_nop 0
  v_mul_f32 v232, 0x3fb8aa3b, v233
  v_sub_f32 v234, 0, v230
  v_cvt_pk_bf16_f32 v228, v234, v234
  v_and_b32 v235, 0xffff0000, v228
  v_sub_f32 v235, v234, v235
  v_cvt_pk_bf16_f32 v229, v235, 0
  v_cndmask_b32 v228, 0, v228, s[48:49]
  v_cndmask_b32 v229, 0, v229, s[48:49]
  v_mov_b32 v230, 0
  v_mov_b32 v231, 0
  ds_read_b64_tr_b16 v[176:177], v254 offset:16384
  ds_read_b64_tr_b16 v[178:179], v254 offset:16640
  ds_read_b64_tr_b16 v[180:181], v254 offset:49152
  ds_read_b64_tr_b16 v[182:183], v254 offset:49408
  ds_read_b64_tr_b16 v[184:185], v254 offset:16896
  ds_read_b64_tr_b16 v[186:187], v254 offset:17152
  ds_read_b64_tr_b16 v[188:189], v254 offset:49664
  ds_read_b64_tr_b16 v[190:191], v254 offset:49920
  ds_read_b64_tr_b16 v[192:193], v254 offset:18432
  ds_read_b64_tr_b16 v[194:195], v254 offset:18688
  ds_read_b64_tr_b16 v[196:197], v254 offset:51200
  ds_read_b64_tr_b16 v[198:199], v254 offset:51456
  s_waitcnt lgkmcnt(8)
  v_mfma_f32_32x32x16_bf16 v[128:143], v[176:179], v[64:67], v[128:143]
  ds_read_b64_tr_b16 v[200:201], v254 offset:18944
  ds_read_b64_tr_b16 v[202:203], v254 offset:19200
  ds_read_b64_tr_b16 v[204:205], v254 offset:51712
  ds_read_b64_tr_b16 v[206:207], v254 offset:51968
  v_mfma_f32_32x32x16_bf16 v[144:159], v[64:67], v[180:183], v[144:159]
  s_waitcnt lgkmcnt(8)
  v_mfma_f32_32x32x16_bf16 v[128:143], v[184:187], v[68:71], v[128:143]
  ds_read_b64_tr_b16 v[176:177], v254 offset:20480
  ds_read_b64_tr_b16 v[178:179], v254 offset:20736
  ds_read_b64_tr_b16 v[180:181], v254 offset:53248
  ds_read_b64_tr_b16 v[182:183], v254 offset:53504
  v_mfma_f32_32x32x16_bf16 v[144:159], v[68:71], v[188:191], v[144:159]
  s_waitcnt lgkmcnt(8)
  v_mfma_f32_32x32x16_bf16 v[128:143], v[192:195], v[72:75], v[128:143]
  ds_read_b64_tr_b16 v[184:185], v254 offset:20992
  ds_read_b64_tr_b16 v[186:187], v254 offset:21248
  ds_read_b64_tr_b16 v[188:189], v254 offset:53760
  ds_read_b64_tr_b16 v[190:191], v254 offset:54016
  v_mfma_f32_32x32x16_bf16 v[144:159], v[72:75], v[196:199], v[144:159]
  s_waitcnt lgkmcnt(8)
  v_mfma_f32_32x32x16_bf16 v[128:143], v[200:203], v[76:79], v[128:143]
  ds_read_b64_tr_b16 v[192:193], v254 offset:22528
  ds_read_b64_tr_b16 v[194:195], v254 offset:22784
  ds_read_b64_tr_b16 v[196:197], v254 offset:55296
  ds_read_b64_tr_b16 v[198:199], v254 offset:55552
  v_mfma_f32_32x32x16_bf16 v[144:159], v[76:79], v[204:207], v[144:159]
  s_waitcnt lgkmcnt(8)
  v_mfma_f32_32x32x16_bf16 v[128:143], v[176:179], v[80:83], v[128:143]
  ds_read_b64_tr_b16 v[200:201], v254 offset:23040
  ds_read_b64_tr_b16 v[202:203], v254 offset:23296
  ds_read_b64_tr_b16 v[204:205], v254 offset:55808
  ds_read_b64_tr_b16 v[206:207], v254 offset:56064
  v_mfma_f32_32x32x16_bf16 v[144:159], v[80:83], v[180:183], v[144:159]
  v_mfma_f32_32x32x16_bf16 v[128:143], a[240:243], v[228:231], v[128:143]
  v_mfma_f32_32x32x16_bf16 v[144:159], v[228:231], a[242:245], v[144:159]
  s_waitcnt lgkmcnt(8)
  v_mfma_f32_32x32x16_bf16 v[128:143], v[184:187], v[84:87], v[128:143]
  ds_read_b64_tr_b16 v[176:177], v254 offset:24576
  ds_read_b64_tr_b16 v[178:179], v254 offset:24832
  ds_read_b64_tr_b16 v[180:181], v254 offset:57344
  ds_read_b64_tr_b16 v[182:183], v254 offset:57600
  v_mfma_f32_32x32x16_bf16 v[144:159], v[84:87], v[188:191], v[144:159]
  s_waitcnt lgkmcnt(8)
  v_mfma_f32_32x32x16_bf16 v[128:143], v[192:195], v[88:91], v[128:143]
  ds_read_b64_tr_b16 v[184:185], v254 offset:25088
  ds_read_b64_tr_b16 v[186:187], v254 offset:25344
  ds_read_b64_tr_b16 v[188:189], v254 offset:57856
  ds_read_b64_tr_b16 v[190:191], v254 offset:58112
  v_mfma_f32_32x32x16_bf16 v[144:159], v[88:91], v[196:199], v[144:159]
  s_waitcnt lgkmcnt(8)
  v_mfma_f32_32x32x16_bf16 v[128:143], v[200:203], v[92:95], v[128:143]
  ds_read_b64_tr_b16 v[192:193], v254 offset:26624
  ds_read_b64_tr_b16 v[194:195], v254 offset:26880
  ds_read_b64_tr_b16 v[196:197], v254 offset:59392
  ds_read_b64_tr_b16 v[198:199], v254 offset:59648
  v_mfma_f32_32x32x16_bf16 v[144:159], v[92:95], v[204:207], v[144:159]
  s_waitcnt lgkmcnt(8)
  v_mfma_f32_32x32x16_bf16 v[128:143], v[176:179], v[96:99], v[128:143]
  ds_read_b64_tr_b16 v[200:201], v254 offset:27136
  ds_read_b64_tr_b16 v[202:203], v254 offset:27392
  ds_read_b64_tr_b16 v[204:205], v254 offset:59904
  ds_read_b64_tr_b16 v[206:207], v254 offset:60160
  v_mfma_f32_32x32x16_bf16 v[144:159], v[96:99], v[180:183], v[144:159]
  s_waitcnt lgkmcnt(8)
  v_mfma_f32_32x32x16_bf16 v[128:143], v[184:187], v[100:103], v[128:143]
  ds_read_b64_tr_b16 v[176:177], v254 offset:28672
  ds_read_b64_tr_b16 v[178:179], v254 offset:28928
  ds_read_b64_tr_b16 v[180:181], v254 offset:61440
  ds_read_b64_tr_b16 v[182:183], v254 offset:61696
  v_mfma_f32_32x32x16_bf16 v[144:159], v[100:103], v[188:191], v[144:159]
  s_waitcnt lgkmcnt(8)
  v_mfma_f32_32x32x16_bf16 v[128:143], v[192:195], v[104:107], v[128:143]
  ds_read_b64_tr_b16 v[184:185], v254 offset:29184
  ds_read_b64_tr_b16 v[186:187], v254 offset:29440
  ds_read_b64_tr_b16 v[188:189], v254 offset:61952
  ds_read_b64_tr_b16 v[190:191], v254 offset:62208
  v_mfma_f32_32x32x16_bf16 v[144:159], v[104:107], v[196:199], v[144:159]
  s_waitcnt lgkmcnt(8)
  v_mfma_f32_32x32x16_bf16 v[128:143], v[200:203], v[108:111], v[128:143]
  ds_read_b64_tr_b16 v[192:193], v254 offset:30720
  ds_read_b64_tr_b16 v[194:195], v254 offset:30976
  ds_read_b64_tr_b16 v[196:197], v254 offset:63488
  ds_read_b64_tr_b16 v[198:199], v254 offset:63744
  v_mfma_f32_32x32x16_bf16 v[144:159], v[108:111], v[204:207], v[144:159]
  s_waitcnt lgkmcnt(8)
  v_mfma_f32_32x32x16_bf16 v[128:143], v[176:179], v[112:115], v[128:143]
  ds_read_b64_tr_b16 v[200:201], v254 offset:31232
  ds_read_b64_tr_b16 v[202:203], v254 offset:31488
  ds_read_b64_tr_b16 v[204:205], v254 offset:64000
  ds_read_b64_tr_b16 v[206:207], v254 offset:64256
  v_mfma_f32_32x32x16_bf16 v[144:159], v[112:115], v[180:183], v[144:159]
  s_waitcnt lgkmcnt(8)
  v_mfma_f32_32x32x16_bf16 v[128:143], v[184:187], v[116:119], v[128:143]
  v_mfma_f32_32x32x16_bf16 v[144:159], v[116:119], v[188:191], v[144:159]
  s_waitcnt lgkmcnt(4)
  v_mfma_f32_32x32x16_bf16 v[128:143], v[192:195], v[120:123], v[128:143]
  v_mfma_f32_32x32x16_bf16 v[144:159], v[120:123], v[196:199], v[144:159]
  s_waitcnt lgkmcnt(0)
  v_mfma_f32_32x32x16_bf16 v[128:143], v[200:203], v[124:127], v[128:143]
  v_mfma_f32_32x32x16_bf16 v[144:159], v[124:127], v[204:207], v[144:159]
  s_nop 10
  v_cvt_pk_bf16_f32 v176, v128, v129
  v_cvt_pk_bf16_f32 v177, v130, v131
  v_cvt_pk_bf16_f32 v178, v132, v133
  v_cvt_pk_bf16_f32 v179, v134, v135
  v_cvt_pk_bf16_f32 v180, v136, v137
  v_cvt_pk_bf16_f32 v181, v138, v139
  v_cvt_pk_bf16_f32 v182, v140, v141
  v_cvt_pk_bf16_f32 v183, v142, v143
  v_mfma_f32_32x32x16_bf16 v[184:199], a[224:227], v[176:179], 0
  s_nop 0
  v_mfma_f32_32x32x16_bf16 v[184:199], a[228:231], v[180:183], v[184:199]
  s_barrier
  s_and_b32 s56, s42, 7
  s_lshl_b32 s56, s56, 7
  s_mul_i32 s57, s40, 8192
  s_add_u32 s56, s56, s57
  s_add_u32 s56, s56, 0
  s_lshl_b32 s57, s40, 10
  s_add_u32 s57, s57, 131072
  s_lshl_b32 s82, s2, 1
  s_and_b32 s83, s40, 1
  s_add_u32 s83, s83, s82
  s_min_u32 s82, s83, 447
  s_lshl_b32 s86, s40, 12
  s_add_u32 s86, s86, 98304
  s_cmp_ge_u32 s40, 2
  s_cbranch_scc1 L_pk1_1_w1
  s_and_b32 s84, s82, 7
  s_lshr_b32 s85, s82, 3
  s_lshl_b32 s74, s84, 7
  s_lshl_b32 s75, s85, 15
  s_add_u32 s74, s74, s75
  s_add_u32 m0, s86, 0
  s_add_u32 s76, s74, 0
  buffer_load_dwordx4 v247, s[24:27], s76 offen lds
  s_add_u32 m0, s86, 1024
  s_add_u32 s76, s74, 8192
  buffer_load_dwordx4 v247, s[24:27], s76 offen lds
  s_add_u32 m0, s86, 2048
  s_add_u32 s76, s74, 16384
  buffer_load_dwordx4 v247, s[24:27], s76 offen lds
  s_add_u32 m0, s86, 3072
  s_add_u32 s76, s74, 24576
  buffer_load_dwordx4 v247, s[24:27], s76 offen lds
  s_branch L_pk1_1
L_pk1_1_w1:
  s_lshr_b32 s84, s82, 4
  s_and_b32 s85, s82, 15
  s_lshl_b32 s74, s84, 7
  s_mul_i32 s75, s85, 114688
  s_add_u32 s74, s74, s75
  s_add_u32 m0, s86, 0
  s_add_u32 s76, s74, 0
  buffer_load_dwordx4 v246, s[20:23], s76 offen lds
  s_add_u32 m0, s86, 1024
  s_add_u32 s76, s74, 28672
  buffer_load_dwordx4 v246, s[20:23], s76 offen lds
  s_add_u32 m0, s86, 2048
  s_add_u32 s76, s74, 57344
  buffer_load_dwordx4 v246, s[20:23], s76 offen lds
  s_add_u32 m0, s86, 3072
  s_add_u32 s76, s74, 86016
  buffer_load_dwordx4 v246, s[20:23], s76 offen lds
L_pk1_1:
  s_lshl_b32 s74, s40, 7
  s_add_u32 s74, s74, 118784
  v_and_b32 v234, 31, v244
  v_lshlrev_b32 v234, 2, v234
  v_add_u32 v234, s74, v234
  ds_write_b32 v234, v233
  v_add_u32 v235, s74, v243
  ds_read_b128 v[128:131], v235 offset:0
  ds_read_b128 v[132:135], v235 offset:32
  ds_read_b128 v[136:139], v235 offset:64
  ds_read_b128 v[140:143], v235 offset:96
  v_max3_f32 v200, v184, v185, v186
  v_max3_f32 v201, -v184, -v185, -v186
  v_max3_f32 v200, v200, v187, v188
  v_max3_f32 v201, v201, -v187, -v188
  v_max3_f32 v200, v200, v189, v190
  s_lshl_b32 s87, s42, 2
  s_add_u32 s87, s87, s40
  s_mul_i32 s89, s41, 460800
  s_mul_i32 s88, s87, 7296
  s_add_u32 s89, s89, s88
  s_add_u32 s89, s89, 6815744
  v_lshlrev_b32 v226, 7, v244
  s_mov_b32 exec_hi, 0x03ffffff
  buffer_load_dword v245, v226, s[36:39], s89 offen sc1
  s_mul_i32 s89, s41, 133120
  s_mul_i32 s88, s87, 2176
  s_add_u32 s89, s89, s88
  s_add_u32 s89, s89, 4194304
  s_mov_b64 exec, 0x3ffff
  buffer_load_dword v245, v226, s[36:39], s89 offen sc1
  s_lshl_b32 s89, s41, 14
  s_lshl_b32 s88, s87, 8
  s_add_u32 s89, s89, s88
  s_add_u32 s89, s89, 65536
  s_mov_b64 exec, 3
  buffer_load_dword v245, v226, s[36:39], s89 offen sc1
  s_mov_b64 exec, -1
  v_max3_f32 v201, v201, -v189, -v190
  v_max_f32 v200, v200, v191
  v_max_f32 v201, v201, -v191
  v_max3_f32 v202, v192, v193, v194
  v_max3_f32 v203, -v192, -v193, -v194
  v_max3_f32 v202, v202, v195, v196
  v_max3_f32 v203, v203, -v195, -v196
  v_max3_f32 v202, v202, v197, v198
  v_max3_f32 v203, v203, -v197, -v198
  v_max_f32 v202, v202, v199
  v_max_f32 v203, v203, -v199
  v_permlane32_swap_b32 v200, v201
  s_nop 0
  v_permlane32_swap_b32 v202, v203
  v_max_f32 v200, v200, v201
  s_add_u32 s58, s92, 0
  s_and_b32 s58, s58, 7
  s_lshl_b32 s81, s58, 12
  s_add_u32 m0, s81, s57
  s_mul_i32 s58, s58, 32768
  s_add_u32 s58, s58, s56
  buffer_load_dwordx4 v247, s[16:19], s58 offen lds
  v_max_f32 v202, v202, v203
  v_mov_b32 v201, v200
  v_mov_b32 v203, v202
  s_nop 0
  v_permlane32_swap_b32 v200, v201
  v_permlane32_swap_b32 v202, v203
  v_pk_mul_f32 v[200:201], v[200:201], v[232:233] op_sel_hi:[1,0]
  v_pk_mul_f32 v[202:203], v[202:203], v[232:233] op_sel_hi:[1,0]
  v_mov_b32 v204, v201
  v_pk_fma_f32 v[208:209], v[184:185], v[232:233], v[204:205] op_sel_hi:[1,0,0] neg_lo:[1,0,1] neg_hi:[1,0,1]
  v_pk_fma_f32 v[184:185], v[184:185], v[232:233], v[200:201] op_sel_hi:[1,0,0] neg_lo:[0,0,1] neg_hi:[0,0,1]
  v_pk_fma_f32 v[210:211], v[186:187], v[232:233], v[204:205] op_sel_hi:[1,0,0] neg_lo:[1,0,1] neg_hi:[1,0,1]
  v_pk_fma_f32 v[186:187], v[186:187], v[232:233], v[200:201] op_sel_hi:[1,0,0] neg_lo:[0,0,1] neg_hi:[0,0,1]
  v_pk_fma_f32 v[212:213], v[188:189], v[232:233], v[204:205] op_sel_hi:[1,0,0] neg_lo:[1,0,1] neg_hi:[1,0,1]
  v_pk_fma_f32 v[188:189], v[188:189], v[232:233], v[200:201] op_sel_hi:[1,0,0] neg_lo:[0,0,1] neg_hi:[0,0,1]
  s_add_u32 s58, s92, 1
  s_and_b32 s58, s58, 7
  s_lshl_b32 s81, s58, 12
  s_add_u32 m0, s81, s57
  s_mul_i32 s58, s58, 32768
  s_add_u32 s58, s58, s56
  buffer_load_dwordx4 v247, s[16:19], s58 offen lds
  v_pk_fma_f32 v[214:215], v[190:191], v[232:233], v[204:205] op_sel_hi:[1,0,0] neg_lo:[1,0,1] neg_hi:[1,0,1]
  v_pk_fma_f32 v[190:191], v[190:191], v[232:233], v[200:201] op_sel_hi:[1,0,0] neg_lo:[0,0,1] neg_hi:[0,0,1]
  v_mov_b32 v206, v203
  v_pk_fma_f32 v[216:217], v[192:193], v[232:233], v[206:207] op_sel_hi:[1,0,0] neg_lo:[1,0,1] neg_hi:[1,0,1]
  v_pk_fma_f32 v[192:193], v[192:193], v[232:233], v[202:203] op_sel_hi:[1,0,0] neg_lo:[0,0,1] neg_hi:[0,0,1]
  v_pk_fma_f32 v[218:219], v[194:195], v[232:233], v[206:207] op_sel_hi:[1,0,0] neg_lo:[1,0,1] neg_hi:[1,0,1]
  v_pk_fma_f32 v[194:195], v[194:195], v[232:233], v[202:203] op_sel_hi:[1,0,0] neg_lo:[0,0,1] neg_hi:[0,0,1]
  v_pk_fma_f32 v[220:221], v[196:197], v[232:233], v[206:207] op_sel_hi:[1,0,0] neg_lo:[1,0,1] neg_hi:[1,0,1]
  v_pk_fma_f32 v[196:197], v[196:197], v[232:233], v[202:203] op_sel_hi:[1,0,0] neg_lo:[0,0,1] neg_hi:[0,0,1]
  v_pk_fma_f32 v[222:223], v[198:199], v[232:233], v[206:207] op_sel_hi:[1,0,0] neg_lo:[1,0,1] neg_hi:[1,0,1]
  v_pk_fma_f32 v[198:199], v[198:199], v[232:233], v[202:203] op_sel_hi:[1,0,0] neg_lo:[0,0,1] neg_hi:[0,0,1]
  v_exp_f32 v184, v184
  v_exp_f32 v208, v208
  v_exp_f32 v185, v185
  s_add_u32 s58, s92, 2
  s_and_b32 s58, s58, 7
  s_lshl_b32 s81, s58, 12
  s_add_u32 m0, s81, s57
  s_mul_i32 s58, s58, 32768
  s_add_u32 s58, s58, s56
  buffer_load_dwordx4 v247, s[16:19], s58 offen lds
  v_exp_f32 v209, v209
  v_exp_f32 v186, v186
  v_exp_f32 v210, v210
  v_exp_f32 v187, v187
  v_exp_f32 v211, v211
  v_exp_f32 v188, v188
  v_exp_f32 v212, v212
  v_exp_f32 v189, v189
  s_add_u32 s58, s92, 3
  s_and_b32 s58, s58, 7
  s_lshl_b32 s81, s58, 12
  s_add_u32 m0, s81, s57
  s_mul_i32 s58, s58, 32768
  s_add_u32 s58, s58, s56
  buffer_load_dwordx4 v247, s[16:19], s58 offen lds
  v_exp_f32 v213, v213
  v_exp_f32 v190, v190
  v_exp_f32 v214, v214
  v_exp_f32 v191, v191
  v_exp_f32 v215, v215
  v_exp_f32 v192, v192
  v_exp_f32 v216, v216
  v_exp_f32 v193, v193
  s_add_u32 s58, s92, 4
  s_and_b32 s58, s58, 7
  s_lshl_b32 s81, s58, 12
  s_add_u32 m0, s81, s57
  s_mul_i32 s58, s58, 32768
  s_add_u32 s58, s58, s56
  buffer_load_dwordx4 v247, s[16:19], s58 offen lds
  v_exp_f32 v217, v217
  v_exp_f32 v194, v194
  v_exp_f32 v218, v218
  v_exp_f32 v195, v195
  v_exp_f32 v219, v219
  v_exp_f32 v196, v196
  v_exp_f32 v220, v220
  v_exp_f32 v197, v197
  s_add_u32 s58, s92, 5
  s_and_b32 s58, s58, 7
  s_lshl_b32 s81, s58, 12
  s_add_u32 m0, s81, s57
  s_mul_i32 s58, s58, 32768
  s_add_u32 s58, s58, s56
  buffer_load_dwordx4 v247, s[16:19], s58 offen lds
  v_exp_f32 v221, v221
  v_exp_f32 v198, v198
  v_exp_f32 v222, v222
  v_exp_f32 v199, v199
  v_exp_f32 v223, v223
  v_pk_add_f32 v[200:201], v[184:185], v[186:187]
  v_pk_add_f32 v[204:205], v[208:209], v[210:211]
  v_pk_add_f32 v[200:201], v[200:201], v[188:189]
  v_pk_add_f32 v[204:205], v[204:205], v[212:213]
  v_pk_add_f32 v[200:201], v[200:201], v[190:191]
  v_pk_add_f32 v[204:205], v[204:205], v[214:215]
  s_add_u32 s58, s92, 6
  s_and_b32 s58, s58, 7
  s_lshl_b32 s81, s58, 12
  s_add_u32 m0, s81, s57
  s_mul_i32 s58, s58, 32768
  s_add_u32 s58, s58, s56
  buffer_load_dwordx4 v247, s[16:19], s58 offen lds
  v_add_f32 v200, v200, v201
  v_add_f32 v201, v204, v205
  v_pk_add_f32 v[202:203], v[192:193], v[194:195]
  v_pk_add_f32 v[206:207], v[216:217], v[218:219]
  v_pk_add_f32 v[202:203], v[202:203], v[196:197]
  v_pk_add_f32 v[206:207], v[206:207], v[220:221]
  v_pk_add_f32 v[202:203], v[202:203], v[198:199]
  v_pk_add_f32 v[206:207], v[206:207], v[222:223]
  v_add_f32 v202, v202, v203
  v_add_f32 v203, v206, v207
  v_permlane32_swap_b32 v200, v201
  s_nop 0
  v_permlane32_swap_b32 v202, v203
  v_add_f32 v200, v200, v201
  v_add_f32 v202, v202, v203
  s_add_u32 s58, s92, 7
  s_and_b32 s58, s58, 7
  s_lshl_b32 s81, s58, 12
  s_add_u32 m0, s81, s57
  s_mul_i32 s58, s58, 32768
  s_add_u32 s58, s58, s56
  buffer_load_dwordx4 v247, s[16:19], s58 offen lds
  v_rcp_f32 v200, v200
  v_rcp_f32 v202, v202
  v_mov_b32 v204, v200
  v_mov_b32 v206, v202
  s_nop 0
  v_permlane32_swap_b32 v200, v204
  v_permlane32_swap_b32 v202, v206
  v_pk_mul_f32 v[184:185], v[184:185], v[200:201] op_sel_hi:[1,0]
  v_pk_mul_f32 v[208:209], v[208:209], v[204:205] op_sel_hi:[1,0]
  v_pk_mul_f32 v[186:187], v[186:187], v[200:201] op_sel_hi:[1,0]
  v_pk_mul_f32 v[210:211], v[210:211], v[204:205] op_sel_hi:[1,0]
  v_pk_mul_f32 v[188:189], v[188:189], v[200:201] op_sel_hi:[1,0]
  v_pk_mul_f32 v[212:213], v[212:213], v[204:205] op_sel_hi:[1,0]
  v_pk_mul_f32 v[190:191], v[190:191], v[200:201] op_sel_hi:[1,0]
  v_pk_mul_f32 v[214:215], v[214:215], v[204:205] op_sel_hi:[1,0]
  v_cvt_pk_bf16_f32 v160, v184, v185
  v_cvt_pk_bf16_f32 v164, v208, v209
  v_cvt_pk_bf16_f32 v161, v186, v187
  v_cvt_pk_bf16_f32 v165, v210, v211
  v_cvt_pk_bf16_f32 v162, v188, v189
  v_cvt_pk_bf16_f32 v166, v212, v213
  v_cvt_pk_bf16_f32 v163, v190, v191
  v_cvt_pk_bf16_f32 v167, v214, v215
  v_pk_mul_f32 v[192:193], v[192:193], v[202:203] op_sel_hi:[1,0]
  v_pk_mul_f32 v[216:217], v[216:217], v[206:207] op_sel_hi:[1,0]
  v_pk_mul_f32 v[194:195], v[194:195], v[202:203] op_sel_hi:[1,0]
  v_pk_mul_f32 v[218:219], v[218:219], v[206:207] op_sel_hi:[1,0]
  v_pk_mul_f32 v[196:197], v[196:197], v[202:203] op_sel_hi:[1,0]
  v_pk_mul_f32 v[220:221], v[220:221], v[206:207] op_sel_hi:[1,0]
  v_pk_mul_f32 v[198:199], v[198:199], v[202:203] op_sel_hi:[1,0]
  v_pk_mul_f32 v[222:223], v[222:223], v[206:207] op_sel_hi:[1,0]
  v_cvt_pk_bf16_f32 v168, v192, v193
  v_cvt_pk_bf16_f32 v172, v216, v217
  v_cvt_pk_bf16_f32 v169, v194, v195
  v_cvt_pk_bf16_f32 v173, v218, v219
  v_cvt_pk_bf16_f32 v170, v196, v197
  v_cvt_pk_bf16_f32 v174, v220, v221
  v_cvt_pk_bf16_f32 v171, v198, v199
  v_cvt_pk_bf16_f32 v175, v222, v223
  s_waitcnt lgkmcnt(0)
  v_pk_mul_f32 v[144:145], v[144:145], v[128:129]
  v_pk_mul_f32 v[146:147], v[146:147], v[130:131]
  v_pk_mul_f32 v[148:149], v[148:149], v[132:133]
  v_pk_mul_f32 v[150:151], v[150:151], v[134:135]
  v_pk_mul_f32 v[152:153], v[152:153], v[136:137]
  v_pk_mul_f32 v[154:155], v[154:155], v[138:139]
  v_pk_mul_f32 v[156:157], v[156:157], v[140:141]
  v_pk_mul_f32 v[158:159], v[158:159], v[142:143]
  v_mfma_f32_32x32x16_bf16 v[128:143], v[160:163], a[232:235], 0
  v_mfma_f32_32x32x16_bf16 v[128:143], v[164:167], a[236:239], v[128:143]
  v_mfma_f32_32x32x16_bf16 v[184:199], v[168:171], a[232:235], 0
  v_mfma_f32_32x32x16_bf16 v[184:199], v[172:175], a[236:239], v[184:199]
  v_cvt_pk_bf16_f32 v176, v144, v145
  v_cvt_pk_bf16_f32 v177, v146, v147
  v_cvt_pk_bf16_f32 v178, v148, v149
  v_cvt_pk_bf16_f32 v179, v150, v151
  v_cvt_pk_bf16_f32 v180, v152, v153
  v_cvt_pk_bf16_f32 v181, v154, v155
  v_cvt_pk_bf16_f32 v182, v156, v157
  v_cvt_pk_bf16_f32 v183, v158, v159
  v_cndmask_b32 v200, v176, 0, s[50:51]
  v_cndmask_b32 v176, 0, v176, s[50:51]
  v_cndmask_b32 v201, v177, 0, s[50:51]
  v_cndmask_b32 v177, 0, v177, s[50:51]
  v_cndmask_b32 v202, v178, 0, s[50:51]
  v_cndmask_b32 v178, 0, v178, s[50:51]
  v_cndmask_b32 v203, v179, 0, s[50:51]
  v_cndmask_b32 v179, 0, v179, s[50:51]
  v_cndmask_b32 v204, v180, 0, s[50:51]
  v_cndmask_b32 v180, 0, v180, s[50:51]
  v_cndmask_b32 v205, v181, 0, s[50:51]
  v_cndmask_b32 v181, 0, v181, s[50:51]
  v_cndmask_b32 v206, v182, 0, s[50:51]
  v_cndmask_b32 v182, 0, v182, s[50:51]
  v_cndmask_b32 v207, v183, 0, s[50:51]
  v_cndmask_b32 v183, 0, v183, s[50:51]
  v_cvt_pk_bf16_f32 v144, v128, v129
  v_cvt_pk_bf16_f32 v145, v130, v131
  v_cvt_pk_bf16_f32 v146, v132, v133
  v_cvt_pk_bf16_f32 v147, v134, v135
  v_cvt_pk_bf16_f32 v148, v136, v137
  v_cvt_pk_bf16_f32 v149, v138, v139
  v_cvt_pk_bf16_f32 v150, v140, v141
  v_cvt_pk_bf16_f32 v151, v142, v143
  v_cvt_pk_bf16_f32 v152, v184, v185
  v_cvt_pk_bf16_f32 v153, v186, v187
  v_cvt_pk_bf16_f32 v154, v188, v189
  v_cvt_pk_bf16_f32 v155, v190, v191
  v_cvt_pk_bf16_f32 v156, v192, v193
  v_cvt_pk_bf16_f32 v157, v194, v195
  v_cvt_pk_bf16_f32 v158, v196, v197
  v_cvt_pk_bf16_f32 v159, v198, v199
  v_mfma_f32_32x32x16_bf16 v[160:175], v[144:147], v[176:179], 0
  v_mfma_f32_32x32x16_bf16 v[160:175], v[148:151], v[180:183], v[160:175]
  v_mfma_f32_32x32x16_bf16 v[160:175], v[152:155], v[200:203], v[160:175]
  v_mfma_f32_32x32x16_bf16 v[160:175], v[156:159], v[204:207], v[160:175]
  v_add_f32 v208, v128, v129
  v_add_f32 v210, v130, v131
  v_add_f32 v209, v184, v185
  v_add_f32 v211, v186, v187
  v_add_f32 v208, v208, v132
  v_add_f32 v210, v210, v133
  v_add_f32 v209, v209, v188
  v_add_f32 v211, v211, v189
  v_add_f32 v208, v208, v134
  v_add_f32 v210, v210, v135
  v_add_f32 v209, v209, v190
  v_add_f32 v211, v211, v191
  v_add_f32 v208, v208, v136
  v_add_f32 v210, v210, v137
  v_add_f32 v209, v209, v192
  v_add_f32 v211, v211, v193
  v_add_f32 v208, v208, v138
  v_add_f32 v210, v210, v139
  v_add_f32 v209, v209, v194
  v_add_f32 v211, v211, v195
  v_add_f32 v208, v208, v140
  v_add_f32 v210, v210, v141
  v_add_f32 v209, v209, v196
  v_add_f32 v211, v211, v197
  v_add_f32 v208, v208, v142
  v_add_f32 v210, v210, v143
  v_add_f32 v209, v209, v198
  v_add_f32 v211, v211, v199
  v_add_f32 v208, v208, v210
  v_add_f32 v209, v209, v211
  s_nop 1
  v_permlane32_swap_b32 v208, v209
  v_add_f32 v208, v208, v209
  s_waitcnt vmcnt(11)
  v_add_u32 v192, s86, v252
  v_add_u32 v193, s86, v251
  ds_read_b64_tr_b16 v[176:177], v192 offset:0
  ds_read_b64_tr_b16 v[178:179], v192 offset:512
  ds_read_b64_tr_b16 v[180:181], v192 offset:1024
  ds_read_b64_tr_b16 v[182:183], v192 offset:1536
  ds_read_b64_tr_b16 v[184:185], v193 offset:0
  ds_read_b64_tr_b16 v[186:187], v193 offset:512
  ds_read_b64_tr_b16 v[188:189], v193 offset:1024
  ds_read_b64_tr_b16 v[190:191], v193 offset:1536
  s_waitcnt lgkmcnt(0)
  s_lshl_b32 s74, s40, 12
  s_add_u32 s74, s74, 98304
  v_add_u32 v210, s74, v255
  s_lshl_b32 s74, s40, 8
  s_add_u32 s74, s74, 98304
  v_lshlrev_b32 v211, 2, v244
  v_add_u32 v212, s74, v211
  v_add_u32 v213, 98304, v211
  ds_write_b32 v212, v208 offset:16384
  ds_write_b128 v210, v[160:163] offset:0
  ds_write_b128 v210, v[164:167] offset:1024
  ds_write_b128 v210, v[168:171] offset:2048
  ds_write_b128 v210, v[172:175] offset:3072
  s_lshl_b32 s74, s40, 10
  s_add_u32 s74, s74, 98304
  v_add_u32 v210, s74, v255
  s_waitcnt lgkmcnt(0)
  s_barrier
  ds_read_b128 v[128:131], v210 offset:0
  ds_read_b128 v[132:135], v210 offset:4096
  ds_read_b128 v[136:139], v210 offset:8192
  ds_read_b128 v[140:143], v210 offset:12288
  ds_read_b32 v144, v213 offset:16384
  ds_read_b32 v145, v213 offset:16640
  ds_read_b32 v146, v213 offset:16896
  ds_read_b32 v147, v213 offset:17152
  s_lshl_b32 s74, s42, 4
  s_add_u32 s74, s74, s41
  s_lshl_b32 s75, s74, 11
  s_lshl_b32 s76, s40, 9
  s_add_u32 s75, s75, s76
  s_add_u32 s75, s75, 524288
  s_lshl_b32 s77, s74, 8
  s_add_u32 s77, s77, 2621440
  s_waitcnt lgkmcnt(0)
  v_pk_add_f32 v[128:129], v[128:129], v[132:133]
  v_pk_add_f32 v[130:131], v[130:131], v[134:135]
  v_pk_add_f32 v[136:137], v[136:137], v[140:141]
  v_pk_add_f32 v[138:139], v[138:139], v[142:143]
  v_pk_add_f32 v[144:145], v[144:145], v[146:147]
  v_pk_add_f32 v[128:129], v[128:129], v[136:137]
  v_pk_add_f32 v[130:131], v[130:131], v[138:139]
  v_add_f32 v144, v144, v145
  v_cvt_pk_bf16_f32 v132, v128, v129
  v_cvt_pk_bf16_f32 v133, v130, v131
  buffer_store_dwordx2 v[132:133], v248, s[36:39], s75 offen sc0 sc1
  s_cmp_eq_u32 s40, 0
  s_cbranch_scc0 L_noz0
  buffer_store_dword v144, v211, s[36:39], s77 offen sc0 sc1
L_noz0:
  v_mov_b32 v238, 0
  s_mov_b32 s80, 0
L_tag_2:
  buffer_load_dwordx2 v[236:237], v238, s[32:35], 0 offen sc0 sc1
  s_waitcnt vmcnt(0)
  v_readfirstlane_b32 s44, v236
  v_readfirstlane_b32 s45, v237
  s_add_u32 s80, s80, 1
  s_cmp_gt_u32 s80, 0x40000
  s_cbranch_scc1 L_tag_2_x
  s_cmp_eq_u32 s44, 0
  s_cbranch_scc1 L_tag_2
L_tag_2_x:
  s_lshl_b32 s75, s74, 2
  s_add_u32 s75, s75, s40
  s_lshl_b32 s75, s75, 3
  s_add_u32 s75, s75, 24576
  s_waitcnt vmcnt(0)
  s_or_b32 s70, s44, 1
  v_mov_b32 v236, s70
  v_mov_b32 v237, s45
  v_mov_b32 v238, 0
  s_mov_b64 exec, 1
  buffer_store_dwordx2 v[236:237], v238, s[36:39], s75 offen sc0 sc1
  s_mov_b64 exec, -1
  s_cmp_eq_u32 s40, 0
  s_cbranch_scc0 L_nohello
  s_getreg_b32 s74, hwreg(HW_REG_XCC_ID)
  s_and_b32 s74, s74, 7
  s_lshl_b32 s74, s74, 4
  s_or_b32 s74, s74, s44
  v_mov_b32 v236, s74
  v_mov_b32 v237, s45
  v_mov_b32 v238, 0
  s_lshl_b32 s75, s41, 4
  s_add_u32 s75, s75, s42
  s_lshl_b32 s75, s75, 3
  s_add_u32 s75, s75, 16384
  s_mov_b64 exec, 1
  buffer_store_dwordx2 v[236:237], v238, s[36:39], s75 offen sc0 sc1
  s_mov_b64 exec, -1
L_nohello:
  s_cmp_ge_u32 s83, 448
  s_cbranch_scc1 L_pk2_3
  s_cmp_ge_u32 s40, 2
  s_cbranch_scc1 L_pk2_3_w1
  s_mul_i32 s74, s84, 224
  s_lshl_b32 s75, s85, 1
  s_add_u32 s74, s74, s75
  s_lshl_b32 s74, s74, 10
  s_add_u32 s74, s74, 14680064
  s_add_u32 s76, s74, 0
  buffer_store_dwordx4 v[176:179], v255, s[36:39], s76 offen sc0 sc1
  s_add_u32 s76, s74, 1024
  buffer_store_dwordx4 v[180:183], v255, s[36:39], s76 offen sc0 sc1
  s_add_u32 s76, s74, 114688
  buffer_store_dwordx4 v[184:187], v255, s[36:39], s76 offen sc0 sc1
  s_add_u32 s76, s74, 115712
  buffer_store_dwordx4 v[188:191], v255, s[36:39], s76 offen sc0 sc1
  s_branch L_pk2_3
L_pk2_3_w1:
  v_mov_b32 v160, 0x3f803f80
  v_mov_b32 v161, 0x3f803f80
  v_mov_b32 v162, 0x3f803f80
  v_mov_b32 v163, 0x3f803f80
  s_nop 1
  v_mfma_f32_32x32x16_bf16 v[128:143], v[160:163], v[176:179], 0
  v_mfma_f32_32x32x16_bf16 v[128:143], v[160:163], v[180:183], v[128:143]
  v_mfma_f32_32x32x16_bf16 v[144:159], v[160:163], v[184:187], 0
  v_mfma_f32_32x32x16_bf16 v[144:159], v[160:163], v[188:191], v[144:159]
  v_and_b32 v160, 31, v244
  v_lshlrev_b32 v160, 6, v160
  s_lshl_b32 s74, s84, 12
  s_lshl_b32 s75, s85, 2
  s_add_u32 s74, s74, s75
  s_add_u32 s74, s74, 327680
  s_nop 15
  s_mov_b64 exec, 0xffffffff
  buffer_store_dword v128, v160, s[36:39], s74 offen sc0 sc1
  buffer_store_dword v144, v160, s[36:39], s74 offen offset:2048 sc0 sc1
  s_mov_b64 exec, -1
L_pk2_3:
  s_waitcnt lgkmcnt(0)
  s_barrier
  s_and_b32 s56, s42, 7
  s_lshl_b32 s56, s56, 7
  s_mul_i32 s57, s40, 8192
  s_add_u32 s56, s56, s57
  s_add_u32 s56, s56, 262144
  s_lshl_b32 s57, s40, 10
  s_add_u32 s57, s57, 98304
  ds_read_b64_tr_b16 v[176:177], v253 offset:0
  ds_read_b64_tr_b16 v[178:179], v253 offset:256
  ds_read_b64_tr_b16 v[180:181], v253 offset:512
  ds_read_b64_tr_b16 v[182:183], v253 offset:768
  ds_read_b64_tr_b16 v[184:185], v253 offset:2048
  ds_read_b64_tr_b16 v[186:187], v253 offset:2304
  s_waitcnt lgkmcnt(4)
  v_mfma_f32_32x32x16_bf16 v[160:175], v[176:179], v[0:3], 0
  ds_read_b64_tr_b16 v[188:189], v253 offset:2560
  ds_read_b64_tr_b16 v[190:191], v253 offset:2816
  s_add_u32 s58, s92, 0
  s_and_b32 s58, s58, 7
  s_lshl_b32 s81, s58, 12
  s_add_u32 m0, s81, s57
  s_mul_i32 s58, s58, 32768
  s_add_u32 s58, s58, s56
  buffer_load_dwordx4 v247, s[16:19], s58 offen lds
  s_waitcnt lgkmcnt(4)
  v_mfma_f32_32x32x16_bf16 v[160:175], v[180:183], v[4:7], v[160:175]
  ds_read_b64_tr_b16 v[176:177], v253 offset:4096
  ds_read_b64_tr_b16 v[178:179], v253 offset:4352
  s_waitcnt lgkmcnt(4)
  v_mfma_f32_32x32x16_bf16 v[160:175], v[184:187], v[8:11], v[160:175]
  s_add_u32 s58, s92, 1
  s_and_b32 s58, s58, 7
  s_lshl_b32 s81, s58, 12
  s_add_u32 m0, s81, s57
  s_mul_i32 s58, s58, 32768
  s_add_u32 s58, s58, s56
  buffer_load_dwordx4 v247, s[16:19], s58 offen lds
  ds_read_b64_tr_b16 v[180:181], v253 offset:4608
  ds_read_b64_tr_b16 v[182:183], v253 offset:4864
  s_waitcnt lgkmcnt(4)
  v_mfma_f32_32x32x16_bf16 v[160:175], v[188:191], v[12:15], v[160:175]
  ds_read_b64_tr_b16 v[184:185], v253 offset:6144
  ds_read_b64_tr_b16 v[186:187], v253 offset:6400
  s_waitcnt lgkmcnt(4)
  v_mfma_f32_32x32x16_bf16 v[160:175], v[176:179], v[16:19], v[160:175]
  s_add_u32 s58, s92, 2
  s_and_b32 s58, s58, 7
  s_lshl_b32 s81, s58, 12
  s_add_u32 m0, s81, s57
  s_mul_i32 s58, s58, 32768
  s_add_u32 s58, s58, s56
  buffer_load_dwordx4 v247, s[16:19], s58 offen lds
  ds_read_b64_tr_b16 v[188:189], v253 offset:6656
  ds_read_b64_tr_b16 v[190:191], v253 offset:6912
  s_waitcnt lgkmcnt(4)
  v_mfma_f32_32x32x16_bf16 v[160:175], v[180:183], v[20:23], v[160:175]
  ds_read_b64_tr_b16 v[176:177], v253 offset:8192
  ds_read_b64_tr_b16 v[178:179], v253 offset:8448
  s_waitcnt lgkmcnt(4)
  v_mfma_f32_32x32x16_bf16 v[160:175], v[184:187], v[24:27], v[160:175]
  s_add_u32 s58, s92, 3
  s_and_b32 s58, s58, 7
  s_lshl_b32 s81, s58, 12
  s_add_u32 m0, s81, s57
  s_mul_i32 s58, s58, 32768
  s_add_u32 s58, s58, s56
  buffer_load_dwordx4 v247, s[16:19], s58 offen lds
  ds_read_b64_tr_b16 v[180:181], v253 offset:8704
  ds_read_b64_tr_b16 v[182:183], v253 offset:8960
  s_waitcnt lgkmcnt(4)
  v_mfma_f32_32x32x16_bf16 v[160:175], v[188:191], v[28:31], v[160:175]
  ds_read_b64_tr_b16 v[184:185], v253 offset:10240
  ds_read_b64_tr_b16 v[186:187], v253 offset:10496
  s_waitcnt lgkmcnt(4)
  v_mfma_f32_32x32x16_bf16 v[160:175], v[176:179], v[32:35], v[160:175]
  s_add_u32 s58, s92, 4
  s_and_b32 s58, s58, 7
  s_lshl_b32 s81, s58, 12
  s_add_u32 m0, s81, s57
  s_mul_i32 s58, s58, 32768
  s_add_u32 s58, s58, s56
  buffer_load_dwordx4 v247, s[16:19], s58 offen lds
  ds_read_b64_tr_b16 v[188:189], v253 offset:10752
  ds_read_b64_tr_b16 v[190:191], v253 offset:11008
  v_mfma_f32_32x32x16_bf16 v[160:175], a[244:247], v[228:231], v[160:175]
  s_waitcnt lgkmcnt(4)
  v_mfma_f32_32x32x16_bf16 v[160:175], v[180:183], v[36:39], v[160:175]
  s_add_u32 s58, s92, 5
  s_and_b32 s58, s58, 7
  s_lshl_b32 s81, s58, 12
  s_add_u32 m0, s81, s57
  s_mul_i32 s58, s58, 32768
  s_add_u32 s58, s58, s56
  buffer_load_dwordx4 v247, s[16:19], s58 offen lds
  ds_read_b64_tr_b16 v[176:177], v253 offset:12288
  ds_read_b64_tr_b16 v[178:179], v253 offset:12544
  s_waitcnt lgkmcnt(4)
  v_mfma_f32_32x32x16_bf16 v[160:175], v[184:187], v[40:43], v[160:175]
  ds_read_b64_tr_b16 v[180:181], v253 offset:12800
  ds_read_b64_tr_b16 v[182:183], v253 offset:13056
  s_waitcnt lgkmcnt(4)
  v_mfma_f32_32x32x16_bf16 v[160:175], v[188:191], v[44:47], v[160:175]
  s_add_u32 s58, s92, 6
  s_and_b32 s58, s58, 7
  s_lshl_b32 s81, s58, 12
  s_add_u32 m0, s81, s57
  s_mul_i32 s58, s58, 32768
  s_add_u32 s58, s58, s56
  buffer_load_dwordx4 v247, s[16:19], s58 offen lds
  ds_read_b64_tr_b16 v[184:185], v253 offset:14336
  ds_read_b64_tr_b16 v[186:187], v253 offset:14592
  s_waitcnt lgkmcnt(4)
  v_mfma_f32_32x32x16_bf16 v[160:175], v[176:179], v[48:51], v[160:175]
  ds_read_b64_tr_b16 v[188:189], v253 offset:14848
  ds_read_b64_tr_b16 v[190:191], v253 offset:15104
  s_waitcnt lgkmcnt(4)
  v_mfma_f32_32x32x16_bf16 v[160:175], v[180:183], v[52:55], v[160:175]
  s_add_u32 s58, s92, 7
  s_and_b32 s58, s58, 7
  s_lshl_b32 s81, s58, 12
  s_add_u32 m0, s81, s57
  s_mul_i32 s58, s58, 32768
  s_add_u32 s58, s58, s56
  buffer_load_dwordx4 v247, s[16:19], s58 offen lds
  ds_read_b64_tr_b16 v[176:177], v253 offset:16384
  ds_read_b64_tr_b16 v[178:179], v253 offset:16640
  s_waitcnt lgkmcnt(4)
  v_mfma_f32_32x32x16_bf16 v[160:175], v[184:187], v[56:59], v[160:175]
  ds_read_b64_tr_b16 v[180:181], v253 offset:16896
  ds_read_b64_tr_b16 v[182:183], v253 offset:17152
  s_waitcnt lgkmcnt(4)
  v_mfma_f32_32x32x16_bf16 v[160:175], v[188:191], v[60:63], v[160:175]
  ds_read_b64_tr_b16 v[184:185], v253 offset:18432
  ds_read_b64_tr_b16 v[186:187], v253 offset:18688
  s_waitcnt lgkmcnt(4)
  v_mfma_f32_32x32x16_bf16 v[160:175], v[176:179], v[64:67], v[160:175]
  ds_read_b64_tr_b16 v[188:189], v253 offset:18944
  ds_read_b64_tr_b16 v[190:191], v253 offset:19200
  s_waitcnt lgkmcnt(4)
  v_mfma_f32_32x32x16_bf16 v[160:175], v[180:183], v[68:71], v[160:175]
  ds_read_b64_tr_b16 v[176:177], v253 offset:20480
  ds_read_b64_tr_b16 v[178:179], v253 offset:20736
  s_waitcnt lgkmcnt(4)
  v_mfma_f32_32x32x16_bf16 v[160:175], v[184:187], v[72:75], v[160:175]
  ds_read_b64_tr_b16 v[180:181], v253 offset:20992
  ds_read_b64_tr_b16 v[182:183], v253 offset:21248
  s_waitcnt lgkmcnt(4)
  v_mfma_f32_32x32x16_bf16 v[160:175], v[188:191], v[76:79], v[160:175]
  ds_read_b64_tr_b16 v[184:185], v253 offset:22528
  ds_read_b64_tr_b16 v[186:187], v253 offset:22784
  s_waitcnt lgkmcnt(4)
  v_mfma_f32_32x32x16_bf16 v[160:175], v[176:179], v[80:83], v[160:175]
  ds_read_b64_tr_b16 v[188:189], v253 offset:23040
  ds_read_b64_tr_b16 v[190:191], v253 offset:23296
  s_waitcnt lgkmcnt(4)
  v_mfma_f32_32x32x16_bf16 v[160:175], v[180:183], v[84:87], v[160:175]
  ds_read_b64_tr_b16 v[176:177], v253 offset:24576
  ds_read_b64_tr_b16 v[178:179], v253 offset:24832
  s_waitcnt lgkmcnt(4)
  v_mfma_f32_32x32x16_bf16 v[160:175], v[184:187], v[88:91], v[160:175]
  ds_read_b64_tr_b16 v[180:181], v253 offset:25088
  ds_read_b64_tr_b16 v[182:183], v253 offset:25344
  s_waitcnt lgkmcnt(4)
  v_mfma_f32_32x32x16_bf16 v[160:175], v[188:191], v[92:95], v[160:175]
  ds_read_b64_tr_b16 v[184:185], v253 offset:26624
  ds_read_b64_tr_b16 v[186:187], v253 offset:26880
  s_waitcnt lgkmcnt(4)
  v_mfma_f32_32x32x16_bf16 v[160:175], v[176:179], v[96:99], v[160:175]
  ds_read_b64_tr_b16 v[188:189], v253 offset:27136
  ds_read_b64_tr_b16 v[190:191], v253 offset:27392
  s_waitcnt lgkmcnt(4)
  v_mfma_f32_32x32x16_bf16 v[160:175], v[180:183], v[100:103], v[160:175]
  ds_read_b64_tr_b16 v[176:177], v253 offset:28672
  ds_read_b64_tr_b16 v[178:179], v253 offset:28928
  s_waitcnt lgkmcnt(4)
  v_mfma_f32_32x32x16_bf16 v[160:175], v[184:187], v[104:107], v[160:175]
  ds_read_b64_tr_b16 v[180:181], v253 offset:29184
  ds_read_b64_tr_b16 v[182:183], v253 offset:29440
  s_waitcnt lgkmcnt(4)
  v_mfma_f32_32x32x16_bf16 v[160:175], v[188:191], v[108:111], v[160:175]
  ds_read_b64_tr_b16 v[184:185], v253 offset:30720
  ds_read_b64_tr_b16 v[186:187], v253 offset:30976
  s_waitcnt lgkmcnt(4)
  v_mfma_f32_32x32x16_bf16 v[160:175], v[176:179], v[112:115], v[160:175]
  ds_read_b64_tr_b16 v[188:189], v253 offset:31232
  ds_read_b64_tr_b16 v[190:191], v253 offset:31488
  s_waitcnt lgkmcnt(4)
  v_mfma_f32_32x32x16_bf16 v[160:175], v[180:183], v[116:119], v[160:175]
  s_waitcnt lgkmcnt(2)
  v_mfma_f32_32x32x16_bf16 v[160:175], v[184:187], v[120:123], v[160:175]
  s_waitcnt lgkmcnt(0)
  v_mfma_f32_32x32x16_bf16 v[160:175], v[188:191], v[124:127], v[160:175]
  s_lshl_b32 s71, s42, 9
  s_add_u32 s71, s71, 24576
  s_lshl_b32 s62, 0x11111111, s40
  s_or_b32 s70, s44, 1
  s_mov_b32 s68, s62
  s_mov_b32 s69, s62
  s_mov_b32 s80, 0
L_poll_4:
  buffer_load_dwordx2 v[236:237], v248, s[36:39], s71 offen sc1
  s_add_u32 s80, s80, 1
  s_cmp_gt_u32 s80, 0x40000
  s_cbranch_scc1 L_poll_4_x
  s_waitcnt vmcnt(0)
  v_subrev_u32 v236, s70, v236
  v_cmp_ge_u32 vcc, 14, v236
  v_cmp_eq_u32 s[66:67], s45, v237
  s_and_b64 vcc, vcc, s[66:67]
  s_andn2_b64 s[66:67], s[68:69], vcc
  s_cbranch_scc1 L_poll_4
L_poll_4_x:
  s_waitcnt vmcnt(0)
  s_cmp_ge_u32 s83, 448
  s_cbranch_scc1 L_pk3_5
  s_lshl_b32 s75, s84, 6
  s_add_u32 s75, s75, s85
  s_lshl_b32 s75, s75, 3
  s_add_u32 s75, s75, 32768
  s_lshl_b32 s76, s83, 3
  s_add_u32 s76, s76, 40960
  s_cmp_ge_u32 s40, 2
  s_cselect_b32 s75, s76, s75
  s_or_b32 s70, s44, 1
  v_mov_b32 v236, s70
  v_mov_b32 v237, s45
  v_mov_b32 v238, 0
  s_mov_b64 exec, 1
  buffer_store_dwordx2 v[236:237], v238, s[36:39], s75 offen sc0 sc1
  s_mov_b64 exec, -1
L_pk3_5:
  s_lshl_b32 s71, s41, 7
  s_add_u32 s71, s71, 16384
  s_mov_b32 s80, 0
L_hello_6:
  buffer_load_dwordx2 v[236:237], v248, s[36:39], s71 offen sc1
  s_add_u32 s80, s80, 1
  s_cmp_gt_u32 s80, 0x40000
  s_cbranch_scc1 L_hello_6_x
  s_waitcnt vmcnt(0)
  v_and_b32 v238, 0xffffff8f, v236
  v_cmp_eq_u32 vcc, s44, v238
  v_cmp_eq_u32 s[66:67], s45, v237
  s_and_b64 vcc, vcc, s[66:67]
  s_mov_b64 s[68:69], 0xffff
  s_andn2_b64 s[66:67], s[68:69], vcc
  s_cbranch_scc1 L_hello_6
L_hello_6_x:
  s_waitcnt vmcnt(0)
  v_readfirstlane_b32 s66, v236
  s_nop 1
  v_cmp_ne_u32 vcc, s66, v236
  s_and_b32 s66, vcc_lo, 0xffff
  s_cmp_eq_u32 s66, 0
  s_cselect_b32 s46, 1, 0
  s_lshl_b32 s60, s42, 15
  s_lshl_b32 s75, s40, 9
  s_add_u32 s60, s60, s75
  s_add_u32 s60, s60, 524288
  v_lshlrev_b32 v224, 2, v244
  s_cmp_eq_u32 s40, 0
  s_cbranch_scc0 L_z_7
  s_lshl_b32 s75, s42, 12
  s_add_u32 s75, s75, 2621440
  buffer_load_dword v208, v224, s[36:39], s75 offen offset:0 sc1
  buffer_load_dword v209, v224, s[36:39], s75 offen offset:256 sc1
  buffer_load_dword v210, v224, s[36:39], s75 offen offset:512 sc1
  buffer_load_dword v211, v224, s[36:39], s75 offen offset:768 sc1
  buffer_load_dword v212, v224, s[36:39], s75 offen offset:1024 sc1
  buffer_load_dword v213, v224, s[36:39], s75 offen offset:1280 sc1
  buffer_load_dword v214, v224, s[36:39], s75 offen offset:1536 sc1
  buffer_load_dword v215, v224, s[36:39], s75 offen offset:1792 sc1
  buffer_load_dword v216, v224, s[36:39], s75 offen offset:2048 sc1
  buffer_load_dword v217, v224, s[36:39], s75 offen offset:2304 sc1
  buffer_load_dword v218, v224, s[36:39], s75 offen offset:2560 sc1
  buffer_load_dword v219, v224, s[36:39], s75 offen offset:2816 sc1
  buffer_load_dword v220, v224, s[36:39], s75 offen offset:3072 sc1
  buffer_load_dword v221, v224, s[36:39], s75 offen offset:3328 sc1
  buffer_load_dword v222, v224, s[36:39], s75 offen offset:3584 sc1
  buffer_load_dword v223, v224, s[36:39], s75 offen offset:3840 sc1
L_z_7:
  s_lshl_b32 s75, s93, 12
  s_add_u32 s61, s60, s75
  s_xor_b32 s75, s75, 16384
  s_add_u32 s60, s60, s75
  s_barrier
  v_cvt_pk_bf16_f32 v0, v160, v161
  v_cvt_pk_bf16_f32 v1, v162, v163
  v_cvt_pk_bf16_f32 v2, v164, v165
  v_cvt_pk_bf16_f32 v3, v166, v167
  buffer_load_dwordx2 v[176:177], v248, s[36:39], s61 offen offset:0 sc1
  v_cvt_pk_bf16_f32 v4, v168, v169
  v_cvt_pk_bf16_f32 v5, v170, v171
  v_cvt_pk_bf16_f32 v6, v172, v173
  v_cvt_pk_bf16_f32 v7, v174, v175
  buffer_load_dwordx2 v[178:179], v248, s[36:39], s61 offen offset:2048 sc1
  v_mfma_f32_32x32x16_bf16 v[8:23], a[224:227], v[0:3], 0
  s_add_u32 s61, s61, 4096
  buffer_load_dwordx2 v[180:181], v248, s[36:39], s61 offen offset:0 sc1
  v_mfma_f32_32x32x16_bf16 v[8:23], a[228:231], v[4:7], v[8:23]
  buffer_load_dwordx2 v[182:183], v248, s[36:39], s61 offen offset:2048 sc1
  s_nop 10
  v_max3_f32 v24, v8, v9, v10
  v_max3_f32 v25, -v8, -v9, -v10
  v_max3_f32 v24, v24, v11, v12
  v_max3_f32 v25, v25, -v11, -v12
  s_add_u32 s61, s61, 4096
  buffer_load_dwordx2 v[184:185], v248, s[36:39], s61 offen offset:0 sc1
  v_max3_f32 v24, v24, v13, v14
  v_max3_f32 v25, v25, -v13, -v14
  v_max_f32 v24, v24, v15
  v_max_f32 v25, v25, -v15
  buffer_load_dwordx2 v[186:187], v248, s[36:39], s61 offen offset:2048 sc1
  v_max3_f32 v26, v16, v17, v18
  v_max3_f32 v27, -v16, -v17, -v18
  v_max3_f32 v26, v26, v19, v20
  v_max3_f32 v27, v27, -v19, -v20
  s_add_u32 s61, s61, 4096
  buffer_load_dwordx2 v[188:189], v248, s[36:39], s61 offen offset:0 sc1
  v_max3_f32 v26, v26, v21, v22
  v_max3_f32 v27, v27, -v21, -v22
  v_max_f32 v26, v26, v23
  v_max_f32 v27, v27, -v23
  buffer_load_dwordx2 v[190:191], v248, s[36:39], s61 offen offset:2048 sc1
  v_permlane32_swap_b32 v24, v25
  v_permlane32_swap_b32 v26, v27
  buffer_load_dwordx2 v[192:193], v248, s[36:39], s60 offen offset:0 sc1
  v_max_f32 v24, v24, v25
  v_max_f32 v26, v26, v27
  v_mov_b32 v25, v24
  v_mov_b32 v27, v26
  buffer_load_dwordx2 v[194:195], v248, s[36:39], s60 offen offset:2048 sc1
  v_permlane32_swap_b32 v24, v25
  v_permlane32_swap_b32 v26, v27
  s_add_u32 s60, s60, 4096
  buffer_load_dwordx2 v[196:197], v248, s[36:39], s60 offen offset:0 sc1
  v_pk_mul_f32 v[24:25], v[24:25], v[232:233] op_sel_hi:[1,0]
  v_pk_mul_f32 v[26:27], v[26:27], v[232:233] op_sel_hi:[1,0]
  v_mov_b32 v28, v25
  v_pk_fma_f32 v[32:33], v[8:9], v[232:233], v[28:29] op_sel_hi:[1,0,0] neg_lo:[1,0,1] neg_hi:[1,0,1]
  buffer_load_dwordx2 v[198:199], v248, s[36:39], s60 offen offset:2048 sc1
  v_pk_fma_f32 v[8:9], v[8:9], v[232:233], v[24:25] op_sel_hi:[1,0,0] neg_lo:[0,0,1] neg_hi:[0,0,1]
  v_pk_fma_f32 v[34:35], v[10:11], v[232:233], v[28:29] op_sel_hi:[1,0,0] neg_lo:[1,0,1] neg_hi:[1,0,1]
  v_pk_fma_f32 v[10:11], v[10:11], v[232:233], v[24:25] op_sel_hi:[1,0,0] neg_lo:[0,0,1] neg_hi:[0,0,1]
  v_pk_fma_f32 v[36:37], v[12:13], v[232:233], v[28:29] op_sel_hi:[1,0,0] neg_lo:[1,0,1] neg_hi:[1,0,1]
  s_add_u32 s60, s60, 4096
  buffer_load_dwordx2 v[200:201], v248, s[36:39], s60 offen offset:0 sc1
  v_pk_fma_f32 v[12:13], v[12:13], v[232:233], v[24:25] op_sel_hi:[1,0,0] neg_lo:[0,0,1] neg_hi:[0,0,1]
  v_pk_fma_f32 v[38:39], v[14:15], v[232:233], v[28:29] op_sel_hi:[1,0,0] neg_lo:[1,0,1] neg_hi:[1,0,1]
  v_pk_fma_f32 v[14:15], v[14:15], v[232:233], v[24:25] op_sel_hi:[1,0,0] neg_lo:[0,0,1] neg_hi:[0,0,1]
  v_mov_b32 v30, v27
  buffer_load_dwordx2 v[202:203], v248, s[36:39], s60 offen offset:2048 sc1
  v_pk_fma_f32 v[40:41], v[16:17], v[232:233], v[30:31] op_sel_hi:[1,0,0] neg_lo:[1,0,1] neg_hi:[1,0,1]
  v_pk_fma_f32 v[16:17], v[16:17], v[232:233], v[26:27] op_sel_hi:[1,0,0] neg_lo:[0,0,1] neg_hi:[0,0,1]
  v_pk_fma_f32 v[42:43], v[18:19], v[232:233], v[30:31] op_sel_hi:[1,0,0] neg_lo:[1,0,1] neg_hi:[1,0,1]
  v_pk_fma_f32 v[18:19], v[18:19], v[232:233], v[26:27] op_sel_hi:[1,0,0] neg_lo:[0,0,1] neg_hi:[0,0,1]
  s_add_u32 s60, s60, 4096
  buffer_load_dwordx2 v[204:205], v248, s[36:39], s60 offen offset:0 sc1
  v_pk_fma_f32 v[44:45], v[20:21], v[232:233], v[30:31] op_sel_hi:[1,0,0] neg_lo:[1,0,1] neg_hi:[1,0,1]
  v_pk_fma_f32 v[20:21], v[20:21], v[232:233], v[26:27] op_sel_hi:[1,0,0] neg_lo:[0,0,1] neg_hi:[0,0,1]
  v_pk_fma_f32 v[46:47], v[22:23], v[232:233], v[30:31] op_sel_hi:[1,0,0] neg_lo:[1,0,1] neg_hi:[1,0,1]
  v_pk_fma_f32 v[22:23], v[22:23], v[232:233], v[26:27] op_sel_hi:[1,0,0] neg_lo:[0,0,1] neg_hi:[0,0,1]
  buffer_load_dwordx2 v[206:207], v248, s[36:39], s60 offen offset:2048 sc1
  v_exp_f32 v8, v8
  v_exp_f32 v32, v32
  v_exp_f32 v9, v9
  v_exp_f32 v33, v33
  v_exp_f32 v10, v10
  v_exp_f32 v34, v34
  v_exp_f32 v11, v11
  v_exp_f32 v35, v35
  v_exp_f32 v12, v12
  v_exp_f32 v36, v36
  v_exp_f32 v13, v13
  v_exp_f32 v37, v37
  v_exp_f32 v14, v14
  v_exp_f32 v38, v38
  v_exp_f32 v15, v15
  v_exp_f32 v39, v39
  v_exp_f32 v16, v16
  v_exp_f32 v40, v40
  v_exp_f32 v17, v17
  v_exp_f32 v41, v41
  v_exp_f32 v18, v18
  v_exp_f32 v42, v42
  v_exp_f32 v19, v19
  v_exp_f32 v43, v43
  v_exp_f32 v20, v20
  v_exp_f32 v44, v44
  v_exp_f32 v21, v21
  v_exp_f32 v45, v45
  v_exp_f32 v22, v22
  v_exp_f32 v46, v46
  v_exp_f32 v23, v23
  v_exp_f32 v47, v47
  v_pk_add_f32 v[24:25], v[8:9], v[10:11]
  v_pk_add_f32 v[28:29], v[32:33], v[34:35]
  v_pk_add_f32 v[24:25], v[24:25], v[12:13]
  v_pk_add_f32 v[28:29], v[28:29], v[36:37]
  v_pk_add_f32 v[24:25], v[24:25], v[14:15]
  v_pk_add_f32 v[28:29], v[28:29], v[38:39]
  v_add_f32 v24, v24, v25
  v_add_f32 v25, v28, v29
  v_pk_add_f32 v[26:27], v[16:17], v[18:19]
  v_pk_add_f32 v[30:31], v[40:41], v[42:43]
  v_pk_add_f32 v[26:27], v[26:27], v[20:21]
  v_pk_add_f32 v[30:31], v[30:31], v[44:45]
  v_pk_add_f32 v[26:27], v[26:27], v[22:23]
  v_pk_add_f32 v[30:31], v[30:31], v[46:47]
  v_add_f32 v26, v26, v27
  v_add_f32 v27, v30, v31
  v_permlane32_swap_b32 v24, v25
  s_nop 0
  v_permlane32_swap_b32 v26, v27
  v_add_f32 v24, v24, v25
  v_add_f32 v26, v26, v27
  v_rcp_f32 v24, v24
  v_rcp_f32 v26, v26
  v_mov_b32 v28, v24
  v_mov_b32 v30, v26
  s_nop 0
  v_permlane32_swap_b32 v24, v28
  v_permlane32_swap_b32 v26, v30
  v_pk_mul_f32 v[8:9], v[8:9], v[24:25] op_sel_hi:[1,0]
  v_pk_mul_f32 v[32:33], v[32:33], v[28:29] op_sel_hi:[1,0]
  v_pk_mul_f32 v[10:11], v[10:11], v[24:25] op_sel_hi:[1,0]
  v_pk_mul_f32 v[34:35], v[34:35], v[28:29] op_sel_hi:[1,0]
  v_pk_mul_f32 v[12:13], v[12:13], v[24:25] op_sel_hi:[1,0]
  v_pk_mul_f32 v[36:37], v[36:37], v[28:29] op_sel_hi:[1,0]
  v_pk_mul_f32 v[14:15], v[14:15], v[24:25] op_sel_hi:[1,0]
  v_pk_mul_f32 v[38:39], v[38:39], v[28:29] op_sel_hi:[1,0]
  v_cvt_pk_bf16_f32 v128, v8, v9
  v_cvt_pk_bf16_f32 v132, v32, v33
  v_cvt_pk_bf16_f32 v129, v10, v11
  v_cvt_pk_bf16_f32 v133, v34, v35
  v_cvt_pk_bf16_f32 v130, v12, v13
  v_cvt_pk_bf16_f32 v134, v36, v37
  v_cvt_pk_bf16_f32 v131, v14, v15
  v_cvt_pk_bf16_f32 v135, v38, v39
  v_pk_mul_f32 v[16:17], v[16:17], v[26:27] op_sel_hi:[1,0]
  v_pk_mul_f32 v[40:41], v[40:41], v[30:31] op_sel_hi:[1,0]
  v_pk_mul_f32 v[18:19], v[18:19], v[26:27] op_sel_hi:[1,0]
  v_pk_mul_f32 v[42:43], v[42:43], v[30:31] op_sel_hi:[1,0]
  v_pk_mul_f32 v[20:21], v[20:21], v[26:27] op_sel_hi:[1,0]
  v_pk_mul_f32 v[44:45], v[44:45], v[30:31] op_sel_hi:[1,0]
  v_pk_mul_f32 v[22:23], v[22:23], v[26:27] op_sel_hi:[1,0]
  v_pk_mul_f32 v[46:47], v[46:47], v[30:31] op_sel_hi:[1,0]
  v_cvt_pk_bf16_f32 v136, v16, v17
  v_cvt_pk_bf16_f32 v140, v40, v41
  v_cvt_pk_bf16_f32 v137, v18, v19
  v_cvt_pk_bf16_f32 v141, v42, v43
  v_cvt_pk_bf16_f32 v138, v20, v21
  v_cvt_pk_bf16_f32 v142, v44, v45
  v_cvt_pk_bf16_f32 v139, v22, v23
  v_cvt_pk_bf16_f32 v143, v46, v47
  s_and_b32 s61, s40, 1
  s_cmp_eq_u32 s61, 0
  s_cselect_b64 vcc, -1, 0
  s_cselect_b32 s76, 32768, 0
  s_add_u32 s76, s76, 98304
  v_cndmask_b32 v160, v249, v250, vcc
  v_cndmask_b32 v161, v250, v249, vcc
  v_add_u32 v160, s76, v160
  v_add_u32 v161, s76, v161
  ds_read_b64_tr_b16 v[0:1], v160 offset:0
  ds_read_b64_tr_b16 v[2:3], v160 offset:1024
  ds_read_b64_tr_b16 v[4:5], v161 offset:0
  ds_read_b64_tr_b16 v[6:7], v161 offset:1024
  ds_read_b64_tr_b16 v[8:9], v160 offset:2048
  ds_read_b64_tr_b16 v[10:11], v160 offset:3072
  ds_read_b64_tr_b16 v[12:13], v161 offset:2048
  ds_read_b64_tr_b16 v[14:15], v161 offset:3072
  ds_read_b64_tr_b16 v[16:17], v160 offset:4096
  ds_read_b64_tr_b16 v[18:19], v160 offset:5120
  ds_read_b64_tr_b16 v[20:21], v161 offset:4096
  ds_read_b64_tr_b16 v[22:23], v161 offset:5120
  ds_read_b64_tr_b16 v[24:25], v160 offset:6144
  ds_read_b64_tr_b16 v[26:27], v160 offset:7168
  ds_read_b64_tr_b16 v[28:29], v161 offset:6144
  ds_read_b64_tr_b16 v[30:31], v161 offset:7168
  ds_read_b64_tr_b16 v[32:33], v160 offset:8192
  ds_read_b64_tr_b16 v[34:35], v160 offset:9216
  ds_read_b64_tr_b16 v[36:37], v161 offset:8192
  ds_read_b64_tr_b16 v[38:39], v161 offset:9216
  ds_read_b64_tr_b16 v[40:41], v160 offset:10240
  ds_read_b64_tr_b16 v[42:43], v160 offset:11264
  ds_read_b64_tr_b16 v[44:45], v161 offset:10240
  ds_read_b64_tr_b16 v[46:47], v161 offset:11264
  ds_read_b64_tr_b16 v[48:49], v160 offset:12288
  ds_read_b64_tr_b16 v[50:51], v160 offset:13312
  ds_read_b64_tr_b16 v[52:53], v161 offset:12288
  ds_read_b64_tr_b16 v[54:55], v161 offset:13312
  ds_read_b64_tr_b16 v[56:57], v160 offset:14336
  ds_read_b64_tr_b16 v[58:59], v160 offset:15360
  ds_read_b64_tr_b16 v[60:61], v161 offset:14336
  ds_read_b64_tr_b16 v[62:63], v161 offset:15360
  ds_read_b64_tr_b16 v[64:65], v160 offset:16384
  ds_read_b64_tr_b16 v[66:67], v160 offset:17408
  ds_read_b64_tr_b16 v[68:69], v161 offset:16384
  ds_read_b64_tr_b16 v[70:71], v161 offset:17408
  ds_read_b64_tr_b16 v[72:73], v160 offset:18432
  ds_read_b64_tr_b16 v[74:75], v160 offset:19456
  ds_read_b64_tr_b16 v[76:77], v161 offset:18432
  ds_read_b64_tr_b16 v[78:79], v161 offset:19456
  ds_read_b64_tr_b16 v[80:81], v160 offset:20480
  ds_read_b64_tr_b16 v[82:83], v160 offset:21504
  ds_read_b64_tr_b16 v[84:85], v161 offset:20480
  ds_read_b64_tr_b16 v[86:87], v161 offset:21504
  ds_read_b64_tr_b16 v[88:89], v160 offset:22528
  ds_read_b64_tr_b16 v[90:91], v160 offset:23552
  ds_read_b64_tr_b16 v[92:93], v161 offset:22528
  ds_read_b64_tr_b16 v[94:95], v161 offset:23552
  ds_read_b64_tr_b16 v[96:97], v160 offset:24576
  ds_read_b64_tr_b16 v[98:99], v160 offset:25600
  ds_read_b64_tr_b16 v[100:101], v161 offset:24576
  ds_read_b64_tr_b16 v[102:103], v161 offset:25600
  ds_read_b64_tr_b16 v[104:105], v160 offset:26624
  ds_read_b64_tr_b16 v[106:107], v160 offset:27648
  ds_read_b64_tr_b16 v[108:109], v161 offset:26624
  ds_read_b64_tr_b16 v[110:111], v161 offset:27648
  ds_read_b64_tr_b16 v[112:113], v160 offset:28672
  ds_read_b64_tr_b16 v[114:115], v160 offset:29696
  ds_read_b64_tr_b16 v[116:117], v161 offset:28672
  ds_read_b64_tr_b16 v[118:119], v161 offset:29696
  ds_read_b64_tr_b16 v[120:121], v160 offset:30720
  ds_read_b64_tr_b16 v[122:123], v160 offset:31744
  ds_read_b64_tr_b16 v[124:125], v161 offset:30720
  ds_read_b64_tr_b16 v[126:127], v161 offset:31744
  s_waitcnt lgkmcnt(0)
  s_barrier
  s_lshl_b32 s56, s42, 8
  s_mul_i32 s57, s40, 28672
  s_add_u32 s56, s56, s57
  s_add_u32 s56, s56, 0
  s_lshl_b32 s57, s40, 10
  s_add_u32 s57, s57, 98304
  s_add_u32 s58, s93, 0
  s_and_b32 s58, s58, 7
  s_lshl_b32 s81, s58, 12
  s_add_u32 m0, s81, s57
  s_mul_i32 s58, s58, 114688
  s_add_u32 s58, s58, s56
  buffer_load_dwordx4 v246, s[20:23], s58 offen lds
  s_add_u32 s58, s93, 1
  s_and_b32 s58, s58, 7
  s_lshl_b32 s81, s58, 12
  s_add_u32 m0, s81, s57
  s_mul_i32 s58, s58, 114688
  s_add_u32 s58, s58, s56
  buffer_load_dwordx4 v246, s[20:23], s58 offen lds
  s_add_u32 s58, s93, 2
  s_and_b32 s58, s58, 7
  s_lshl_b32 s81, s58, 12
  s_add_u32 m0, s81, s57
  s_mul_i32 s58, s58, 114688
  s_add_u32 s58, s58, s56
  buffer_load_dwordx4 v246, s[20:23], s58 offen lds
  s_add_u32 s58, s93, 3
  s_and_b32 s58, s58, 7
  s_lshl_b32 s81, s58, 12
  s_add_u32 m0, s81, s57
  s_mul_i32 s58, s58, 114688
  s_add_u32 s58, s58, s56
  buffer_load_dwordx4 v246, s[20:23], s58 offen lds
  s_add_u32 s58, s93, 4
  s_and_b32 s58, s58, 7
  s_lshl_b32 s81, s58, 12
  s_add_u32 m0, s81, s57
  s_mul_i32 s58, s58, 114688
  s_add_u32 s58, s58, s56
  buffer_load_dwordx4 v246, s[20:23], s58 offen lds
  s_add_u32 s58, s93, 5
  s_and_b32 s58, s58, 7
  s_lshl_b32 s81, s58, 12
  s_add_u32 m0, s81, s57
  s_mul_i32 s58, s58, 114688
  s_add_u32 s58, s58, s56
  buffer_load_dwordx4 v246, s[20:23], s58 offen lds
  s_add_u32 s58, s93, 6
  s_and_b32 s58, s58, 7
  s_lshl_b32 s81, s58, 12
  s_add_u32 m0, s81, s57
  s_mul_i32 s58, s58, 114688
  s_add_u32 s58, s58, s56
  buffer_load_dwordx4 v246, s[20:23], s58 offen lds
  s_add_u32 s58, s93, 7
  s_and_b32 s58, s58, 7
  s_lshl_b32 s81, s58, 12
  s_add_u32 m0, s81, s57
  s_mul_i32 s58, s58, 114688
  s_add_u32 s58, s58, s56
  buffer_load_dwordx4 v246, s[20:23], s58 offen lds
  v_mov_b32 v224, 0x00003f80
  v_mov_b32 v225, 0x3f800000
  v_mov_b32 v144, 0
  v_mov_b32 v145, 0
  v_mov_b32 v146, 0
  v_mov_b32 v147, 0
  s_waitcnt vmcnt(23)
  v_dot2c_f32_bf16 v144, v176, v224
  v_dot2c_f32_bf16 v145, v176, v225
  v_dot2c_f32_bf16 v146, v177, v224
  v_dot2c_f32_bf16 v147, v177, v225
  s_waitcnt vmcnt(22)
  v_dot2c_f32_bf16 v144, v178, v224
  v_dot2c_f32_bf16 v145, v178, v225
  v_dot2c_f32_bf16 v146, v179, v224
  v_dot2c_f32_bf16 v147, v179, v225
  s_waitcnt vmcnt(21)
  v_dot2c_f32_bf16 v144, v180, v224
  v_dot2c_f32_bf16 v145, v180, v225
  v_dot2c_f32_bf16 v146, v181, v224
  v_dot2c_f32_bf16 v147, v181, v225
  s_waitcnt vmcnt(20)
  v_dot2c_f32_bf16 v144, v182, v224
  v_dot2c_f32_bf16 v145, v182, v225
  v_dot2c_f32_bf16 v146, v183, v224
  v_dot2c_f32_bf16 v147, v183, v225
  s_waitcnt vmcnt(19)
  v_dot2c_f32_bf16 v144, v184, v224
  v_dot2c_f32_bf16 v145, v184, v225
  v_dot2c_f32_bf16 v146, v185, v224
  v_dot2c_f32_bf16 v147, v185, v225
  s_waitcnt vmcnt(18)
  v_dot2c_f32_bf16 v144, v186, v224
  v_dot2c_f32_bf16 v145, v186, v225
  v_dot2c_f32_bf16 v146, v187, v224
  v_dot2c_f32_bf16 v147, v187, v225
  s_waitcnt vmcnt(17)
  v_dot2c_f32_bf16 v144, v188, v224
  v_dot2c_f32_bf16 v145, v188, v225
  v_dot2c_f32_bf16 v146, v189, v224
  v_dot2c_f32_bf16 v147, v189, v225
  s_waitcnt vmcnt(16)
  v_dot2c_f32_bf16 v144, v190, v224
  v_dot2c_f32_bf16 v145, v190, v225
  v_dot2c_f32_bf16 v146, v191, v224
  v_dot2c_f32_bf16 v147, v191, v225
  s_waitcnt vmcnt(15)
  v_dot2c_f32_bf16 v144, v192, v224
  v_dot2c_f32_bf16 v145, v192, v225
  v_dot2c_f32_bf16 v146, v193, v224
  v_dot2c_f32_bf16 v147, v193, v225
  s_waitcnt vmcnt(14)
  v_dot2c_f32_bf16 v144, v194, v224
  v_dot2c_f32_bf16 v145, v194, v225
  v_dot2c_f32_bf16 v146, v195, v224
  v_dot2c_f32_bf16 v147, v195, v225
  s_waitcnt vmcnt(13)
  v_dot2c_f32_bf16 v144, v196, v224
  v_dot2c_f32_bf16 v145, v196, v225
  v_dot2c_f32_bf16 v146, v197, v224
  v_dot2c_f32_bf16 v147, v197, v225
  s_waitcnt vmcnt(12)
  v_dot2c_f32_bf16 v144, v198, v224
  v_dot2c_f32_bf16 v145, v198, v225
  v_dot2c_f32_bf16 v146, v199, v224
  v_dot2c_f32_bf16 v147, v199, v225
  s_waitcnt vmcnt(11)
  v_dot2c_f32_bf16 v144, v200, v224
  v_dot2c_f32_bf16 v145, v200, v225
  v_dot2c_f32_bf16 v146, v201, v224
  v_dot2c_f32_bf16 v147, v201, v225
  s_waitcnt vmcnt(10)
  v_dot2c_f32_bf16 v144, v202, v224
  v_dot2c_f32_bf16 v145, v202, v225
  v_dot2c_f32_bf16 v146, v203, v224
  v_dot2c_f32_bf16 v147, v203, v225
  s_waitcnt vmcnt(9)
  v_dot2c_f32_bf16 v144, v204, v224
  v_dot2c_f32_bf16 v145, v204, v225
  v_dot2c_f32_bf16 v146, v205, v224
  v_dot2c_f32_bf16 v147, v205, v225
  s_waitcnt vmcnt(8)
  v_dot2c_f32_bf16 v144, v206, v224
  v_dot2c_f32_bf16 v145, v206, v225
  v_dot2c_f32_bf16 v146, v207, v224
  v_dot2c_f32_bf16 v147, v207, v225
  s_nop 0
  v_cvt_pk_bf16_f32 v226, v144, v145
  s_nop 0
  v_cvt_pk_bf16_f32 v227, v146, v147
  s_lshl_b32 s74, s40, 9
  s_add_u32 s74, s74, 131072
  v_add_u32 v234, s74, v248
  ds_write_b64 v234, v[226:227]
  s_cmp_eq_u32 s40, 0
  s_cbranch_scc0 L_z2_8
  v_pk_add_f32 v[208:209], v[208:209], v[216:217]
  v_pk_add_f32 v[210:211], v[210:211], v[218:219]
  v_pk_add_f32 v[212:213], v[212:213], v[220:221]
  v_pk_add_f32 v[214:215], v[214:215], v[222:223]
  v_pk_add_f32 v[208:209], v[208:209], v[212:213]
  v_pk_add_f32 v[210:211], v[210:211], v[214:215]
  v_pk_add_f32 v[208:209], v[208:209], v[210:211]
  v_add_f32 v208, v208, v209
  v_bfe_u32 v148, v244, 4, 2
  v_bfe_u32 v149, v244, 2, 1
  v_lshl_add_u32 v148, v148, 1, v149
  v_and_b32 v149, 3, v244
  v_bfe_u32 v150, v244, 3, 1
  v_lshl_add_u32 v149, v150, 2, v149
  v_lshl_add_u32 v148, v148, 3, v149
  v_lshlrev_b32 v148, 1, v148
  v_add_u32 v148, 131072, v148
  v_cvt_pk_bf16_f32 v208, v208, v208
  ds_write_b16 v148, v208 offset:4096
L_z2_8:
  s_waitcnt lgkmcnt(0)
  s_barrier
  v_add_u32 v234, 131072, v248
  v_add_u32 v235, 131072, v243
  ds_read_b64 v[144:145], v234 offset:0
  ds_read_b64 v[146:147], v234 offset:512
  ds_read_b64 v[148:149], v234 offset:1024
  ds_read_b64 v[150:151], v234 offset:1536
  ds_read_b128 v[152:155], v235 offset:4096
  ds_read_b128 v[156:159], v235 offset:4128
  ds_read_b128 v[160:163], v235 offset:4160
  ds_read_b128 v[164:167], v235 offset:4192
  s_lshl_b32 s75, s41, 2
  s_add_u32 s75, s75, s40
  s_mul_i32 s75, s75, 115200
  s_lshl_b32 s76, s42, 11
  s_add_u32 s75, s75, s76
  s_add_u32 s55, s75, 6815744
  s_lshl_b32 s54, s42, 2
  s_add_u32 s54, s54, s40
  s_lshl_b32 s54, s54, 3
  s_lshl_b32 s74, s41, 9
  s_add_u32 s54, s54, s74
  s_add_u32 s54, s54, 0
  s_waitcnt lgkmcnt(0)
  v_cndmask_b32 v168, v152, v144, s[50:51]
  v_cndmask_b32 v176, v144, v160, s[50:51]
  v_cndmask_b32 v169, v153, v145, s[50:51]
  v_cndmask_b32 v177, v145, v161, s[50:51]
  v_cndmask_b32 v170, v154, v146, s[50:51]
  v_cndmask_b32 v178, v146, v162, s[50:51]
  v_cndmask_b32 v171, v155, v147, s[50:51]
  v_cndmask_b32 v179, v147, v163, s[50:51]
  v_cndmask_b32 v172, v156, v148, s[50:51]
  v_cndmask_b32 v180, v148, v164, s[50:51]
  v_cndmask_b32 v173, v157, v149, s[50:51]
  v_cndmask_b32 v181, v149, v165, s[50:51]
  v_cndmask_b32 v174, v158, v150, s[50:51]
  v_cndmask_b32 v182, v150, v166, s[50:51]
  v_cndmask_b32 v175, v159, v151, s[50:51]
  v_cndmask_b32 v183, v151, v167, s[50:51]
  v_mfma_f32_32x32x16_bf16 v[184:199], v[168:171], v[128:131], 0
  v_mfma_f32_32x32x16_bf16 v[200:215], v[176:179], v[136:139], 0
  v_mfma_f32_32x32x16_bf16 v[184:199], v[172:175], v[132:135], v[184:199]
  v_mfma_f32_32x32x16_bf16 v[200:215], v[180:183], v[140:143], v[200:215]
  s_nop 10
  v_add_f32 v216, 0x358637bd, v192
  v_add_f32 v218, 0x358637bd, v200
  v_rcp_f32 v216, v216
  v_rcp_f32 v218, v218
  v_pk_mul_f32 v[184:185], v[184:185], v[216:217] op_sel_hi:[1,0]
  v_pk_mul_f32 v[208:209], v[208:209], v[218:219] op_sel_hi:[1,0]
  v_pk_mul_f32 v[186:187], v[186:187], v[216:217] op_sel_hi:[1,0]
  v_pk_mul_f32 v[210:211], v[210:211], v[218:219] op_sel_hi:[1,0]
  v_pk_mul_f32 v[188:189], v[188:189], v[216:217] op_sel_hi:[1,0]
  v_pk_mul_f32 v[212:213], v[212:213], v[218:219] op_sel_hi:[1,0]
  v_pk_mul_f32 v[190:191], v[190:191], v[216:217] op_sel_hi:[1,0]
  v_pk_mul_f32 v[214:215], v[214:215], v[218:219] op_sel_hi:[1,0]
  v_cvt_pk_bf16_f32 v220, v184, v185
  v_cvt_pk_bf16_f32 v224, v208, v209
  v_cvt_pk_bf16_f32 v221, v186, v187
  v_cvt_pk_bf16_f32 v225, v210, v211
  v_cvt_pk_bf16_f32 v222, v188, v189
  v_cvt_pk_bf16_f32 v226, v212, v213
  v_cvt_pk_bf16_f32 v223, v190, v191
  v_cvt_pk_bf16_f32 v227, v214, v215
  s_cmp_eq_u32 s46, 0
  s_cbranch_scc1 L_st_9
  buffer_store_dwordx4 v[220:223], v255, s[36:39], s55 offen
  buffer_store_dwordx4 v[224:227], v255, s[36:39], s55 offen offset:1024
  s_branch L_st_9_e
L_st_9:
  buffer_store_dwordx4 v[220:223], v255, s[36:39], s55 offen sc0 sc1
  buffer_store_dwordx4 v[224:227], v255, s[36:39], s55 offen offset:1024 sc0 sc1
L_st_9_e:
  s_waitcnt vmcnt(0)
  s_or_b32 s70, s44, 1
  v_mov_b32 v236, s70
  v_mov_b32 v237, s45
  v_mov_b32 v238, 0
  s_mov_b64 exec, 1
  s_cmp_eq_u32 s46, 0
  s_cbranch_scc1 L_fs_10
  buffer_store_dwordx2 v[236:237], v238, s[36:39], s54 offen
  s_branch L_fs_10_e
L_fs_10:
  buffer_store_dwordx2 v[236:237], v238, s[36:39], s54 offen sc0 sc1
L_fs_10_e:
  s_mov_b64 exec, -1
  s_cmp_ge_u32 s42, 14
  s_cbranch_scc1 L_cse_11
  s_lshl_b32 s71, s42, 8
  s_add_u32 s71, s71, 40960
  s_or_b32 s70, s44, 1
  s_mov_b32 s68, -1
  s_mov_b32 s69, 0
  s_mov_b32 s80, 0
L_poll_12:
  buffer_load_dwordx2 v[236:237], v248, s[36:39], s71 offen sc1
  s_add_u32 s80, s80, 1
  s_cmp_gt_u32 s80, 0x40000
  s_cbranch_scc1 L_poll_12_x
  s_waitcnt vmcnt(0)
  v_subrev_u32 v236, s70, v236
  v_cmp_ge_u32 vcc, 14, v236
  v_cmp_eq_u32 s[66:67], s45, v237
  s_and_b64 vcc, vcc, s[66:67]
  s_andn2_b64 s[66:67], s[68:69], vcc
  s_cbranch_scc1 L_poll_12
L_poll_12_x:
  s_waitcnt vmcnt(0)
  v_and_b32 v176, 31, v244
  v_lshlrev_b32 v176, 6, v176
  v_lshl_add_u32 v176, v243, 1, v176
  s_lshl_b32 s74, s42, 13
  s_add_u32 s74, s74, 327680
  s_add_u32 s75, s74, 0
  buffer_load_dwordx4 v[144:147], v176, s[36:39], s75 offen sc1
  buffer_load_dwordx4 v[148:151], v176, s[36:39], s75 offen offset:16 sc1
  s_add_u32 s75, s74, 2048
  buffer_load_dwordx4 v[152:155], v176, s[36:39], s75 offen sc1
  buffer_load_dwordx4 v[156:159], v176, s[36:39], s75 offen offset:16 sc1
  s_add_u32 s75, s74, 4096
  buffer_load_dwordx4 v[160:163], v176, s[36:39], s75 offen sc1
  buffer_load_dwordx4 v[164:167], v176, s[36:39], s75 offen offset:16 sc1
  s_add_u32 s75, s74, 6144
  buffer_load_dwordx4 v[168:171], v176, s[36:39], s75 offen sc1
  buffer_load_dwordx4 v[172:175], v176, s[36:39], s75 offen offset:16 sc1
  s_waitcnt vmcnt(0)
  v_pk_add_f32 v[144:145], v[144:145], v[146:147]
  v_pk_add_f32 v[148:149], v[148:149], v[150:151]
  v_pk_add_f32 v[144:145], v[144:145], v[148:149]
  v_add_f32 v144, v144, v145
  v_mov_b32 v145, v144
  s_nop 1
  v_permlane32_swap_b32 v144, v145
  v_add_f32 v144, v144, v145
  v_cvt_pk_bf16_f32 v148, v144, v144
  v_and_b32 v148, 0xffff0000, v148
  v_sub_f32 v149, v144, v148
  v_cvt_pk_bf16_f32 v146, v148, v149
  v_cvt_pk_bf16_f32 v147, v148, 0
  v_accvgpr_write_b32 a246, v146
  v_accvgpr_write_b32 a247, v147
  v_pk_add_f32 v[152:153], v[152:153], v[154:155]
  v_pk_add_f32 v[156:157], v[156:157], v[158:159]
  v_pk_add_f32 v[152:153], v[152:153], v[156:157]
  v_add_f32 v152, v152, v153
  v_mov_b32 v153, v152
  s_nop 1
  v_permlane32_swap_b32 v152, v153
  v_add_f32 v152, v152, v153
  v_cvt_pk_bf16_f32 v156, v152, v152
  v_and_b32 v156, 0xffff0000, v156
  v_sub_f32 v157, v152, v156
  v_cvt_pk_bf16_f32 v154, v156, v157
  v_cvt_pk_bf16_f32 v155, v156, 0
  v_accvgpr_write_b32 a248, v154
  v_accvgpr_write_b32 a249, v155
  v_pk_add_f32 v[160:161], v[160:161], v[162:163]
  v_pk_add_f32 v[164:165], v[164:165], v[166:167]
  v_pk_add_f32 v[160:161], v[160:161], v[164:165]
  v_add_f32 v160, v160, v161
  v_mov_b32 v161, v160
  s_nop 1
  v_permlane32_swap_b32 v160, v161
  v_add_f32 v160, v160, v161
  v_cvt_pk_bf16_f32 v164, v160, v160
  v_and_b32 v164, 0xffff0000, v164
  v_sub_f32 v165, v160, v164
  v_cvt_pk_bf16_f32 v162, v164, v165
  v_cvt_pk_bf16_f32 v163, v164, 0
  v_accvgpr_write_b32 a250, v162
  v_accvgpr_write_b32 a251, v163
  v_pk_add_f32 v[168:169], v[168:169], v[170:171]
  v_pk_add_f32 v[172:173], v[172:173], v[174:175]
  v_pk_add_f32 v[168:169], v[168:169], v[172:173]
  v_add_f32 v168, v168, v169
  v_mov_b32 v169, v168
  s_nop 1
  v_permlane32_swap_b32 v168, v169
  v_add_f32 v168, v168, v169
  v_cvt_pk_bf16_f32 v172, v168, v168
  v_and_b32 v172, 0xffff0000, v172
  v_sub_f32 v173, v168, v172
  v_cvt_pk_bf16_f32 v170, v172, v173
  v_cvt_pk_bf16_f32 v171, v172, 0
  v_accvgpr_write_b32 a252, v170
  v_accvgpr_write_b32 a253, v171
L_cse_11:
  s_lshr_b32 s60, s42, 3
  s_lshl_b32 s60, s60, 1
  s_lshr_b32 s74, s40, 1
  s_add_u32 s60, s60, s74
  s_and_b32 s61, s40, 1
  s_and_b32 s62, s42, 7
  s_lshl_b32 s62, s62, 1
  s_add_u32 s62, s62, s61
  s_and_b32 s60, s42, 7
  s_lshl_b32 s71, s60, 9
  s_add_u32 s71, s71, 32768
  s_mul_i32 s61, s40, 14
  s_mov_b64 s[62:63], 0x3fff
  s_lshl_b64 s[62:63], s[62:63], s61
  s_or_b32 s70, s44, 1
  s_mov_b32 s68, s62
  s_mov_b32 s69, s63
  s_mov_b32 s80, 0
L_poll_13:
  buffer_load_dwordx2 v[236:237], v248, s[36:39], s71 offen sc1
  s_add_u32 s80, s80, 1
  s_cmp_gt_u32 s80, 0x40000
  s_cbranch_scc1 L_poll_13_x
  s_waitcnt vmcnt(0)
  v_subrev_u32 v236, s70, v236
  v_cmp_ge_u32 vcc, 14, v236
  v_cmp_eq_u32 s[66:67], s45, v237
  s_and_b64 vcc, vcc, s[66:67]
  s_andn2_b64 s[66:67], s[68:69], vcc
  s_cbranch_scc1 L_poll_13
L_poll_13_x:
  s_waitcnt vmcnt(0)
  s_and_b32 s61, s40, 1
  s_lshl_b32 s62, s60, 1
  s_or_b32 s63, s62, s61
  s_xor_b32 s62, s63, 1
  s_mul_i32 s64, s40, 28
  s_mul_i32 s84, s63, 112
  s_add_u32 s84, s84, s64
  s_lshl_b32 s84, s84, 10
  s_add_u32 s84, s84, 14680064
  s_mul_i32 s85, s62, 112
  s_add_u32 s85, s85, s64
  s_lshl_b32 s85, s85, 10
  s_add_u32 s85, s85, 14680064
  s_lshr_b32 s60, s42, 3
  s_lshl_b32 s60, s60, 1
  s_lshr_b32 s74, s40, 1
  s_add_u32 s60, s60, s74
  s_and_b32 s61, s40, 1
  s_and_b32 s62, s42, 7
  s_lshl_b32 s62, s62, 1
  s_add_u32 s62, s62, s61
  s_lshl_b32 s75, s41, 2
  s_add_u32 s75, s75, s60
  s_mul_i32 s75, s75, 32768
  s_lshl_b32 s76, s62, 6
  s_add_u32 s75, s75, s76
  v_and_b32 v232, 31, v244
  v_lshlrev_b32 v232, 10, v232
  v_lshl_add_u32 v232, v243, 1, v232
  buffer_load_dwordx4 v[136:139], v232, s[4:7], s75 offen
  buffer_load_dwordx4 v[140:143], v232, s[4:7], s75 offen offset:16
  v_and_b32 v226, 3, v244
  v_bfe_u32 v227, v244, 3, 1
  v_lshl_add_u32 v226, v227, 2, v226
  v_bfe_u32 v227, v244, 2, 1
  v_lshrrev_b32 v228, 5, v244
  v_xor_b32 v227, v227, v228
  v_lshl_add_u32 v226, v227, 3, v226
  v_bfe_u32 v227, v244, 4, 1
  v_lshl_add_u32 v228, v227, 3, v226
  v_and_b32 v229, 1, v228
  v_lshlrev_b32 v229, 4, v229
  s_movk_i32 s74, 0x3f80
  v_lshlrev_b32 v229, v229, s74
  v_lshrrev_b32 v230, 1, v228
  v_cmp_eq_u32 vcc, 0, v230
  s_nop 1
  v_cndmask_b32 v128, 0, v229, vcc
  v_cmp_eq_u32 vcc, 1, v230
  s_nop 1
  v_cndmask_b32 v129, 0, v229, vcc
  v_cmp_eq_u32 vcc, 2, v230
  s_nop 1
  v_cndmask_b32 v130, 0, v229, vcc
  v_cmp_eq_u32 vcc, 3, v230
  s_nop 1
  v_cndmask_b32 v131, 0, v229, vcc
  v_xor_b32 v227, 1, v227
  v_lshl_add_u32 v228, v227, 3, v226
  v_and_b32 v229, 1, v228
  v_lshlrev_b32 v229, 4, v229
  s_movk_i32 s74, 0x3f80
  v_lshlrev_b32 v229, v229, s74
  v_lshrrev_b32 v230, 1, v228
  v_cmp_eq_u32 vcc, 0, v230
  s_nop 1
  v_cndmask_b32 v132, 0, v229, vcc
  v_cmp_eq_u32 vcc, 1, v230
  s_nop 1
  v_cndmask_b32 v133, 0, v229, vcc
  v_cmp_eq_u32 vcc, 2, v230
  s_nop 1
  v_cndmask_b32 v134, 0, v229, vcc
  v_cmp_eq_u32 vcc, 3, v230
  s_nop 1
  v_cndmask_b32 v135, 0, v229, vcc
  s_lshl_b32 s52, s41, 2
  s_add_u32 s52, s52, s60
  s_mul_i32 s52, s52, 33280
  s_lshl_b32 s76, s62, 11
  s_add_u32 s52, s52, s76
  s_add_u32 s52, s52, 4194304
  s_lshl_b32 s53, s41, 2
  s_add_u32 s53, s53, s60
  s_mul_i32 s53, s53, 4096
  s_bfe_u32 s76, s62, 0x20001
  s_lshl_b32 s76, s76, 10
  s_add_u32 s53, s53, s76
  s_lshr_b32 s76, s62, 3
  s_lshl_b32 s76, s76, 9
  s_add_u32 s53, s53, s76
  s_and_b32 s76, s62, 1
  s_lshl_b32 s76, s76, 3
  s_add_u32 s53, s53, s76
  s_add_u32 s53, s53, 65536
  v_and_b32 v240, 31, v244
  v_lshlrev_b32 v240, 4, v240
  v_lshrrev_b32 v241, 2, v243
  v_add_u32 v240, v240, v241
  s_lshl_b32 s54, s42, 2
  s_add_u32 s54, s54, s40
  s_lshl_b32 s54, s54, 3
  s_lshl_b32 s74, s41, 9
  s_add_u32 s54, s54, s74
  s_add_u32 s54, s54, 0
  s_lshl_b32 s63, 0x11111111, s60
  s_cmp_eq_u32 s61, 0
  s_cselect_b32 s64, s63, 0
  s_cselect_b32 s65, 0, s63
  s_lshl_b32 s71, s41, 9
  s_add_u32 s71, s71, 0
  s_or_b32 s70, s44, 1
  s_mov_b32 s68, s64
  s_mov_b32 s69, s65
  s_mov_b32 s80, 0
L_poll_14:
  buffer_load_dwordx2 v[236:237], v248, s[36:39], s71 offen sc1
  s_add_u32 s80, s80, 1
  s_cmp_gt_u32 s80, 0x40000
  s_cbranch_scc1 L_poll_14_x
  s_waitcnt vmcnt(0)
  v_subrev_u32 v236, s70, v236
  v_cmp_ge_u32 vcc, 14, v236
  v_cmp_eq_u32 s[66:67], s45, v237
  s_and_b64 vcc, vcc, s[66:67]
  s_andn2_b64 s[66:67], s[68:69], vcc
  s_cbranch_scc1 L_poll_14
L_poll_14_x:
  s_waitcnt vmcnt(0)
  s_lshl_b32 s75, s41, 2
  s_add_u32 s75, s75, s60
  s_mul_i32 s75, s75, 115200
  s_lshl_b32 s76, s61, 14
  s_add_u32 s75, s75, s76
  s_add_u32 s59, s75, 6815744
  buffer_load_dwordx4 v[144:147], v255, s[36:39], s59 offen offset:0 sc1
  buffer_load_dwordx4 v[148:151], v255, s[36:39], s59 offen offset:1024 sc1
  buffer_load_dwordx4 v[152:155], v255, s[36:39], s59 offen offset:2048 sc1
  buffer_load_dwordx4 v[156:159], v255, s[36:39], s59 offen offset:3072 sc1
  s_add_u32 s59, s59, 4096
  buffer_load_dwordx4 v[160:163], v255, s[36:39], s59 offen offset:0 sc1
  buffer_load_dwordx4 v[164:167], v255, s[36:39], s59 offen offset:1024 sc1
  buffer_load_dwordx4 v[168:171], v255, s[36:39], s59 offen offset:2048 sc1
  buffer_load_dwordx4 v[172:175], v255, s[36:39], s59 offen offset:3072 sc1
  s_add_u32 s59, s59, 4096
  buffer_load_dwordx4 v[176:179], v255, s[36:39], s59 offen offset:0 sc1
  buffer_load_dwordx4 v[180:183], v255, s[36:39], s59 offen offset:1024 sc1
  v_mfma_f32_32x32x16_bf16 v[208:223], v[128:131], v[136:139], 0
  v_mfma_f32_32x32x16_bf16 v[208:223], v[132:135], v[140:143], v[208:223]
  s_lshl_b32 s74, s40, 12
  s_add_u32 s75, s74, 131072
  v_add_u32 v128, s75, v255
  s_xor_b32 s74, s74, 4096
  s_add_u32 s75, s74, 131072
  v_add_u32 v129, s75, v255
  v_lshlrev_b32 v130, 7, v244
  s_waitcnt vmcnt(9)
  v_mfma_f32_32x32x16_bf16 v[224:239], v[4:7], v[144:147], 0
  buffer_load_dwordx4 v[184:187], v255, s[36:39], s59 offen offset:2048 sc1
  v_mfma_f32_32x32x16_bf16 v[208:223], v[0:3], v[144:147], v[208:223]
  s_waitcnt vmcnt(9)
  v_mfma_f32_32x32x16_bf16 v[224:239], v[12:15], v[148:151], v[224:239]
  buffer_load_dwordx4 v[188:191], v255, s[36:39], s59 offen offset:3072 sc1
  v_mfma_f32_32x32x16_bf16 v[208:223], v[8:11], v[148:151], v[208:223]
  s_waitcnt vmcnt(9)
  v_mfma_f32_32x32x16_bf16 v[224:239], v[20:23], v[152:155], v[224:239]
  s_add_u32 s59, s59, 4096
  buffer_load_dwordx4 v[192:195], v255, s[36:39], s59 offen offset:0 sc1
  v_mfma_f32_32x32x16_bf16 v[208:223], v[16:19], v[152:155], v[208:223]
  s_waitcnt vmcnt(9)
  v_mfma_f32_32x32x16_bf16 v[224:239], v[28:31], v[156:159], v[224:239]
  buffer_load_dwordx4 v[196:199], v255, s[36:39], s59 offen offset:1024 sc1
  v_mfma_f32_32x32x16_bf16 v[208:223], v[24:27], v[156:159], v[208:223]
  s_waitcnt vmcnt(9)
  v_mfma_f32_32x32x16_bf16 v[224:239], v[36:39], v[160:163], v[224:239]
  buffer_load_dwordx4 v[200:203], v255, s[36:39], s59 offen offset:2048 sc1
  v_mfma_f32_32x32x16_bf16 v[208:223], v[32:35], v[160:163], v[208:223]
  s_waitcnt vmcnt(9)
  v_mfma_f32_32x32x16_bf16 v[224:239], v[44:47], v[164:167], v[224:239]
  buffer_load_dwordx4 v[204:207], v255, s[36:39], s59 offen offset:3072 sc1
  v_mfma_f32_32x32x16_bf16 v[208:223], v[40:43], v[164:167], v[208:223]
  s_waitcnt vmcnt(9)
  v_mfma_f32_32x32x16_bf16 v[224:239], v[52:55], v[168:171], v[224:239]
  buffer_load_dwordx4 a[0:3], v255, s[36:39], s84 offen offset:0 sc1
  buffer_load_dwordx4 a[8:11], v255, s[36:39], s84 offen offset:1024 sc1
  buffer_load_dwordx4 a[16:19], v255, s[36:39], s84 offen offset:2048 sc1
  v_mfma_f32_32x32x16_bf16 v[208:223], v[48:51], v[168:171], v[208:223]
  s_waitcnt vmcnt(11)
  v_mfma_f32_32x32x16_bf16 v[224:239], v[60:63], v[172:175], v[224:239]
  buffer_load_dwordx4 a[24:27], v255, s[36:39], s84 offen offset:3072 sc1
  s_add_u32 s84, s84, 4096
  buffer_load_dwordx4 a[32:35], v255, s[36:39], s84 offen offset:0 sc1
  buffer_load_dwordx4 a[40:43], v255, s[36:39], s84 offen offset:1024 sc1
  v_mfma_f32_32x32x16_bf16 v[208:223], v[56:59], v[172:175], v[208:223]
  s_waitcnt vmcnt(13)
  v_mfma_f32_32x32x16_bf16 v[224:239], v[68:71], v[176:179], v[224:239]
  buffer_load_dwordx4 a[48:51], v255, s[36:39], s84 offen offset:2048 sc1
  buffer_load_dwordx4 a[56:59], v255, s[36:39], s84 offen offset:3072 sc1
  s_add_u32 s84, s84, 4096
  buffer_load_dwordx4 a[64:67], v255, s[36:39], s84 offen offset:0 sc1
  v_mfma_f32_32x32x16_bf16 v[208:223], v[64:67], v[176:179], v[208:223]
  s_waitcnt vmcnt(15)
  v_mfma_f32_32x32x16_bf16 v[224:239], v[76:79], v[180:183], v[224:239]
  buffer_load_dwordx4 a[72:75], v255, s[36:39], s84 offen offset:1024 sc1
  buffer_load_dwordx4 a[80:83], v255, s[36:39], s84 offen offset:2048 sc1
  buffer_load_dwordx4 a[88:91], v255, s[36:39], s84 offen offset:3072 sc1
  v_mfma_f32_32x32x16_bf16 v[208:223], v[72:75], v[180:183], v[208:223]
  s_waitcnt vmcnt(17)
  v_mfma_f32_32x32x16_bf16 v[224:239], v[84:87], v[184:187], v[224:239]
  s_add_u32 s84, s84, 4096
  buffer_load_dwordx4 a[96:99], v255, s[36:39], s84 offen offset:0 sc1
  buffer_load_dwordx4 a[104:107], v255, s[36:39], s84 offen offset:1024 sc1
  buffer_load_dwordx4 a[112:115], v255, s[36:39], s84 offen offset:2048 sc1
  v_mfma_f32_32x32x16_bf16 v[208:223], v[80:83], v[184:187], v[208:223]
  s_waitcnt vmcnt(19)
  v_mfma_f32_32x32x16_bf16 v[224:239], v[92:95], v[188:191], v[224:239]
  buffer_load_dwordx4 a[120:123], v255, s[36:39], s84 offen offset:3072 sc1
  s_add_u32 s84, s84, 4096
  buffer_load_dwordx4 a[128:131], v255, s[36:39], s84 offen offset:0 sc1
  buffer_load_dwordx4 a[136:139], v255, s[36:39], s84 offen offset:1024 sc1
  v_mfma_f32_32x32x16_bf16 v[208:223], v[88:91], v[188:191], v[208:223]
  s_waitcnt vmcnt(21)
  v_mfma_f32_32x32x16_bf16 v[224:239], v[100:103], v[192:195], v[224:239]
  v_mfma_f32_32x32x16_bf16 v[208:223], v[96:99], v[192:195], v[208:223]
  s_waitcnt vmcnt(20)
  v_mfma_f32_32x32x16_bf16 v[224:239], v[108:111], v[196:199], v[224:239]
  v_mfma_f32_32x32x16_bf16 v[208:223], v[104:107], v[196:199], v[208:223]
  s_waitcnt vmcnt(19)
  v_mfma_f32_32x32x16_bf16 v[224:239], v[116:119], v[200:203], v[224:239]
  v_mfma_f32_32x32x16_bf16 v[208:223], v[112:115], v[200:203], v[208:223]
  s_waitcnt vmcnt(18)
  v_mfma_f32_32x32x16_bf16 v[224:239], v[124:127], v[204:207], v[224:239]
  v_mfma_f32_32x32x16_bf16 v[208:223], v[120:123], v[204:207], v[208:223]
  s_nop 10
  ds_write_b128 v128, v[224:227] offset:0
  ds_write_b128 v128, v[228:231] offset:1024
  ds_write_b128 v128, v[232:235] offset:2048
  ds_write_b128 v128, v[236:239] offset:3072
  s_waitcnt lgkmcnt(0)
  s_barrier
  ds_read_b128 v[144:147], v129 offset:0
  ds_read_b128 v[148:151], v129 offset:1024
  ds_read_b128 v[152:155], v129 offset:2048
  ds_read_b128 v[156:159], v129 offset:3072
  s_waitcnt lgkmcnt(0)
  v_pk_add_f32 v[208:209], v[208:209], v[144:145]
  v_pk_add_f32 v[210:211], v[210:211], v[146:147]
  v_pk_add_f32 v[212:213], v[212:213], v[148:149]
  v_pk_add_f32 v[214:215], v[214:215], v[150:151]
  v_pk_add_f32 v[216:217], v[216:217], v[152:153]
  v_pk_add_f32 v[218:219], v[218:219], v[154:155]
  v_pk_add_f32 v[220:221], v[220:221], v[156:157]
  v_pk_add_f32 v[222:223], v[222:223], v[158:159]
  v_cvt_pk_bf16_f32 v160, v208, v209
  v_cvt_pk_bf16_f32 v161, v210, v211
  v_cvt_pk_bf16_f32 v162, v212, v213
  v_cvt_pk_bf16_f32 v163, v214, v215
  v_cvt_pk_bf16_f32 v164, v216, v217
  v_cvt_pk_bf16_f32 v165, v218, v219
  v_cvt_pk_bf16_f32 v166, v220, v221
  v_cvt_pk_bf16_f32 v167, v222, v223
  s_cmp_eq_u32 s46, 0
  s_cbranch_scc1 L_st_16
  buffer_store_dwordx4 v[160:163], v255, s[36:39], s52 offen
  buffer_store_dwordx4 v[164:167], v255, s[36:39], s52 offen offset:1024
  s_branch L_st_16_e
L_st_16:
  buffer_store_dwordx4 v[160:163], v255, s[36:39], s52 offen sc0 sc1
  buffer_store_dwordx4 v[164:167], v255, s[36:39], s52 offen offset:1024 sc0 sc1
L_st_16_e:
  v_pk_add_f32 v[168:169], v[208:209], v[210:211]
  v_pk_mul_f32 v[170:171], v[208:209], v[208:209]
  v_pk_fma_f32 v[170:171], v[210:211], v[210:211], v[170:171]
  v_pk_add_f32 v[168:169], v[168:169], v[212:213]
  v_pk_fma_f32 v[170:171], v[212:213], v[212:213], v[170:171]
  v_pk_add_f32 v[168:169], v[168:169], v[214:215]
  v_pk_fma_f32 v[170:171], v[214:215], v[214:215], v[170:171]
  v_pk_add_f32 v[168:169], v[168:169], v[216:217]
  v_pk_fma_f32 v[170:171], v[216:217], v[216:217], v[170:171]
  v_pk_add_f32 v[168:169], v[168:169], v[218:219]
  v_pk_fma_f32 v[170:171], v[218:219], v[218:219], v[170:171]
  v_pk_add_f32 v[168:169], v[168:169], v[220:221]
  v_pk_fma_f32 v[170:171], v[220:221], v[220:221], v[170:171]
  v_pk_add_f32 v[168:169], v[168:169], v[222:223]
  v_pk_fma_f32 v[170:171], v[222:223], v[222:223], v[170:171]
  v_add_f32 v168, v168, v169
  v_add_f32 v169, v170, v171
  s_nop 1
  v_permlane32_swap_b32 v168, v169
  v_add_f32 v168, v168, v169
  s_cmp_eq_u32 s46, 0
  s_cbranch_scc1 L_st_17
  buffer_store_dword v168, v240, s[36:39], s53 offen
  s_branch L_st_17_e
L_st_17:
  buffer_store_dword v168, v240, s[36:39], s53 offen sc0 sc1
L_st_17_e:
  s_waitcnt vmcnt(0)
  s_or_b32 s70, s44, 2
  v_mov_b32 v236, s70
  v_mov_b32 v237, s45
  v_mov_b32 v238, 0
  s_mov_b64 exec, 1
  s_cmp_eq_u32 s46, 0
  s_cbranch_scc1 L_fs_18
  buffer_store_dwordx2 v[236:237], v238, s[36:39], s54 offen
  s_branch L_fs_18_e
L_fs_18:
  buffer_store_dwordx2 v[236:237], v238, s[36:39], s54 offen sc0 sc1
L_fs_18_e:
  s_mov_b64 exec, -1
  s_barrier
  s_lshl_b32 s56, s42, 8
  s_mul_i32 s57, s40, 28672
  s_add_u32 s56, s56, s57
  s_add_u32 s56, s56, 917504
  s_lshl_b32 s57, s40, 10
  s_add_u32 s57, s57, 131072
  s_add_u32 s58, s93, 0
  s_and_b32 s58, s58, 7
  s_lshl_b32 s81, s58, 12
  s_add_u32 m0, s81, s57
  s_mul_i32 s58, s58, 114688
  s_add_u32 s58, s58, s56
  buffer_load_dwordx4 v246, s[20:23], s58 offen lds
  s_add_u32 s58, s93, 1
  s_and_b32 s58, s58, 7
  s_lshl_b32 s81, s58, 12
  s_add_u32 m0, s81, s57
  s_mul_i32 s58, s58, 114688
  s_add_u32 s58, s58, s56
  buffer_load_dwordx4 v246, s[20:23], s58 offen lds
  s_add_u32 s58, s93, 2
  s_and_b32 s58, s58, 7
  s_lshl_b32 s81, s58, 12
  s_add_u32 m0, s81, s57
  s_mul_i32 s58, s58, 114688
  s_add_u32 s58, s58, s56
  buffer_load_dwordx4 v246, s[20:23], s58 offen lds
  s_add_u32 s58, s93, 3
  s_and_b32 s58, s58, 7
  s_lshl_b32 s81, s58, 12
  s_add_u32 m0, s81, s57
  s_mul_i32 s58, s58, 114688
  s_add_u32 s58, s58, s56
  buffer_load_dwordx4 v246, s[20:23], s58 offen lds
  s_add_u32 s58, s93, 4
  s_and_b32 s58, s58, 7
  s_lshl_b32 s81, s58, 12
  s_add_u32 m0, s81, s57
  s_mul_i32 s58, s58, 114688
  s_add_u32 s58, s58, s56
  buffer_load_dwordx4 v246, s[20:23], s58 offen lds
  s_add_u32 s58, s93, 5
  s_and_b32 s58, s58, 7
  s_lshl_b32 s81, s58, 12
  s_add_u32 m0, s81, s57
  s_mul_i32 s58, s58, 114688
  s_add_u32 s58, s58, s56
  buffer_load_dwordx4 v246, s[20:23], s58 offen lds
  s_add_u32 s58, s93, 6
  s_and_b32 s58, s58, 7
  s_lshl_b32 s81, s58, 12
  s_add_u32 m0, s81, s57
  s_mul_i32 s58, s58, 114688
  s_add_u32 s58, s58, s56
  buffer_load_dwordx4 v246, s[20:23], s58 offen lds
  s_add_u32 s58, s93, 7
  s_and_b32 s58, s58, 7
  s_lshl_b32 s81, s58, 12
  s_add_u32 m0, s81, s57
  s_mul_i32 s58, s58, 114688
  s_add_u32 s58, s58, s56
  buffer_load_dwordx4 v246, s[20:23], s58 offen lds
  s_cmp_ge_u32 s42, 14
  s_cbranch_scc1 L_p3skip0
  v_add_u32 v224, 98304, v252
  v_add_u32 v225, 98304, v251
  v_add_u32 v226, 131072, v252
  v_add_u32 v227, 131072, v251
  s_and_b32 s74, s40, 1
  s_lshl_b32 s74, s74, 1
  s_lshl_b32 s63, 0x33333333, s74
  s_cmp_lt_u32 s40, 2
  s_cselect_b32 s64, s63, 0
  s_cselect_b32 s65, 0, s63
  s_lshl_b32 s71, s41, 9
  s_add_u32 s71, s71, 0
  s_or_b32 s70, s44, 2
  s_mov_b32 s68, s64
  s_mov_b32 s69, s65
  s_mov_b32 s80, 0
L_poll_19:
  buffer_load_dwordx2 v[236:237], v248, s[36:39], s71 offen sc1
  s_add_u32 s80, s80, 1
  s_cmp_gt_u32 s80, 0x40000
  s_cbranch_scc1 L_poll_19_x
  s_waitcnt vmcnt(0)
  v_subrev_u32 v236, s70, v236
  v_cmp_ge_u32 vcc, 13, v236
  v_cmp_eq_u32 s[66:67], s45, v237
  s_and_b64 vcc, vcc, s[66:67]
  s_andn2_b64 s[66:67], s[68:69], vcc
  s_cbranch_scc1 L_poll_19
L_poll_19_x:
  s_waitcnt vmcnt(0)
  s_barrier
  s_lshl_b32 s75, s41, 2
  s_add_u32 s75, s75, s40
  s_mul_i32 s75, s75, 33280
  s_add_u32 s75, s75, 4194304
  s_lshl_b32 s77, s41, 2
  s_add_u32 s77, s77, s40
  s_mul_i32 s77, s77, 4096
  s_add_u32 s77, s77, 65536
  buffer_load_dwordx4 v[160:163], v255, s[36:39], s77 offen offset:0 sc1
  buffer_load_dwordx4 v[164:167], v255, s[36:39], s77 offen offset:1024 sc1
  buffer_load_dwordx4 v[168:171], v255, s[36:39], s77 offen offset:2048 sc1
  buffer_load_dwordx4 v[172:175], v255, s[36:39], s77 offen offset:3072 sc1
  s_mov_b32 s59, s75
  s_lshl_b32 s55, s41, 2
  s_add_u32 s55, s55, s40
  s_mul_i32 s55, s55, 115200
  s_lshl_b32 s76, s42, 13
  s_add_u32 s55, s55, s76
  s_add_u32 s55, s55, 6815744
  buffer_load_dwordx4 v[0:3], v255, s[36:39], s59 offen offset:0 sc1
  buffer_load_dwordx4 v[4:7], v255, s[36:39], s59 offen offset:1024 sc1
  buffer_load_dwordx4 v[8:11], v255, s[36:39], s59 offen offset:2048 sc1
  buffer_load_dwordx4 v[12:15], v255, s[36:39], s59 offen offset:3072 sc1
  s_add_u32 s59, s59, 4096
  buffer_load_dwordx4 v[16:19], v255, s[36:39], s59 offen offset:0 sc1
  buffer_load_dwordx4 v[20:23], v255, s[36:39], s59 offen offset:1024 sc1
  buffer_load_dwordx4 v[24:27], v255, s[36:39], s59 offen offset:2048 sc1
  buffer_load_dwordx4 v[28:31], v255, s[36:39], s59 offen offset:3072 sc1
  s_add_u32 s59, s59, 4096
  buffer_load_dwordx4 v[32:35], v255, s[36:39], s59 offen offset:0 sc1
  ds_read_b64_tr_b16 v[192:193], v224 offset:0
  ds_read_b64_tr_b16 v[194:195], v224 offset:512
  ds_read_b64_tr_b16 v[196:197], v225 offset:0
  ds_read_b64_tr_b16 v[198:199], v225 offset:512
  ds_read_b64_tr_b16 v[200:201], v224 offset:1024
  ds_read_b64_tr_b16 v[202:203], v224 offset:1536
  ds_read_b64_tr_b16 v[204:205], v225 offset:1024
  ds_read_b64_tr_b16 v[206:207], v225 offset:1536
  s_waitcnt vmcnt(8)
  s_waitcnt lgkmcnt(4)
  v_mfma_f32_32x32x16_bf16 v[128:143], v[192:195], v[0:3], 0
  v_add_f32 v160, v160, v162
  v_add_f32 v161, v161, v163
  ds_read_b64_tr_b16 v[208:209], v224 offset:4096
  ds_read_b64_tr_b16 v[210:211], v224 offset:4608
  ds_read_b64_tr_b16 v[212:213], v225 offset:4096
  ds_read_b64_tr_b16 v[214:215], v225 offset:4608
  v_mfma_f32_32x32x16_bf16 v[144:159], v[196:199], v[0:3], 0
  v_add_f32 v160, v160, v164
  v_add_f32 v161, v161, v165
  v_add_f32 v160, v160, v166
  v_add_f32 v161, v161, v167
  v_add_f32 v160, v160, v168
  buffer_load_dwordx4 v[36:39], v255, s[36:39], s59 offen offset:1024 sc1
  s_waitcnt vmcnt(8)
  s_waitcnt lgkmcnt(4)
  v_mfma_f32_32x32x16_bf16 v[128:143], v[200:203], v[4:7], v[128:143]
  v_add_f32 v161, v161, v169
  v_add_f32 v160, v160, v170
  ds_read_b64_tr_b16 v[192:193], v224 offset:5120
  ds_read_b64_tr_b16 v[194:195], v224 offset:5632
  ds_read_b64_tr_b16 v[196:197], v225 offset:5120
  ds_read_b64_tr_b16 v[198:199], v225 offset:5632
  v_mfma_f32_32x32x16_bf16 v[144:159], v[204:207], v[4:7], v[144:159]
  v_add_f32 v161, v161, v171
  v_add_f32 v160, v160, v172
  v_add_f32 v161, v161, v173
  v_add_f32 v160, v160, v174
  v_add_f32 v161, v161, v175
  buffer_load_dwordx4 v[40:43], v255, s[36:39], s59 offen offset:2048 sc1
  s_waitcnt vmcnt(8)
  s_waitcnt lgkmcnt(4)
  v_mfma_f32_32x32x16_bf16 v[128:143], v[208:211], v[8:11], v[128:143]
  v_permlane32_swap_b32 v160, v161
  ds_read_b64_tr_b16 v[200:201], v224 offset:8192
  ds_read_b64_tr_b16 v[202:203], v224 offset:8704
  ds_read_b64_tr_b16 v[204:205], v225 offset:8192
  ds_read_b64_tr_b16 v[206:207], v225 offset:8704
  v_mfma_f32_32x32x16_bf16 v[144:159], v[212:215], v[8:11], v[144:159]
  v_add_f32 v160, v160, v161
  v_mov_b32 v161, v160
  s_nop 1
  v_permlane32_swap_b32 v160, v161
  v_mul_f32 v160, 0x3b000000, v160
  buffer_load_dwordx4 v[44:47], v255, s[36:39], s59 offen offset:3072 sc1
  s_waitcnt vmcnt(8)
  s_waitcnt lgkmcnt(4)
  v_mfma_f32_32x32x16_bf16 v[128:143], v[192:195], v[12:15], v[128:143]
  v_mul_f32 v161, 0x3b000000, v161
  v_fma_f32 v161, -v160, v160, v161
  ds_read_b64_tr_b16 v[208:209], v224 offset:9216
  ds_read_b64_tr_b16 v[210:211], v224 offset:9728
  ds_read_b64_tr_b16 v[212:213], v225 offset:9216
  ds_read_b64_tr_b16 v[214:215], v225 offset:9728
  v_mfma_f32_32x32x16_bf16 v[144:159], v[196:199], v[12:15], v[144:159]
  v_max_f32 v161, 0, v161
  v_add_f32 v161, 0x3727c5ac, v161
  v_rsq_f32 v233, v161
  s_add_u32 s59, s59, 4096
  buffer_load_dwordx4 v[48:51], v255, s[36:39], s59 offen offset:0 sc1
  s_waitcnt vmcnt(8)
  s_waitcnt lgkmcnt(4)
  v_mfma_f32_32x32x16_bf16 v[128:143], v[200:203], v[16:19], v[128:143]
  v_mul_f32 v232, 0x3fb8aa3b, v233
  v_sub_f32 v234, 0, v160
  ds_read_b64_tr_b16 v[192:193], v224 offset:12288
  ds_read_b64_tr_b16 v[194:195], v224 offset:12800
  ds_read_b64_tr_b16 v[196:197], v225 offset:12288
  ds_read_b64_tr_b16 v[198:199], v225 offset:12800
  v_mfma_f32_32x32x16_bf16 v[144:159], v[204:207], v[16:19], v[144:159]
  v_cvt_pk_bf16_f32 v228, v234, v234
  v_and_b32 v235, 0xffff0000, v228
  v_sub_f32 v235, v234, v235
  v_cvt_pk_bf16_f32 v229, v235, 0
  v_cndmask_b32 v228, 0, v228, s[48:49]
  buffer_load_dwordx4 v[52:55], v255, s[36:39], s59 offen offset:1024 sc1
  s_waitcnt vmcnt(8)
  s_waitcnt lgkmcnt(4)
  v_mfma_f32_32x32x16_bf16 v[128:143], v[208:211], v[20:23], v[128:143]
  v_cndmask_b32 v229, 0, v229, s[48:49]
  v_mov_b32 v230, 0
  ds_read_b64_tr_b16 v[200:201], v224 offset:13312
  ds_read_b64_tr_b16 v[202:203], v224 offset:13824
  ds_read_b64_tr_b16 v[204:205], v225 offset:13312
  ds_read_b64_tr_b16 v[206:207], v225 offset:13824
  v_mfma_f32_32x32x16_bf16 v[144:159], v[212:215], v[20:23], v[144:159]
  v_mov_b32 v231, 0
  buffer_load_dwordx4 v[56:59], v255, s[36:39], s59 offen offset:2048 sc1
  s_waitcnt vmcnt(8)
  s_waitcnt lgkmcnt(4)
  v_mfma_f32_32x32x16_bf16 v[128:143], v[192:195], v[24:27], v[128:143]
  ds_read_b64_tr_b16 v[208:209], v224 offset:16384
  ds_read_b64_tr_b16 v[210:211], v224 offset:16896
  ds_read_b64_tr_b16 v[212:213], v225 offset:16384
  ds_read_b64_tr_b16 v[214:215], v225 offset:16896
  v_mfma_f32_32x32x16_bf16 v[144:159], v[196:199], v[24:27], v[144:159]
  buffer_load_dwordx4 v[60:63], v255, s[36:39], s59 offen offset:3072 sc1
  s_waitcnt vmcnt(8)
  s_waitcnt lgkmcnt(4)
  v_mfma_f32_32x32x16_bf16 v[128:143], v[200:203], v[28:31], v[128:143]
  ds_read_b64_tr_b16 v[192:193], v224 offset:17408
  ds_read_b64_tr_b16 v[194:195], v224 offset:17920
  ds_read_b64_tr_b16 v[196:197], v225 offset:17408
  ds_read_b64_tr_b16 v[198:199], v225 offset:17920
  v_mfma_f32_32x32x16_bf16 v[144:159], v[204:207], v[28:31], v[144:159]
  s_add_u32 s59, s59, 4096
  buffer_load_dwordx4 v[64:67], v255, s[36:39], s59 offen offset:0 sc1
  s_waitcnt vmcnt(8)
  s_waitcnt lgkmcnt(4)
  v_mfma_f32_32x32x16_bf16 v[128:143], v[208:211], v[32:35], v[128:143]
  ds_read_b64_tr_b16 v[200:201], v224 offset:20480
  ds_read_b64_tr_b16 v[202:203], v224 offset:20992
  ds_read_b64_tr_b16 v[204:205], v225 offset:20480
  ds_read_b64_tr_b16 v[206:207], v225 offset:20992
  v_mfma_f32_32x32x16_bf16 v[144:159], v[212:215], v[32:35], v[144:159]
  buffer_load_dwordx4 v[68:71], v255, s[36:39], s59 offen offset:1024 sc1
  s_waitcnt vmcnt(8)
  s_waitcnt lgkmcnt(4)
  v_mfma_f32_32x32x16_bf16 v[128:143], v[192:195], v[36:39], v[128:143]
  ds_read_b64_tr_b16 v[208:209], v224 offset:21504
  ds_read_b64_tr_b16 v[210:211], v224 offset:22016
  ds_read_b64_tr_b16 v[212:213], v225 offset:21504
  ds_read_b64_tr_b16 v[214:215], v225 offset:22016
  v_mfma_f32_32x32x16_bf16 v[144:159], v[196:199], v[36:39], v[144:159]
  buffer_load_dwordx4 v[72:75], v255, s[36:39], s59 offen offset:2048 sc1
  s_waitcnt vmcnt(8)
  s_waitcnt lgkmcnt(4)
  v_mfma_f32_32x32x16_bf16 v[128:143], v[200:203], v[40:43], v[128:143]
  ds_read_b64_tr_b16 v[192:193], v224 offset:24576
  ds_read_b64_tr_b16 v[194:195], v224 offset:25088
  ds_read_b64_tr_b16 v[196:197], v225 offset:24576
  ds_read_b64_tr_b16 v[198:199], v225 offset:25088
  v_mfma_f32_32x32x16_bf16 v[144:159], v[204:207], v[40:43], v[144:159]
  buffer_load_dwordx4 v[76:79], v255, s[36:39], s59 offen offset:3072 sc1
  s_waitcnt vmcnt(8)
  s_waitcnt lgkmcnt(4)
  v_mfma_f32_32x32x16_bf16 v[128:143], v[208:211], v[44:47], v[128:143]
  ds_read_b64_tr_b16 v[200:201], v224 offset:25600
  ds_read_b64_tr_b16 v[202:203], v224 offset:26112
  ds_read_b64_tr_b16 v[204:205], v225 offset:25600
  ds_read_b64_tr_b16 v[206:207], v225 offset:26112
  v_mfma_f32_32x32x16_bf16 v[144:159], v[212:215], v[44:47], v[144:159]
  s_add_u32 s59, s59, 4096
  buffer_load_dwordx4 v[80:83], v255, s[36:39], s59 offen offset:0 sc1
  s_waitcnt vmcnt(8)
  s_waitcnt lgkmcnt(4)
  v_mfma_f32_32x32x16_bf16 v[128:143], v[192:195], v[48:51], v[128:143]
  ds_read_b64_tr_b16 v[208:209], v224 offset:28672
  ds_read_b64_tr_b16 v[210:211], v224 offset:29184
  ds_read_b64_tr_b16 v[212:213], v225 offset:28672
  ds_read_b64_tr_b16 v[214:215], v225 offset:29184
  v_mfma_f32_32x32x16_bf16 v[144:159], v[196:199], v[48:51], v[144:159]
  buffer_load_dwordx4 v[84:87], v255, s[36:39], s59 offen offset:1024 sc1
  s_waitcnt vmcnt(8)
  s_waitcnt lgkmcnt(4)
  v_mfma_f32_32x32x16_bf16 v[128:143], v[200:203], v[52:55], v[128:143]
  ds_read_b64_tr_b16 v[192:193], v224 offset:29696
  ds_read_b64_tr_b16 v[194:195], v224 offset:30208
  ds_read_b64_tr_b16 v[196:197], v225 offset:29696
  ds_read_b64_tr_b16 v[198:199], v225 offset:30208
  v_mfma_f32_32x32x16_bf16 v[144:159], v[204:207], v[52:55], v[144:159]
  buffer_load_dwordx4 v[88:91], v255, s[36:39], s59 offen offset:2048 sc1
  s_waitcnt vmcnt(8)
  s_waitcnt lgkmcnt(4)
  v_mfma_f32_32x32x16_bf16 v[128:143], v[208:211], v[56:59], v[128:143]
  v_mfma_f32_32x32x16_bf16 v[144:159], v[212:215], v[56:59], v[144:159]
  buffer_load_dwordx4 v[92:95], v255, s[36:39], s59 offen offset:3072 sc1
  s_waitcnt vmcnt(8)
  s_waitcnt lgkmcnt(0)
  v_mfma_f32_32x32x16_bf16 v[128:143], v[192:195], v[60:63], v[128:143]
  v_mfma_f32_32x32x16_bf16 v[144:159], v[196:199], v[60:63], v[144:159]
  s_add_u32 s59, s59, 4096
  buffer_load_dwordx4 v[96:99], v255, s[36:39], s59 offen offset:0 sc1
  s_barrier
  s_lshl_b32 s56, s42, 8
  s_mul_i32 s57, s40, 28672
  s_add_u32 s56, s56, s57
  s_add_u32 s56, s56, 128
  s_lshl_b32 s57, s40, 10
  s_add_u32 s57, s57, 98304
  ds_read_b64_tr_b16 v[192:193], v226 offset:0
  ds_read_b64_tr_b16 v[194:195], v226 offset:512
  ds_read_b64_tr_b16 v[196:197], v227 offset:0
  ds_read_b64_tr_b16 v[198:199], v227 offset:512
  ds_read_b64_tr_b16 v[200:201], v226 offset:1024
  ds_read_b64_tr_b16 v[202:203], v226 offset:1536
  ds_read_b64_tr_b16 v[204:205], v227 offset:1024
  ds_read_b64_tr_b16 v[206:207], v227 offset:1536
  s_waitcnt vmcnt(8)
  s_waitcnt lgkmcnt(4)
  v_mfma_f32_32x32x16_bf16 v[128:143], v[192:195], v[64:67], v[128:143]
  ds_read_b64_tr_b16 v[208:209], v226 offset:4096
  ds_read_b64_tr_b16 v[210:211], v226 offset:4608
  ds_read_b64_tr_b16 v[212:213], v227 offset:4096
  ds_read_b64_tr_b16 v[214:215], v227 offset:4608
  v_mfma_f32_32x32x16_bf16 v[144:159], v[196:199], v[64:67], v[144:159]
  s_add_u32 s58, s93, 0
  s_and_b32 s58, s58, 7
  s_lshl_b32 s81, s58, 12
  s_add_u32 m0, s81, s57
  s_mul_i32 s58, s58, 114688
  s_add_u32 s58, s58, s56
  buffer_load_dwordx4 v246, s[20:23], s58 offen lds
  s_add_u32 s58, s93, 1
  s_and_b32 s58, s58, 7
  s_lshl_b32 s81, s58, 12
  s_add_u32 m0, s81, s57
  s_mul_i32 s58, s58, 114688
  s_add_u32 s58, s58, s56
  buffer_load_dwordx4 v246, s[20:23], s58 offen lds
  buffer_load_dwordx4 v[100:103], v255, s[36:39], s59 offen offset:1024 sc1
  s_waitcnt vmcnt(10)
  s_waitcnt lgkmcnt(4)
  v_mfma_f32_32x32x16_bf16 v[128:143], v[200:203], v[68:71], v[128:143]
  ds_read_b64_tr_b16 v[192:193], v226 offset:5120
  ds_read_b64_tr_b16 v[194:195], v226 offset:5632
  ds_read_b64_tr_b16 v[196:197], v227 offset:5120
  ds_read_b64_tr_b16 v[198:199], v227 offset:5632
  v_mfma_f32_32x32x16_bf16 v[144:159], v[204:207], v[68:71], v[144:159]
  s_add_u32 s58, s93, 2
  s_and_b32 s58, s58, 7
  s_lshl_b32 s81, s58, 12
  s_add_u32 m0, s81, s57
  s_mul_i32 s58, s58, 114688
  s_add_u32 s58, s58, s56
  buffer_load_dwordx4 v246, s[20:23], s58 offen lds
  s_add_u32 s58, s93, 3
  s_and_b32 s58, s58, 7
  s_lshl_b32 s81, s58, 12
  s_add_u32 m0, s81, s57
  s_mul_i32 s58, s58, 114688
  s_add_u32 s58, s58, s56
  buffer_load_dwordx4 v246, s[20:23], s58 offen lds
  buffer_load_dwordx4 v[104:107], v255, s[36:39], s59 offen offset:2048 sc1
  s_waitcnt vmcnt(12)
  s_waitcnt lgkmcnt(4)
  v_mfma_f32_32x32x16_bf16 v[128:143], v[208:211], v[72:75], v[128:143]
  ds_read_b64_tr_b16 v[200:201], v226 offset:8192
  ds_read_b64_tr_b16 v[202:203], v226 offset:8704
  ds_read_b64_tr_b16 v[204:205], v227 offset:8192
  ds_read_b64_tr_b16 v[206:207], v227 offset:8704
  v_mfma_f32_32x32x16_bf16 v[144:159], v[212:215], v[72:75], v[144:159]
  s_add_u32 s58, s93, 4
  s_and_b32 s58, s58, 7
  s_lshl_b32 s81, s58, 12
  s_add_u32 m0, s81, s57
  s_mul_i32 s58, s58, 114688
  s_add_u32 s58, s58, s56
  buffer_load_dwordx4 v246, s[20:23], s58 offen lds
  s_add_u32 s58, s93, 5
  s_and_b32 s58, s58, 7
  s_lshl_b32 s81, s58, 12
  s_add_u32 m0, s81, s57
  s_mul_i32 s58, s58, 114688
  s_add_u32 s58, s58, s56
  buffer_load_dwordx4 v246, s[20:23], s58 offen lds
  buffer_load_dwordx4 v[108:111], v255, s[36:39], s59 offen offset:3072 sc1
  s_waitcnt vmcnt(14)
  s_waitcnt lgkmcnt(4)
  v_mfma_f32_32x32x16_bf16 v[128:143], v[192:195], v[76:79], v[128:143]
  ds_read_b64_tr_b16 v[208:209], v226 offset:9216
  ds_read_b64_tr_b16 v[210:211], v226 offset:9728
  ds_read_b64_tr_b16 v[212:213], v227 offset:9216
  ds_read_b64_tr_b16 v[214:215], v227 offset:9728
  v_mfma_f32_32x32x16_bf16 v[144:159], v[196:199], v[76:79], v[144:159]
  s_add_u32 s58, s93, 6
  s_and_b32 s58, s58, 7
  s_lshl_b32 s81, s58, 12
  s_add_u32 m0, s81, s57
  s_mul_i32 s58, s58, 114688
  s_add_u32 s58, s58, s56
  buffer_load_dwordx4 v246, s[20:23], s58 offen lds
  s_add_u32 s58, s93, 7
  s_and_b32 s58, s58, 7
  s_lshl_b32 s81, s58, 12
  s_add_u32 m0, s81, s57
  s_mul_i32 s58, s58, 114688
  s_add_u32 s58, s58, s56
  buffer_load_dwordx4 v246, s[20:23], s58 offen lds
  s_add_u32 s59, s59, 4096
  buffer_load_dwordx4 v[112:115], v255, s[36:39], s59 offen offset:0 sc1
  s_waitcnt vmcnt(16)
  s_waitcnt lgkmcnt(4)
  v_mfma_f32_32x32x16_bf16 v[128:143], v[200:203], v[80:83], v[128:143]
  ds_read_b64_tr_b16 v[192:193], v226 offset:12288
  ds_read_b64_tr_b16 v[194:195], v226 offset:12800
  ds_read_b64_tr_b16 v[196:197], v227 offset:12288
  ds_read_b64_tr_b16 v[198:199], v227 offset:12800
  v_mfma_f32_32x32x16_bf16 v[144:159], v[204:207], v[80:83], v[144:159]
  buffer_load_dwordx4 v[116:119], v255, s[36:39], s59 offen offset:1024 sc1
  s_waitcnt vmcnt(16)
  s_waitcnt lgkmcnt(4)
  v_mfma_f32_32x32x16_bf16 v[128:143], v[208:211], v[84:87], v[128:143]
  ds_read_b64_tr_b16 v[200:201], v226 offset:13312
  ds_read_b64_tr_b16 v[202:203], v226 offset:13824
  ds_read_b64_tr_b16 v[204:205], v227 offset:13312
  ds_read_b64_tr_b16 v[206:207], v227 offset:13824
  v_mfma_f32_32x32x16_bf16 v[144:159], v[212:215], v[84:87], v[144:159]
  buffer_load_dwordx4 v[120:123], v255, s[36:39], s59 offen offset:2048 sc1
  s_waitcnt vmcnt(16)
  s_waitcnt lgkmcnt(4)
  v_mfma_f32_32x32x16_bf16 v[128:143], v[192:195], v[88:91], v[128:143]
  ds_read_b64_tr_b16 v[208:209], v226 offset:16384
  ds_read_b64_tr_b16 v[210:211], v226 offset:16896
  ds_read_b64_tr_b16 v[212:213], v227 offset:16384
  ds_read_b64_tr_b16 v[214:215], v227 offset:16896
  v_mfma_f32_32x32x16_bf16 v[144:159], v[196:199], v[88:91], v[144:159]
  buffer_load_dwordx4 v[124:127], v255, s[36:39], s59 offen offset:3072 sc1
  s_waitcnt vmcnt(16)
  s_waitcnt lgkmcnt(4)
  v_mfma_f32_32x32x16_bf16 v[128:143], v[200:203], v[92:95], v[128:143]
  ds_read_b64_tr_b16 v[192:193], v226 offset:17408
  ds_read_b64_tr_b16 v[194:195], v226 offset:17920
  ds_read_b64_tr_b16 v[196:197], v227 offset:17408
  ds_read_b64_tr_b16 v[198:199], v227 offset:17920
  v_mfma_f32_32x32x16_bf16 v[144:159], v[204:207], v[92:95], v[144:159]
  s_waitcnt vmcnt(15)
  s_waitcnt lgkmcnt(4)
  v_mfma_f32_32x32x16_bf16 v[128:143], v[208:211], v[96:99], v[128:143]
  ds_read_b64_tr_b16 v[200:201], v226 offset:20480
  ds_read_b64_tr_b16 v[202:203], v226 offset:20992
  ds_read_b64_tr_b16 v[204:205], v227 offset:20480
  ds_read_b64_tr_b16 v[206:207], v227 offset:20992
  v_mfma_f32_32x32x16_bf16 v[144:159], v[212:215], v[96:99], v[144:159]
  s_waitcnt vmcnt(12)
  s_waitcnt lgkmcnt(4)
  v_mfma_f32_32x32x16_bf16 v[128:143], v[192:195], v[100:103], v[128:143]
  ds_read_b64_tr_b16 v[208:209], v226 offset:21504
  ds_read_b64_tr_b16 v[210:211], v226 offset:22016
  ds_read_b64_tr_b16 v[212:213], v227 offset:21504
  ds_read_b64_tr_b16 v[214:215], v227 offset:22016
  v_mfma_f32_32x32x16_bf16 v[144:159], v[196:199], v[100:103], v[144:159]
  s_waitcnt vmcnt(9)
  s_waitcnt lgkmcnt(4)
  v_mfma_f32_32x32x16_bf16 v[128:143], v[200:203], v[104:107], v[128:143]
  ds_read_b64_tr_b16 v[192:193], v226 offset:24576
  ds_read_b64_tr_b16 v[194:195], v226 offset:25088
  ds_read_b64_tr_b16 v[196:197], v227 offset:24576
  ds_read_b64_tr_b16 v[198:199], v227 offset:25088
  v_mfma_f32_32x32x16_bf16 v[144:159], v[204:207], v[104:107], v[144:159]
  v_mfma_f32_32x32x16_bf16 v[128:143], a[246:249], v[228:231], v[128:143]
  v_mfma_f32_32x32x16_bf16 v[144:159], a[248:251], v[228:231], v[144:159]
  s_waitcnt vmcnt(6)
  s_waitcnt lgkmcnt(4)
  v_mfma_f32_32x32x16_bf16 v[128:143], v[208:211], v[108:111], v[128:143]
  ds_read_b64_tr_b16 v[200:201], v226 offset:25600
  ds_read_b64_tr_b16 v[202:203], v226 offset:26112
  ds_read_b64_tr_b16 v[204:205], v227 offset:25600
  ds_read_b64_tr_b16 v[206:207], v227 offset:26112
  v_mfma_f32_32x32x16_bf16 v[144:159], v[212:215], v[108:111], v[144:159]
  s_waitcnt vmcnt(3)
  s_waitcnt lgkmcnt(4)
  v_mfma_f32_32x32x16_bf16 v[128:143], v[192:195], v[112:115], v[128:143]
  ds_read_b64_tr_b16 v[208:209], v226 offset:28672
  ds_read_b64_tr_b16 v[210:211], v226 offset:29184
  ds_read_b64_tr_b16 v[212:213], v227 offset:28672
  ds_read_b64_tr_b16 v[214:215], v227 offset:29184
  v_mfma_f32_32x32x16_bf16 v[144:159], v[196:199], v[112:115], v[144:159]
  s_waitcnt vmcnt(2)
  s_waitcnt lgkmcnt(4)
  v_mfma_f32_32x32x16_bf16 v[128:143], v[200:203], v[116:119], v[128:143]
  ds_read_b64_tr_b16 v[192:193], v226 offset:29696
  ds_read_b64_tr_b16 v[194:195], v226 offset:30208
  ds_read_b64_tr_b16 v[196:197], v227 offset:29696
  ds_read_b64_tr_b16 v[198:199], v227 offset:30208
  v_mfma_f32_32x32x16_bf16 v[144:159], v[204:207], v[116:119], v[144:159]
  s_waitcnt vmcnt(1)
  s_waitcnt lgkmcnt(4)
  v_mfma_f32_32x32x16_bf16 v[128:143], v[208:211], v[120:123], v[128:143]
  v_mfma_f32_32x32x16_bf16 v[144:159], v[212:215], v[120:123], v[144:159]
  s_waitcnt vmcnt(0)
  s_waitcnt lgkmcnt(0)
  v_mfma_f32_32x32x16_bf16 v[128:143], v[192:195], v[124:127], v[128:143]
  v_mfma_f32_32x32x16_bf16 v[144:159], v[196:199], v[124:127], v[144:159]
  s_waitcnt vmcnt(0)
  s_barrier
  s_lshl_b32 s86, s42, 8
  s_mul_i32 s87, s40, 28672
  s_add_u32 s86, s86, s87
  s_add_u32 s86, s86, 917632
  s_lshl_b32 s87, s40, 10
  s_add_u32 s87, s87, 131072
  ds_read_b64_tr_b16 v[192:193], v224 offset:0
  ds_read_b64_tr_b16 v[194:195], v224 offset:512
  ds_read_b64_tr_b16 v[196:197], v225 offset:0
  ds_read_b64_tr_b16 v[198:199], v225 offset:512
  ds_read_b64_tr_b16 v[200:201], v224 offset:1024
  ds_read_b64_tr_b16 v[202:203], v224 offset:1536
  ds_read_b64_tr_b16 v[204:205], v225 offset:1024
  ds_read_b64_tr_b16 v[206:207], v225 offset:1536
  s_waitcnt lgkmcnt(4)
  v_mfma_f32_32x32x16_bf16 v[160:175], v[192:195], v[0:3], 0
  v_mul_f32 v216, v128, v232
  v_mul_f32 v217, v129, v232
  ds_read_b64_tr_b16 v[208:209], v224 offset:4096
  ds_read_b64_tr_b16 v[210:211], v224 offset:4608
  ds_read_b64_tr_b16 v[212:213], v225 offset:4096
  ds_read_b64_tr_b16 v[214:215], v225 offset:4608
  v_mfma_f32_32x32x16_bf16 v[176:191], v[196:199], v[0:3], 0
  s_add_u32 s88, s93, 0
  s_and_b32 s88, s88, 7
  s_lshl_b32 s81, s88, 12
  s_add_u32 m0, s81, s87
  s_mul_i32 s88, s88, 114688
  s_add_u32 s88, s88, s86
  buffer_load_dwordx4 v246, s[20:23], s88 offen lds
  s_add_u32 s88, s93, 1
  s_and_b32 s88, s88, 7
  s_lshl_b32 s81, s88, 12
  s_add_u32 m0, s81, s87
  s_mul_i32 s88, s88, 114688
  s_add_u32 s88, s88, s86
  buffer_load_dwordx4 v246, s[20:23], s88 offen lds
  buffer_load_dwordx4 a[144:147], v255, s[36:39], s84 offen offset:2048 sc1
  s_waitcnt lgkmcnt(4)
  v_mfma_f32_32x32x16_bf16 v[160:175], v[200:203], v[4:7], v[160:175]
  v_mul_f32 v218, v130, v232
  v_mul_f32 v219, v131, v232
  ds_read_b64_tr_b16 v[192:193], v224 offset:5120
  ds_read_b64_tr_b16 v[194:195], v224 offset:5632
  ds_read_b64_tr_b16 v[196:197], v225 offset:5120
  ds_read_b64_tr_b16 v[198:199], v225 offset:5632
  v_mfma_f32_32x32x16_bf16 v[176:191], v[204:207], v[4:7], v[176:191]
  s_add_u32 s88, s93, 2
  s_and_b32 s88, s88, 7
  s_lshl_b32 s81, s88, 12
  s_add_u32 m0, s81, s87
  s_mul_i32 s88, s88, 114688
  s_add_u32 s88, s88, s86
  buffer_load_dwordx4 v246, s[20:23], s88 offen lds
  s_add_u32 s88, s93, 3
  s_and_b32 s88, s88, 7
  s_lshl_b32 s81, s88, 12
  s_add_u32 m0, s81, s87
  s_mul_i32 s88, s88, 114688
  s_add_u32 s88, s88, s86
  buffer_load_dwordx4 v246, s[20:23], s88 offen lds
  buffer_load_dwordx4 a[152:155], v255, s[36:39], s84 offen offset:3072 sc1
  s_waitcnt lgkmcnt(4)
  v_mfma_f32_32x32x16_bf16 v[160:175], v[208:211], v[8:11], v[160:175]
  v_exp_f32 v216, -v216
  ds_read_b64_tr_b16 v[200:201], v224 offset:8192
  ds_read_b64_tr_b16 v[202:203], v224 offset:8704
  ds_read_b64_tr_b16 v[204:205], v225 offset:8192
  ds_read_b64_tr_b16 v[206:207], v225 offset:8704
  v_mfma_f32_32x32x16_bf16 v[176:191], v[212:215], v[8:11], v[176:191]
  s_add_u32 s88, s93, 4
  s_and_b32 s88, s88, 7
  s_lshl_b32 s81, s88, 12
  s_add_u32 m0, s81, s87
  s_mul_i32 s88, s88, 114688
  s_add_u32 s88, s88, s86
  buffer_load_dwordx4 v246, s[20:23], s88 offen lds
  s_add_u32 s88, s93, 5
  s_and_b32 s88, s88, 7
  s_lshl_b32 s81, s88, 12
  s_add_u32 m0, s81, s87
  s_mul_i32 s88, s88, 114688
  s_add_u32 s88, s88, s86
  buffer_load_dwordx4 v246, s[20:23], s88 offen lds
  s_add_u32 s84, s84, 4096
  buffer_load_dwordx4 a[160:163], v255, s[36:39], s84 offen offset:0 sc1
  s_waitcnt lgkmcnt(4)
  v_mfma_f32_32x32x16_bf16 v[160:175], v[192:195], v[12:15], v[160:175]
  v_exp_f32 v217, -v217
  ds_read_b64_tr_b16 v[208:209], v224 offset:9216
  ds_read_b64_tr_b16 v[210:211], v224 offset:9728
  ds_read_b64_tr_b16 v[212:213], v225 offset:9216
  ds_read_b64_tr_b16 v[214:215], v225 offset:9728
  v_mfma_f32_32x32x16_bf16 v[176:191], v[196:199], v[12:15], v[176:191]
  s_add_u32 s88, s93, 6
  s_and_b32 s88, s88, 7
  s_lshl_b32 s81, s88, 12
  s_add_u32 m0, s81, s87
  s_mul_i32 s88, s88, 114688
  s_add_u32 s88, s88, s86
  buffer_load_dwordx4 v246, s[20:23], s88 offen lds
  s_add_u32 s88, s93, 7
  s_and_b32 s88, s88, 7
  s_lshl_b32 s81, s88, 12
  s_add_u32 m0, s81, s87
  s_mul_i32 s88, s88, 114688
  s_add_u32 s88, s88, s86
  buffer_load_dwordx4 v246, s[20:23], s88 offen lds
  buffer_load_dwordx4 a[168:171], v255, s[36:39], s84 offen offset:1024 sc1
  s_waitcnt lgkmcnt(4)
  v_mfma_f32_32x32x16_bf16 v[160:175], v[200:203], v[16:19], v[160:175]
  v_exp_f32 v218, -v218
  ds_read_b64_tr_b16 v[192:193], v224 offset:12288
  ds_read_b64_tr_b16 v[194:195], v224 offset:12800
  ds_read_b64_tr_b16 v[196:197], v225 offset:12288
  ds_read_b64_tr_b16 v[198:199], v225 offset:12800
  v_mfma_f32_32x32x16_bf16 v[176:191], v[204:207], v[16:19], v[176:191]
  v_exp_f32 v219, -v219
  v_mul_f32 v128, v128, v233
  v_mul_f32 v129, v129, v233
  v_mul_f32 v130, v130, v233
  buffer_load_dwordx4 a[176:179], v255, s[36:39], s84 offen offset:2048 sc1
  s_waitcnt lgkmcnt(4)
  v_mfma_f32_32x32x16_bf16 v[160:175], v[208:211], v[20:23], v[160:175]
  v_mul_f32 v131, v131, v233
  v_add_f32 v216, 1.0, v216
  ds_read_b64_tr_b16 v[200:201], v224 offset:13312
  ds_read_b64_tr_b16 v[202:203], v224 offset:13824
  ds_read_b64_tr_b16 v[204:205], v225 offset:13312
  ds_read_b64_tr_b16 v[206:207], v225 offset:13824
  v_mfma_f32_32x32x16_bf16 v[176:191], v[212:215], v[20:23], v[176:191]
  v_add_f32 v217, 1.0, v217
  v_add_f32 v218, 1.0, v218
  v_add_f32 v219, 1.0, v219
  v_rcp_f32 v216, v216
  buffer_load_dwordx4 a[184:187], v255, s[36:39], s84 offen offset:3072 sc1
  s_waitcnt lgkmcnt(4)
  v_mfma_f32_32x32x16_bf16 v[160:175], v[192:195], v[24:27], v[160:175]
  v_rcp_f32 v217, v217
  ds_read_b64_tr_b16 v[208:209], v224 offset:16384
  ds_read_b64_tr_b16 v[210:211], v224 offset:16896
  ds_read_b64_tr_b16 v[212:213], v225 offset:16384
  ds_read_b64_tr_b16 v[214:215], v225 offset:16896
  v_mfma_f32_32x32x16_bf16 v[176:191], v[196:199], v[24:27], v[176:191]
  v_rcp_f32 v218, v218
  v_rcp_f32 v219, v219
  v_mul_f32 v128, v128, v216
  v_mul_f32 v129, v129, v217
  s_waitcnt lgkmcnt(4)
  v_mfma_f32_32x32x16_bf16 v[160:175], v[200:203], v[28:31], v[160:175]
  v_mul_f32 v130, v130, v218
  v_mul_f32 v131, v131, v219
  ds_read_b64_tr_b16 v[192:193], v224 offset:17408
  ds_read_b64_tr_b16 v[194:195], v224 offset:17920
  ds_read_b64_tr_b16 v[196:197], v225 offset:17408
  ds_read_b64_tr_b16 v[198:199], v225 offset:17920
  v_mfma_f32_32x32x16_bf16 v[176:191], v[204:207], v[28:31], v[176:191]
  v_cvt_pk_bf16_f32 v128, v128, v129
  v_cvt_pk_bf16_f32 v129, v130, v131
  v_mul_f32 v216, v132, v232
  v_mul_f32 v217, v133, v232
  v_mul_f32 v218, v134, v232
  v_mul_f32 v219, v135, v232
  s_waitcnt lgkmcnt(4)
  v_mfma_f32_32x32x16_bf16 v[160:175], v[208:211], v[32:35], v[160:175]
  v_exp_f32 v216, -v216
  ds_read_b64_tr_b16 v[200:201], v224 offset:20480
  ds_read_b64_tr_b16 v[202:203], v224 offset:20992
  ds_read_b64_tr_b16 v[204:205], v225 offset:20480
  ds_read_b64_tr_b16 v[206:207], v225 offset:20992
  v_mfma_f32_32x32x16_bf16 v[176:191], v[212:215], v[32:35], v[176:191]
  v_exp_f32 v217, -v217
  v_exp_f32 v218, -v218
  v_exp_f32 v219, -v219
  s_waitcnt lgkmcnt(4)
  v_mfma_f32_32x32x16_bf16 v[160:175], v[192:195], v[36:39], v[160:175]
  v_mul_f32 v132, v132, v233
  v_mul_f32 v133, v133, v233
  ds_read_b64_tr_b16 v[208:209], v224 offset:21504
  ds_read_b64_tr_b16 v[210:211], v224 offset:22016
  ds_read_b64_tr_b16 v[212:213], v225 offset:21504
  ds_read_b64_tr_b16 v[214:215], v225 offset:22016
  v_mfma_f32_32x32x16_bf16 v[176:191], v[196:199], v[36:39], v[176:191]
  v_mul_f32 v134, v134, v233
  v_mul_f32 v135, v135, v233
  v_add_f32 v216, 1.0, v216
  v_add_f32 v217, 1.0, v217
  v_add_f32 v218, 1.0, v218
  v_add_f32 v219, 1.0, v219
  s_waitcnt lgkmcnt(4)
  v_mfma_f32_32x32x16_bf16 v[160:175], v[200:203], v[40:43], v[160:175]
  v_rcp_f32 v216, v216
  ds_read_b64_tr_b16 v[192:193], v224 offset:24576
  ds_read_b64_tr_b16 v[194:195], v224 offset:25088
  ds_read_b64_tr_b16 v[196:197], v225 offset:24576
  ds_read_b64_tr_b16 v[198:199], v225 offset:25088
  v_mfma_f32_32x32x16_bf16 v[176:191], v[204:207], v[40:43], v[176:191]
  v_rcp_f32 v217, v217
  v_rcp_f32 v218, v218
  v_rcp_f32 v219, v219
  s_waitcnt lgkmcnt(4)
  v_mfma_f32_32x32x16_bf16 v[160:175], v[208:211], v[44:47], v[160:175]
  v_mul_f32 v132, v132, v216
  v_mul_f32 v133, v133, v217
  ds_read_b64_tr_b16 v[200:201], v224 offset:25600
  ds_read_b64_tr_b16 v[202:203], v224 offset:26112
  ds_read_b64_tr_b16 v[204:205], v225 offset:25600
  ds_read_b64_tr_b16 v[206:207], v225 offset:26112
  v_mfma_f32_32x32x16_bf16 v[176:191], v[212:215], v[44:47], v[176:191]
  v_mul_f32 v134, v134, v218
  v_mul_f32 v135, v135, v219
  v_cvt_pk_bf16_f32 v130, v132, v133
  v_cvt_pk_bf16_f32 v131, v134, v135
  v_mul_f32 v216, v136, v232
  v_mul_f32 v217, v137, v232
  s_waitcnt lgkmcnt(4)
  v_mfma_f32_32x32x16_bf16 v[160:175], v[192:195], v[48:51], v[160:175]
  v_mul_f32 v218, v138, v232
  v_mul_f32 v219, v139, v232
  ds_read_b64_tr_b16 v[208:209], v224 offset:28672
  ds_read_b64_tr_b16 v[210:211], v224 offset:29184
  ds_read_b64_tr_b16 v[212:213], v225 offset:28672
  ds_read_b64_tr_b16 v[214:215], v225 offset:29184
  v_mfma_f32_32x32x16_bf16 v[176:191], v[196:199], v[48:51], v[176:191]
  v_exp_f32 v216, -v216
  v_exp_f32 v217, -v217
  v_exp_f32 v218, -v218
  s_waitcnt lgkmcnt(4)
  v_mfma_f32_32x32x16_bf16 v[160:175], v[200:203], v[52:55], v[160:175]
  v_exp_f32 v219, -v219
  ds_read_b64_tr_b16 v[192:193], v224 offset:29696
  ds_read_b64_tr_b16 v[194:195], v224 offset:30208
  ds_read_b64_tr_b16 v[196:197], v225 offset:29696
  ds_read_b64_tr_b16 v[198:199], v225 offset:30208
  v_mfma_f32_32x32x16_bf16 v[176:191], v[204:207], v[52:55], v[176:191]
  v_mul_f32 v136, v136, v233
  v_mul_f32 v137, v137, v233
  v_mul_f32 v138, v138, v233
  v_mul_f32 v139, v139, v233
  v_add_f32 v216, 1.0, v216
  v_add_f32 v217, 1.0, v217
  s_waitcnt lgkmcnt(4)
  v_mfma_f32_32x32x16_bf16 v[160:175], v[208:211], v[56:59], v[160:175]
  v_add_f32 v218, 1.0, v218
  v_add_f32 v219, 1.0, v219
  v_rcp_f32 v216, v216
  v_rcp_f32 v217, v217
  v_mfma_f32_32x32x16_bf16 v[176:191], v[212:215], v[56:59], v[176:191]
  v_rcp_f32 v218, v218
  v_rcp_f32 v219, v219
  v_mul_f32 v136, v136, v216
  v_mul_f32 v137, v137, v217
  s_waitcnt lgkmcnt(0)
  v_mfma_f32_32x32x16_bf16 v[160:175], v[192:195], v[60:63], v[160:175]
  v_mul_f32 v138, v138, v218
  v_mul_f32 v139, v139, v219
  v_cvt_pk_bf16_f32 v132, v136, v137
  v_cvt_pk_bf16_f32 v133, v138, v139
  v_mul_f32 v216, v140, v232
  v_mul_f32 v217, v141, v232
  v_mfma_f32_32x32x16_bf16 v[176:191], v[196:199], v[60:63], v[176:191]
  s_waitcnt vmcnt(3)
  s_barrier
  ds_read_b64_tr_b16 v[192:193], v226 offset:0
  ds_read_b64_tr_b16 v[194:195], v226 offset:512
  ds_read_b64_tr_b16 v[196:197], v227 offset:0
  ds_read_b64_tr_b16 v[198:199], v227 offset:512
  ds_read_b64_tr_b16 v[200:201], v226 offset:1024
  ds_read_b64_tr_b16 v[202:203], v226 offset:1536
  ds_read_b64_tr_b16 v[204:205], v227 offset:1024
  ds_read_b64_tr_b16 v[206:207], v227 offset:1536
  s_waitcnt lgkmcnt(4)
  v_mfma_f32_32x32x16_bf16 v[160:175], v[192:195], v[64:67], v[160:175]
  v_mul_f32 v218, v142, v232
  v_mul_f32 v219, v143, v232
  ds_read_b64_tr_b16 v[208:209], v226 offset:4096
  ds_read_b64_tr_b16 v[210:211], v226 offset:4608
  ds_read_b64_tr_b16 v[212:213], v227 offset:4096
  ds_read_b64_tr_b16 v[214:215], v227 offset:4608
  v_mfma_f32_32x32x16_bf16 v[176:191], v[196:199], v[64:67], v[176:191]
  v_exp_f32 v216, -v216
  v_exp_f32 v217, -v217
  s_add_u32 s84, s84, 4096
  buffer_load_dwordx4 a[192:195], v255, s[36:39], s84 offen offset:0 sc1
  s_waitcnt lgkmcnt(4)
  v_mfma_f32_32x32x16_bf16 v[160:175], v[200:203], v[68:71], v[160:175]
  v_exp_f32 v218, -v218
  ds_read_b64_tr_b16 v[192:193], v226 offset:5120
  ds_read_b64_tr_b16 v[194:195], v226 offset:5632
  ds_read_b64_tr_b16 v[196:197], v227 offset:5120
  ds_read_b64_tr_b16 v[198:199], v227 offset:5632
  v_mfma_f32_32x32x16_bf16 v[176:191], v[204:207], v[68:71], v[176:191]
  v_exp_f32 v219, -v219
  v_mul_f32 v140, v140, v233
  v_mul_f32 v141, v141, v233
  v_mul_f32 v142, v142, v233
  buffer_load_dwordx4 a[200:203], v255, s[36:39], s84 offen offset:1024 sc1
  s_waitcnt lgkmcnt(4)
  v_mfma_f32_32x32x16_bf16 v[160:175], v[208:211], v[72:75], v[160:175]
  v_mul_f32 v143, v143, v233
  v_add_f32 v216, 1.0, v216
  ds_read_b64_tr_b16 v[200:201], v226 offset:8192
  ds_read_b64_tr_b16 v[202:203], v226 offset:8704
  ds_read_b64_tr_b16 v[204:205], v227 offset:8192
  ds_read_b64_tr_b16 v[206:207], v227 offset:8704
  v_mfma_f32_32x32x16_bf16 v[176:191], v[212:215], v[72:75], v[176:191]
  v_add_f32 v217, 1.0, v217
  v_add_f32 v218, 1.0, v218
  v_add_f32 v219, 1.0, v219
  v_rcp_f32 v216, v216
  buffer_load_dwordx4 a[208:211], v255, s[36:39], s84 offen offset:2048 sc1
  s_waitcnt lgkmcnt(4)
  v_mfma_f32_32x32x16_bf16 v[160:175], v[192:195], v[76:79], v[160:175]
  v_rcp_f32 v217, v217
  ds_read_b64_tr_b16 v[208:209], v226 offset:9216
  ds_read_b64_tr_b16 v[210:211], v226 offset:9728
  ds_read_b64_tr_b16 v[212:213], v227 offset:9216
  ds_read_b64_tr_b16 v[214:215], v227 offset:9728
  v_mfma_f32_32x32x16_bf16 v[176:191], v[196:199], v[76:79], v[176:191]
  v_rcp_f32 v218, v218
  v_rcp_f32 v219, v219
  v_mul_f32 v140, v140, v216
  buffer_load_dwordx4 a[216:219], v255, s[36:39], s84 offen offset:3072 sc1
  s_waitcnt lgkmcnt(4)
  v_mfma_f32_32x32x16_bf16 v[160:175], v[200:203], v[80:83], v[160:175]
  v_mul_f32 v141, v141, v217
  v_mul_f32 v142, v142, v218
  ds_read_b64_tr_b16 v[192:193], v226 offset:12288
  ds_read_b64_tr_b16 v[194:195], v226 offset:12800
  ds_read_b64_tr_b16 v[196:197], v227 offset:12288
  ds_read_b64_tr_b16 v[198:199], v227 offset:12800
  v_mfma_f32_32x32x16_bf16 v[176:191], v[204:207], v[80:83], v[176:191]
  v_mul_f32 v143, v143, v219
  v_cvt_pk_bf16_f32 v134, v140, v141
  v_cvt_pk_bf16_f32 v135, v142, v143
  s_add_u32 s56, s55, 0
  buffer_load_dwordx4 a[4:7], v255, s[36:39], s85 offen offset:0 sc1
  s_waitcnt lgkmcnt(4)
  v_mfma_f32_32x32x16_bf16 v[160:175], v[208:211], v[84:87], v[160:175]
  s_cmp_eq_u32 s46, 0
  s_cbranch_scc1 L_st_20
  buffer_store_dwordx4 v[128:131], v255, s[36:39], s56 offen offset:0
  buffer_store_dwordx4 v[132:135], v255, s[36:39], s56 offen offset:1024
  s_branch L_st_20_e
L_st_20:
  buffer_store_dwordx4 v[128:131], v255, s[36:39], s56 offen offset:0 sc0 sc1
  buffer_store_dwordx4 v[132:135], v255, s[36:39], s56 offen offset:1024 sc0 sc1
L_st_20_e:
  ds_read_b64_tr_b16 v[200:201], v226 offset:13312
  ds_read_b64_tr_b16 v[202:203], v226 offset:13824
  ds_read_b64_tr_b16 v[204:205], v227 offset:13312
  ds_read_b64_tr_b16 v[206:207], v227 offset:13824
  v_mfma_f32_32x32x16_bf16 v[176:191], v[212:215], v[84:87], v[176:191]
  v_mul_f32 v216, v144, v232
  v_mul_f32 v217, v145, v232
  v_mul_f32 v218, v146, v232
  v_mul_f32 v219, v147, v232
  buffer_load_dwordx4 a[12:15], v255, s[36:39], s85 offen offset:1024 sc1
  s_waitcnt lgkmcnt(4)
  v_mfma_f32_32x32x16_bf16 v[160:175], v[192:195], v[88:91], v[160:175]
  v_exp_f32 v216, -v216
  ds_read_b64_tr_b16 v[208:209], v226 offset:16384
  ds_read_b64_tr_b16 v[210:211], v226 offset:16896
  ds_read_b64_tr_b16 v[212:213], v227 offset:16384
  ds_read_b64_tr_b16 v[214:215], v227 offset:16896
  v_mfma_f32_32x32x16_bf16 v[176:191], v[196:199], v[88:91], v[176:191]
  v_exp_f32 v217, -v217
  v_exp_f32 v218, -v218
  buffer_load_dwordx4 a[20:23], v255, s[36:39], s85 offen offset:2048 sc1
  s_waitcnt lgkmcnt(4)
  v_mfma_f32_32x32x16_bf16 v[160:175], v[200:203], v[92:95], v[160:175]
  v_exp_f32 v219, -v219
  ds_read_b64_tr_b16 v[192:193], v226 offset:17408
  ds_read_b64_tr_b16 v[194:195], v226 offset:17920
  ds_read_b64_tr_b16 v[196:197], v227 offset:17408
  ds_read_b64_tr_b16 v[198:199], v227 offset:17920
  v_mfma_f32_32x32x16_bf16 v[176:191], v[204:207], v[92:95], v[176:191]
  v_mul_f32 v144, v144, v233
  v_mul_f32 v145, v145, v233
  v_mul_f32 v146, v146, v233
  v_mul_f32 v147, v147, v233
  v_add_f32 v216, 1.0, v216
  buffer_load_dwordx4 a[28:31], v255, s[36:39], s85 offen offset:3072 sc1
  s_waitcnt lgkmcnt(4)
  v_mfma_f32_32x32x16_bf16 v[160:175], v[208:211], v[96:99], v[160:175]
  v_add_f32 v217, 1.0, v217
  v_add_f32 v218, 1.0, v218
  ds_read_b64_tr_b16 v[200:201], v226 offset:20480
  ds_read_b64_tr_b16 v[202:203], v226 offset:20992
  ds_read_b64_tr_b16 v[204:205], v227 offset:20480
  ds_read_b64_tr_b16 v[206:207], v227 offset:20992
  v_mfma_f32_32x32x16_bf16 v[176:191], v[212:215], v[96:99], v[176:191]
  v_add_f32 v219, 1.0, v219
  v_rcp_f32 v216, v216
  s_add_u32 s85, s85, 4096
  buffer_load_dwordx4 a[36:39], v255, s[36:39], s85 offen offset:0 sc1
  s_waitcnt lgkmcnt(4)
  v_mfma_f32_32x32x16_bf16 v[160:175], v[192:195], v[100:103], v[160:175]
  v_rcp_f32 v217, v217
  ds_read_b64_tr_b16 v[208:209], v226 offset:21504
  ds_read_b64_tr_b16 v[210:211], v226 offset:22016
  ds_read_b64_tr_b16 v[212:213], v227 offset:21504
  ds_read_b64_tr_b16 v[214:215], v227 offset:22016
  v_mfma_f32_32x32x16_bf16 v[176:191], v[196:199], v[100:103], v[176:191]
  v_rcp_f32 v218, v218
  v_rcp_f32 v219, v219
  v_mul_f32 v144, v144, v216
  buffer_load_dwordx4 a[44:47], v255, s[36:39], s85 offen offset:1024 sc1
  s_waitcnt lgkmcnt(4)
  v_mfma_f32_32x32x16_bf16 v[160:175], v[200:203], v[104:107], v[160:175]
  v_mul_f32 v145, v145, v217
  v_mul_f32 v146, v146, v218
  ds_read_b64_tr_b16 v[192:193], v226 offset:24576
  ds_read_b64_tr_b16 v[194:195], v226 offset:25088
  ds_read_b64_tr_b16 v[196:197], v227 offset:24576
  ds_read_b64_tr_b16 v[198:199], v227 offset:25088
  v_mfma_f32_32x32x16_bf16 v[176:191], v[204:207], v[104:107], v[176:191]
  v_mul_f32 v147, v147, v219
  v_cvt_pk_bf16_f32 v144, v144, v145
  v_cvt_pk_bf16_f32 v145, v146, v147
  v_mul_f32 v216, v148, v232
  v_mul_f32 v217, v149, v232
  buffer_load_dwordx4 a[52:55], v255, s[36:39], s85 offen offset:2048 sc1
  v_mfma_f32_32x32x16_bf16 v[160:175], a[250:253], v[228:231], v[160:175]
  v_mul_f32 v218, v150, v232
  v_mul_f32 v219, v151, v232
  v_exp_f32 v216, -v216
  v_exp_f32 v217, -v217
  v_mfma_f32_32x32x16_bf16 v[176:191], a[252:255], v[228:231], v[176:191]
  v_exp_f32 v218, -v218
  v_exp_f32 v219, -v219
  v_mul_f32 v148, v148, v233
  v_mul_f32 v149, v149, v233
  s_waitcnt lgkmcnt(4)
  v_mfma_f32_32x32x16_bf16 v[160:175], v[208:211], v[108:111], v[160:175]
  v_mul_f32 v150, v150, v233
  v_mul_f32 v151, v151, v233
  ds_read_b64_tr_b16 v[200:201], v226 offset:25600
  ds_read_b64_tr_b16 v[202:203], v226 offset:26112
  ds_read_b64_tr_b16 v[204:205], v227 offset:25600
  ds_read_b64_tr_b16 v[206:207], v227 offset:26112
  v_mfma_f32_32x32x16_bf16 v[176:191], v[212:215], v[108:111], v[176:191]
  v_add_f32 v216, 1.0, v216
  v_add_f32 v217, 1.0, v217
  v_add_f32 v218, 1.0, v218
  v_add_f32 v219, 1.0, v219
  buffer_load_dwordx4 a[60:63], v255, s[36:39], s85 offen offset:3072 sc1
  s_waitcnt lgkmcnt(4)
  v_mfma_f32_32x32x16_bf16 v[160:175], v[192:195], v[112:115], v[160:175]
  v_rcp_f32 v216, v216
  ds_read_b64_tr_b16 v[208:209], v226 offset:28672
  ds_read_b64_tr_b16 v[210:211], v226 offset:29184
  ds_read_b64_tr_b16 v[212:213], v227 offset:28672
  ds_read_b64_tr_b16 v[214:215], v227 offset:29184
  v_mfma_f32_32x32x16_bf16 v[176:191], v[196:199], v[112:115], v[176:191]
  v_rcp_f32 v217, v217
  v_rcp_f32 v218, v218
  s_add_u32 s85, s85, 4096
  buffer_load_dwordx4 a[68:71], v255, s[36:39], s85 offen offset:0 sc1
  s_waitcnt lgkmcnt(4)
  v_mfma_f32_32x32x16_bf16 v[160:175], v[200:203], v[116:119], v[160:175]
  v_rcp_f32 v219, v219
  ds_read_b64_tr_b16 v[192:193], v226 offset:29696
  ds_read_b64_tr_b16 v[194:195], v226 offset:30208
  ds_read_b64_tr_b16 v[196:197], v227 offset:29696
  ds_read_b64_tr_b16 v[198:199], v227 offset:30208
  v_mfma_f32_32x32x16_bf16 v[176:191], v[204:207], v[116:119], v[176:191]
  v_mul_f32 v148, v148, v216
  v_mul_f32 v149, v149, v217
  v_mul_f32 v150, v150, v218
  v_mul_f32 v151, v151, v219
  v_cvt_pk_bf16_f32 v146, v148, v149
  buffer_load_dwordx4 a[76:79], v255, s[36:39], s85 offen offset:1024 sc1
  s_waitcnt lgkmcnt(4)
  v_mfma_f32_32x32x16_bf16 v[160:175], v[208:211], v[120:123], v[160:175]
  v_cvt_pk_bf16_f32 v147, v150, v151
  v_mul_f32 v216, v152, v232
  v_mul_f32 v217, v153, v232
  v_mul_f32 v218, v154, v232
  v_mul_f32 v219, v155, v232
  v_mfma_f32_32x32x16_bf16 v[176:191], v[212:215], v[120:123], v[176:191]
  v_exp_f32 v216, -v216
  v_exp_f32 v217, -v217
  buffer_load_dwordx4 a[84:87], v255, s[36:39], s85 offen offset:2048 sc1
  s_waitcnt lgkmcnt(0)
  v_mfma_f32_32x32x16_bf16 v[160:175], v[192:195], v[124:127], v[160:175]
  v_exp_f32 v218, -v218
  v_exp_f32 v219, -v219
  v_mul_f32 v152, v152, v233
  v_mul_f32 v153, v153, v233
  v_mfma_f32_32x32x16_bf16 v[176:191], v[196:199], v[124:127], v[176:191]
  v_mul_f32 v154, v154, v233
  v_mul_f32 v155, v155, v233
  v_add_f32 v216, 1.0, v216
  v_add_f32 v217, 1.0, v217
  v_add_f32 v218, 1.0, v218
  buffer_load_dwordx4 a[92:95], v255, s[36:39], s85 offen offset:3072 sc1
  v_add_f32 v219, 1.0, v219
  v_rcp_f32 v216, v216
  v_rcp_f32 v217, v217
  v_rcp_f32 v218, v218
  v_rcp_f32 v219, v219
  v_mul_f32 v152, v152, v216
  v_mul_f32 v153, v153, v217
  v_mul_f32 v154, v154, v218
  v_mul_f32 v155, v155, v219
  v_cvt_pk_bf16_f32 v148, v152, v153
  v_cvt_pk_bf16_f32 v149, v154, v155
  v_mul_f32 v216, v156, v232
  v_mul_f32 v217, v157, v232
  v_mul_f32 v218, v158, v232
  v_mul_f32 v219, v159, v232
  v_exp_f32 v216, -v216
  v_exp_f32 v217, -v217
  v_exp_f32 v218, -v218
  v_exp_f32 v219, -v219
  v_mul_f32 v156, v156, v233
  v_mul_f32 v157, v157, v233
  v_mul_f32 v158, v158, v233
  v_mul_f32 v159, v159, v233
  v_add_f32 v216, 1.0, v216
  v_add_f32 v217, 1.0, v217
  v_add_f32 v218, 1.0, v218
  v_add_f32 v219, 1.0, v219
  v_rcp_f32 v216, v216
  v_rcp_f32 v217, v217
  v_rcp_f32 v218, v218
  v_rcp_f32 v219, v219
  v_mul_f32 v156, v156, v216
  v_mul_f32 v157, v157, v217
  v_mul_f32 v158, v158, v218
  v_mul_f32 v159, v159, v219
  v_cvt_pk_bf16_f32 v150, v156, v157
  v_cvt_pk_bf16_f32 v151, v158, v159
  s_add_u32 s56, s55, 2048
  s_cmp_eq_u32 s46, 0
  s_cbranch_scc1 L_st_21
  buffer_store_dwordx4 v[144:147], v255, s[36:39], s56 offen offset:0
  buffer_store_dwordx4 v[148:151], v255, s[36:39], s56 offen offset:1024
  s_branch L_st_21_e
L_st_21:
  buffer_store_dwordx4 v[144:147], v255, s[36:39], s56 offen offset:0 sc0 sc1
  buffer_store_dwordx4 v[148:151], v255, s[36:39], s56 offen offset:1024 sc0 sc1
L_st_21_e:
  v_mov_b32 v220, v233
  v_mov_b32 v222, 1.0
  v_mov_b32 v223, 1.0
  v_pk_mul_f32 v[216:217], v[160:161], v[232:233] op_sel_hi:[1,0]
  v_pk_mul_f32 v[218:219], v[162:163], v[232:233] op_sel_hi:[1,0]
  v_exp_f32 v216, -v216
  v_exp_f32 v217, -v217
  v_exp_f32 v218, -v218
  v_exp_f32 v219, -v219
  s_add_u32 s85, s85, 4096
  buffer_load_dwordx4 a[100:103], v255, s[36:39], s85 offen offset:0 sc1
  v_pk_mul_f32 v[160:161], v[160:161], v[220:221] op_sel_hi:[1,0]
  v_pk_mul_f32 v[162:163], v[162:163], v[220:221] op_sel_hi:[1,0]
  v_pk_add_f32 v[216:217], v[216:217], v[222:223]
  v_pk_add_f32 v[218:219], v[218:219], v[222:223]
  v_rcp_f32 v216, v216
  v_rcp_f32 v217, v217
  v_rcp_f32 v218, v218
  buffer_load_dwordx4 a[108:111], v255, s[36:39], s85 offen offset:1024 sc1
  v_rcp_f32 v219, v219
  v_pk_mul_f32 v[160:161], v[160:161], v[216:217]
  v_pk_mul_f32 v[162:163], v[162:163], v[218:219]
  v_cvt_pk_bf16_f32 v160, v160, v161
  v_cvt_pk_bf16_f32 v161, v162, v163
  v_pk_mul_f32 v[216:217], v[164:165], v[232:233] op_sel_hi:[1,0]
  v_pk_mul_f32 v[218:219], v[166:167], v[232:233] op_sel_hi:[1,0]
  v_exp_f32 v216, -v216
  buffer_load_dwordx4 a[116:119], v255, s[36:39], s85 offen offset:2048 sc1
  v_exp_f32 v217, -v217
  v_exp_f32 v218, -v218
  v_exp_f32 v219, -v219
  v_pk_mul_f32 v[164:165], v[164:165], v[220:221] op_sel_hi:[1,0]
  v_pk_mul_f32 v[166:167], v[166:167], v[220:221] op_sel_hi:[1,0]
  v_pk_add_f32 v[216:217], v[216:217], v[222:223]
  v_pk_add_f32 v[218:219], v[218:219], v[222:223]
  buffer_load_dwordx4 a[124:127], v255, s[36:39], s85 offen offset:3072 sc1
  v_rcp_f32 v216, v216
  v_rcp_f32 v217, v217
  v_rcp_f32 v218, v218
  v_rcp_f32 v219, v219
  v_pk_mul_f32 v[164:165], v[164:165], v[216:217]
  v_pk_mul_f32 v[166:167], v[166:167], v[218:219]
  s_add_u32 s85, s85, 4096
  buffer_load_dwordx4 a[132:135], v255, s[36:39], s85 offen offset:0 sc1
  v_cvt_pk_bf16_f32 v162, v164, v165
  v_cvt_pk_bf16_f32 v163, v166, v167
  v_pk_mul_f32 v[216:217], v[168:169], v[232:233] op_sel_hi:[1,0]
  v_pk_mul_f32 v[218:219], v[170:171], v[232:233] op_sel_hi:[1,0]
  v_exp_f32 v216, -v216
  v_exp_f32 v217, -v217
  v_exp_f32 v218, -v218
  buffer_load_dwordx4 a[140:143], v255, s[36:39], s85 offen offset:1024 sc1
  v_exp_f32 v219, -v219
  v_pk_mul_f32 v[168:169], v[168:169], v[220:221] op_sel_hi:[1,0]
  v_pk_mul_f32 v[170:171], v[170:171], v[220:221] op_sel_hi:[1,0]
  v_pk_add_f32 v[216:217], v[216:217], v[222:223]
  v_pk_add_f32 v[218:219], v[218:219], v[222:223]
  v_rcp_f32 v216, v216
  v_rcp_f32 v217, v217
  buffer_load_dwordx4 a[148:151], v255, s[36:39], s85 offen offset:2048 sc1
  v_rcp_f32 v218, v218
  v_rcp_f32 v219, v219
  v_pk_mul_f32 v[168:169], v[168:169], v[216:217]
  v_pk_mul_f32 v[170:171], v[170:171], v[218:219]
  v_cvt_pk_bf16_f32 v164, v168, v169
  v_cvt_pk_bf16_f32 v165, v170, v171
  v_pk_mul_f32 v[216:217], v[172:173], v[232:233] op_sel_hi:[1,0]
  v_pk_mul_f32 v[218:219], v[174:175], v[232:233] op_sel_hi:[1,0]
  buffer_load_dwordx4 a[156:159], v255, s[36:39], s85 offen offset:3072 sc1
  v_exp_f32 v216, -v216
  v_exp_f32 v217, -v217
  v_exp_f32 v218, -v218
  v_exp_f32 v219, -v219
  v_pk_mul_f32 v[172:173], v[172:173], v[220:221] op_sel_hi:[1,0]
  v_pk_mul_f32 v[174:175], v[174:175], v[220:221] op_sel_hi:[1,0]
  s_add_u32 s85, s85, 4096
  buffer_load_dwordx4 a[164:167], v255, s[36:39], s85 offen offset:0 sc1
  v_pk_add_f32 v[216:217], v[216:217], v[222:223]
  v_pk_add_f32 v[218:219], v[218:219], v[222:223]
  v_rcp_f32 v216, v216
  v_rcp_f32 v217, v217
  v_rcp_f32 v218, v218
  v_rcp_f32 v219, v219
  buffer_load_dwordx4 a[172:175], v255, s[36:39], s85 offen offset:1024 sc1
  v_pk_mul_f32 v[172:173], v[172:173], v[216:217]
  v_pk_mul_f32 v[174:175], v[174:175], v[218:219]
  v_cvt_pk_bf16_f32 v166, v172, v173
  v_cvt_pk_bf16_f32 v167, v174, v175
  s_add_u32 s56, s55, 4096
  s_cmp_eq_u32 s46, 0
  s_cbranch_scc1 L_st_22
  buffer_store_dwordx4 v[160:163], v255, s[36:39], s56 offen offset:0
  buffer_store_dwordx4 v[164:167], v255, s[36:39], s56 offen offset:1024
  s_branch L_st_22_e
L_st_22:
  buffer_store_dwordx4 v[160:163], v255, s[36:39], s56 offen offset:0 sc0 sc1
  buffer_store_dwordx4 v[164:167], v255, s[36:39], s56 offen offset:1024 sc0 sc1
L_st_22_e:
  buffer_load_dwordx4 a[180:183], v255, s[36:39], s85 offen offset:2048 sc1
  v_pk_mul_f32 v[216:217], v[176:177], v[232:233] op_sel_hi:[1,0]
  v_pk_mul_f32 v[218:219], v[178:179], v[232:233] op_sel_hi:[1,0]
  v_exp_f32 v216, -v216
  v_exp_f32 v217, -v217
  v_exp_f32 v218, -v218
  v_exp_f32 v219, -v219
  buffer_load_dwordx4 a[188:191], v255, s[36:39], s85 offen offset:3072 sc1
  v_pk_mul_f32 v[176:177], v[176:177], v[220:221] op_sel_hi:[1,0]
  v_pk_mul_f32 v[178:179], v[178:179], v[220:221] op_sel_hi:[1,0]
  v_pk_add_f32 v[216:217], v[216:217], v[222:223]
  v_pk_add_f32 v[218:219], v[218:219], v[222:223]
  v_rcp_f32 v216, v216
  v_rcp_f32 v217, v217
  v_rcp_f32 v218, v218
  s_add_u32 s85, s85, 4096
  buffer_load_dwordx4 a[196:199], v255, s[36:39], s85 offen offset:0 sc1
  v_rcp_f32 v219, v219
  v_pk_mul_f32 v[176:177], v[176:177], v[216:217]
  v_pk_mul_f32 v[178:179], v[178:179], v[218:219]
  v_cvt_pk_bf16_f32 v176, v176, v177
  v_cvt_pk_bf16_f32 v177, v178, v179
  v_pk_mul_f32 v[216:217], v[180:181], v[232:233] op_sel_hi:[1,0]
  v_pk_mul_f32 v[218:219], v[182:183], v[232:233] op_sel_hi:[1,0]
  v_exp_f32 v216, -v216
  buffer_load_dwordx4 a[204:207], v255, s[36:39], s85 offen offset:1024 sc1
  v_exp_f32 v217, -v217
  v_exp_f32 v218, -v218
  v_exp_f32 v219, -v219
  v_pk_mul_f32 v[180:181], v[180:181], v[220:221] op_sel_hi:[1,0]
  v_pk_mul_f32 v[182:183], v[182:183], v[220:221] op_sel_hi:[1,0]
  v_pk_add_f32 v[216:217], v[216:217], v[222:223]
  v_pk_add_f32 v[218:219], v[218:219], v[222:223]
  buffer_load_dwordx4 a[212:215], v255, s[36:39], s85 offen offset:2048 sc1
  v_rcp_f32 v216, v216
  v_rcp_f32 v217, v217
  v_rcp_f32 v218, v218
  v_rcp_f32 v219, v219
  v_pk_mul_f32 v[180:181], v[180:181], v[216:217]
  v_pk_mul_f32 v[182:183], v[182:183], v[218:219]
  buffer_load_dwordx4 a[220:223], v255, s[36:39], s85 offen offset:3072 sc1
  v_cvt_pk_bf16_f32 v178, v180, v181
  v_cvt_pk_bf16_f32 v179, v182, v183
  v_pk_mul_f32 v[216:217], v[184:185], v[232:233] op_sel_hi:[1,0]
  v_pk_mul_f32 v[218:219], v[186:187], v[232:233] op_sel_hi:[1,0]
  v_exp_f32 v216, -v216
  v_exp_f32 v217, -v217
  v_exp_f32 v218, -v218
  v_exp_f32 v219, -v219
  v_pk_mul_f32 v[184:185], v[184:185], v[220:221] op_sel_hi:[1,0]
  v_pk_mul_f32 v[186:187], v[186:187], v[220:221] op_sel_hi:[1,0]
  v_pk_add_f32 v[216:217], v[216:217], v[222:223]
  v_pk_add_f32 v[218:219], v[218:219], v[222:223]
  v_rcp_f32 v216, v216
  v_rcp_f32 v217, v217
  v_rcp_f32 v218, v218
  v_rcp_f32 v219, v219
  v_pk_mul_f32 v[184:185], v[184:185], v[216:217]
  v_pk_mul_f32 v[186:187], v[186:187], v[218:219]
  v_cvt_pk_bf16_f32 v180, v184, v185
  v_cvt_pk_bf16_f32 v181, v186, v187
  v_pk_mul_f32 v[216:217], v[188:189], v[232:233] op_sel_hi:[1,0]
  v_pk_mul_f32 v[218:219], v[190:191], v[232:233] op_sel_hi:[1,0]
  v_exp_f32 v216, -v216
  v_exp_f32 v217, -v217
  v_exp_f32 v218, -v218
  v_exp_f32 v219, -v219
  v_pk_mul_f32 v[188:189], v[188:189], v[220:221] op_sel_hi:[1,0]
  v_pk_mul_f32 v[190:191], v[190:191], v[220:221] op_sel_hi:[1,0]
  v_pk_add_f32 v[216:217], v[216:217], v[222:223]
  v_pk_add_f32 v[218:219], v[218:219], v[222:223]
  v_rcp_f32 v216, v216
  v_rcp_f32 v217, v217
  v_rcp_f32 v218, v218
  v_rcp_f32 v219, v219
  v_pk_mul_f32 v[188:189], v[188:189], v[216:217]
  v_pk_mul_f32 v[190:191], v[190:191], v[218:219]
  v_cvt_pk_bf16_f32 v182, v188, v189
  v_cvt_pk_bf16_f32 v183, v190, v191
  s_add_u32 s56, s55, 6144
  s_cmp_eq_u32 s46, 0
  s_cbranch_scc1 L_st_23
  buffer_store_dwordx4 v[176:179], v255, s[36:39], s56 offen offset:0
  buffer_store_dwordx4 v[180:183], v255, s[36:39], s56 offen offset:1024
  s_branch L_st_23_e
L_st_23:
  buffer_store_dwordx4 v[176:179], v255, s[36:39], s56 offen offset:0 sc0 sc1
  buffer_store_dwordx4 v[180:183], v255, s[36:39], s56 offen offset:1024 sc0 sc1
L_st_23_e:
  s_lshl_b32 s75, s42, 2
  s_add_u32 s75, s75, s40
  s_lshl_b32 s75, s75, 3
  s_lshl_b32 s74, s41, 9
  s_add_u32 s75, s75, s74
  s_add_u32 s75, s75, 0
  s_waitcnt vmcnt(0)
  s_or_b32 s70, s44, 3
  v_mov_b32 v236, s70
  v_mov_b32 v237, s45
  v_mov_b32 v238, 0
  s_mov_b64 exec, 1
  s_cmp_eq_u32 s46, 0
  s_cbranch_scc1 L_fs_24
  buffer_store_dwordx2 v[236:237], v238, s[36:39], s75 offen
  s_branch L_fs_24_e
L_fs_24:
  buffer_store_dwordx2 v[236:237], v238, s[36:39], s75 offen sc0 sc1
L_fs_24_e:
  s_mov_b64 exec, -1
  s_branch L_p3done0
L_p3skip0:
  buffer_load_dwordx4 a[144:147], v255, s[36:39], s84 offen offset:2048 sc1
  buffer_load_dwordx4 a[152:155], v255, s[36:39], s84 offen offset:3072 sc1
  s_add_u32 s84, s84, 4096
  buffer_load_dwordx4 a[160:163], v255, s[36:39], s84 offen offset:0 sc1
  buffer_load_dwordx4 a[168:171], v255, s[36:39], s84 offen offset:1024 sc1
  buffer_load_dwordx4 a[176:179], v255, s[36:39], s84 offen offset:2048 sc1
  buffer_load_dwordx4 a[184:187], v255, s[36:39], s84 offen offset:3072 sc1
  s_add_u32 s84, s84, 4096
  buffer_load_dwordx4 a[192:195], v255, s[36:39], s84 offen offset:0 sc1
  buffer_load_dwordx4 a[200:203], v255, s[36:39], s84 offen offset:1024 sc1
  buffer_load_dwordx4 a[208:211], v255, s[36:39], s84 offen offset:2048 sc1
  buffer_load_dwordx4 a[216:219], v255, s[36:39], s84 offen offset:3072 sc1
  buffer_load_dwordx4 a[4:7], v255, s[36:39], s85 offen offset:0 sc1
  buffer_load_dwordx4 a[12:15], v255, s[36:39], s85 offen offset:1024 sc1
  buffer_load_dwordx4 a[20:23], v255, s[36:39], s85 offen offset:2048 sc1
  buffer_load_dwordx4 a[28:31], v255, s[36:39], s85 offen offset:3072 sc1
  s_add_u32 s85, s85, 4096
  buffer_load_dwordx4 a[36:39], v255, s[36:39], s85 offen offset:0 sc1
  buffer_load_dwordx4 a[44:47], v255, s[36:39], s85 offen offset:1024 sc1
  buffer_load_dwordx4 a[52:55], v255, s[36:39], s85 offen offset:2048 sc1
  buffer_load_dwordx4 a[60:63], v255, s[36:39], s85 offen offset:3072 sc1
  s_add_u32 s85, s85, 4096
  buffer_load_dwordx4 a[68:71], v255, s[36:39], s85 offen offset:0 sc1
  buffer_load_dwordx4 a[76:79], v255, s[36:39], s85 offen offset:1024 sc1
  buffer_load_dwordx4 a[84:87], v255, s[36:39], s85 offen offset:2048 sc1
  buffer_load_dwordx4 a[92:95], v255, s[36:39], s85 offen offset:3072 sc1
  s_add_u32 s85, s85, 4096
  buffer_load_dwordx4 a[100:103], v255, s[36:39], s85 offen offset:0 sc1
  buffer_load_dwordx4 a[108:111], v255, s[36:39], s85 offen offset:1024 sc1
  buffer_load_dwordx4 a[116:119], v255, s[36:39], s85 offen offset:2048 sc1
  buffer_load_dwordx4 a[124:127], v255, s[36:39], s85 offen offset:3072 sc1
  s_add_u32 s85, s85, 4096
  buffer_load_dwordx4 a[132:135], v255, s[36:39], s85 offen offset:0 sc1
  buffer_load_dwordx4 a[140:143], v255, s[36:39], s85 offen offset:1024 sc1
  buffer_load_dwordx4 a[148:151], v255, s[36:39], s85 offen offset:2048 sc1
  buffer_load_dwordx4 a[156:159], v255, s[36:39], s85 offen offset:3072 sc1
  s_add_u32 s85, s85, 4096
  buffer_load_dwordx4 a[164:167], v255, s[36:39], s85 offen offset:0 sc1
  buffer_load_dwordx4 a[172:175], v255, s[36:39], s85 offen offset:1024 sc1
  buffer_load_dwordx4 a[180:183], v255, s[36:39], s85 offen offset:2048 sc1
  buffer_load_dwordx4 a[188:191], v255, s[36:39], s85 offen offset:3072 sc1
  s_add_u32 s85, s85, 4096
  buffer_load_dwordx4 a[196:199], v255, s[36:39], s85 offen offset:0 sc1
  buffer_load_dwordx4 a[204:207], v255, s[36:39], s85 offen offset:1024 sc1
  buffer_load_dwordx4 a[212:215], v255, s[36:39], s85 offen offset:2048 sc1
  buffer_load_dwordx4 a[220:223], v255, s[36:39], s85 offen offset:3072 sc1
  s_waitcnt vmcnt(0)
L_p3done0:
  s_barrier
  s_lshr_b32 s60, s42, 3
  s_lshl_b32 s60, s60, 1
  s_lshr_b32 s74, s40, 1
  s_add_u32 s61, s60, s74
  s_xor_b32 s62, s61, 1
  s_and_b32 s63, s42, 7
  s_lshl_b32 s63, s63, 1
  s_and_b32 s74, s40, 1
  s_add_u32 s63, s63, s74
  s_lshl_b32 s75, s41, 2
  s_add_u32 s75, s75, s61
  s_mul_i32 s75, s75, 33280
  s_lshl_b32 s76, s63, 11
  s_add_u32 s75, s75, s76
  s_add_u32 s75, s75, 4194304
  buffer_load_dwordx4 v[200:203], v255, s[36:39], s75 offen sc1
  buffer_load_dwordx4 v[204:207], v255, s[36:39], s75 offen offset:1024 sc1
  v_and_b32 v226, 3, v244
  v_bfe_u32 v227, v244, 3, 1
  v_lshl_add_u32 v226, v227, 2, v226
  v_bfe_u32 v227, v244, 2, 1
  v_lshrrev_b32 v228, 5, v244
  v_xor_b32 v227, v227, v228
  v_lshl_add_u32 v226, v227, 3, v226
  v_bfe_u32 v227, v244, 4, 1
  v_lshl_add_u32 v228, v227, 3, v226
  v_and_b32 v229, 1, v228
  v_lshlrev_b32 v229, 4, v229
  s_movk_i32 s74, 0x3f80
  v_lshlrev_b32 v229, v229, s74
  v_lshrrev_b32 v230, 1, v228
  v_cmp_eq_u32 vcc, 0, v230
  s_nop 1
  v_cndmask_b32 v192, 0, v229, vcc
  v_cmp_eq_u32 vcc, 1, v230
  s_nop 1
  v_cndmask_b32 v193, 0, v229, vcc
  v_cmp_eq_u32 vcc, 2, v230
  s_nop 1
  v_cndmask_b32 v194, 0, v229, vcc
  v_cmp_eq_u32 vcc, 3, v230
  s_nop 1
  v_cndmask_b32 v195, 0, v229, vcc
  v_xor_b32 v227, 1, v227
  v_lshl_add_u32 v228, v227, 3, v226
  v_and_b32 v229, 1, v228
  v_lshlrev_b32 v229, 4, v229
  s_movk_i32 s74, 0x3f80
  v_lshlrev_b32 v229, v229, s74
  v_lshrrev_b32 v230, 1, v228
  v_cmp_eq_u32 vcc, 0, v230
  s_nop 1
  v_cndmask_b32 v196, 0, v229, vcc
  v_cmp_eq_u32 vcc, 1, v230
  s_nop 1
  v_cndmask_b32 v197, 0, v229, vcc
  v_cmp_eq_u32 vcc, 2, v230
  s_nop 1
  v_cndmask_b32 v198, 0, v229, vcc
  v_cmp_eq_u32 vcc, 3, v230
  s_nop 1
  v_cndmask_b32 v199, 0, v229, vcc
  s_lshl_b32 s52, s41, 2
  s_add_u32 s52, s52, s61
  s_mul_i32 s52, s52, 33280
  s_lshl_b32 s76, s63, 11
  s_add_u32 s52, s52, s76
  s_add_u32 s52, s52, 4194304
  s_lshl_b32 s53, s41, 2
  s_add_u32 s53, s53, s61
  s_mul_i32 s53, s53, 4096
  s_bfe_u32 s76, s63, 0x20001
  s_lshl_b32 s76, s76, 10
  s_add_u32 s53, s53, s76
  s_lshr_b32 s76, s63, 3
  s_lshl_b32 s76, s76, 9
  s_add_u32 s53, s53, s76
  s_and_b32 s76, s63, 1
  s_lshl_b32 s76, s76, 3
  s_add_u32 s53, s53, s76
  s_add_u32 s53, s53, 65536
  v_and_b32 v240, 31, v244
  v_lshlrev_b32 v240, 4, v240
  v_lshrrev_b32 v241, 2, v243
  v_add_u32 v240, v240, v241
  s_lshl_b32 s54, s42, 2
  s_add_u32 s54, s54, s40
  s_lshl_b32 s54, s54, 3
  s_lshl_b32 s74, s41, 9
  s_add_u32 s54, s54, s74
  s_add_u32 s54, s54, 0
  s_lshl_b32 s55, s41, 2
  s_add_u32 s55, s55, s62
  s_mul_i32 s55, s55, 115200
  s_mul_i32 s76, s40, 28672
  s_add_u32 s55, s55, s76
  s_add_u32 s55, s55, 6815744
  s_lshl_b32 s59, s41, 2
  s_add_u32 s59, s59, s61
  s_mul_i32 s59, s59, 115200
  s_mul_i32 s76, s40, 28672
  s_add_u32 s59, s59, s76
  s_add_u32 s59, s59, 6815744
  s_xor_b32 s74, s40, 1
  s_lshl_b32 s75, s74, 14
  s_lshl_b32 s76, s40, 12
  s_add_u32 s75, s75, s76
  s_add_u32 s75, s75, 98304
  v_add_u32 v208, s75, v255
  s_lshl_b32 s75, s74, 12
  s_lshl_b32 s76, s40, 14
  s_add_u32 s75, s75, s76
  s_add_u32 s75, s75, 98304
  v_add_u32 v212, s75, v255
  s_xor_b32 s74, s40, 2
  s_lshl_b32 s75, s74, 14
  s_lshl_b32 s76, s40, 12
  s_add_u32 s75, s75, s76
  s_add_u32 s75, s75, 98304
  v_add_u32 v209, s75, v255
  s_lshl_b32 s75, s74, 12
  s_lshl_b32 s76, s40, 14
  s_add_u32 s75, s75, s76
  s_add_u32 s75, s75, 98304
  v_add_u32 v213, s75, v255
  s_xor_b32 s74, s40, 3
  s_lshl_b32 s75, s74, 14
  s_lshl_b32 s76, s40, 12
  s_add_u32 s75, s75, s76
  s_add_u32 s75, s75, 98304
  v_add_u32 v210, s75, v255
  s_lshl_b32 s75, s74, 12
  s_lshl_b32 s76, s40, 14
  s_add_u32 s75, s75, s76
  s_add_u32 s75, s75, 98304
  v_add_u32 v214, s75, v255
  s_mul_i32 s74, s40, 7
  s_lshr_b32 s74, s74, 1
  s_lshl_b32 s74, s74, 2
  s_add_u32 s74, s74, s60
  s_mov_b64 s[64:65], 0x3333
  s_lshl_b64 s[64:65], s[64:65], s74
  s_lshl_b32 s71, s41, 9
  s_add_u32 s71, s71, 0
  s_or_b32 s70, s44, 3
  s_mov_b32 s68, s64
  s_mov_b32 s69, s65
  s_mov_b32 s80, 0
L_poll_25:
  buffer_load_dwordx2 v[236:237], v248, s[36:39], s71 offen sc1
  s_add_u32 s80, s80, 1
  s_cmp_gt_u32 s80, 0x40000
  s_cbranch_scc1 L_poll_25_x
  s_waitcnt vmcnt(0)
  v_subrev_u32 v236, s70, v236
  v_cmp_ge_u32 vcc, 12, v236
  v_cmp_eq_u32 s[66:67], s45, v237
  s_and_b64 vcc, vcc, s[66:67]
  s_andn2_b64 s[66:67], s[68:69], vcc
  s_cbranch_scc1 L_poll_25
L_poll_25_x:
  s_waitcnt vmcnt(0)
  buffer_load_dwordx4 v[0:3], v255, s[36:39], s55 offen offset:0 sc1
  buffer_load_dwordx4 v[4:7], v255, s[36:39], s55 offen offset:1024 sc1
  buffer_load_dwordx4 v[8:11], v255, s[36:39], s55 offen offset:2048 sc1
  buffer_load_dwordx4 v[12:15], v255, s[36:39], s55 offen offset:3072 sc1
  s_add_u32 s55, s55, 4096
  buffer_load_dwordx4 v[16:19], v255, s[36:39], s55 offen offset:0 sc1
  buffer_load_dwordx4 v[20:23], v255, s[36:39], s55 offen offset:1024 sc1
  buffer_load_dwordx4 v[24:27], v255, s[36:39], s55 offen offset:2048 sc1
  buffer_load_dwordx4 v[28:31], v255, s[36:39], s55 offen offset:3072 sc1
  s_add_u32 s55, s55, 4096
  buffer_load_dwordx4 v[32:35], v255, s[36:39], s55 offen offset:0 sc1
  buffer_load_dwordx4 v[36:39], v255, s[36:39], s55 offen offset:1024 sc1
  v_mfma_f32_32x32x16_bf16 v[160:175], v[192:195], v[200:203], 0
  v_mfma_f32_32x32x16_bf16 v[160:175], v[196:199], v[204:207], v[160:175]
  s_waitcnt vmcnt(9)
  v_mfma_f32_32x32x16_bf16 v[144:159], a[4:7], v[0:3], 0
  buffer_load_dwordx4 v[40:43], v255, s[36:39], s55 offen offset:2048 sc1
  v_mfma_f32_32x32x16_bf16 v[128:143], a[0:3], v[0:3], 0
  s_waitcnt vmcnt(9)
  v_mfma_f32_32x32x16_bf16 v[144:159], a[12:15], v[4:7], v[144:159]
  buffer_load_dwordx4 v[44:47], v255, s[36:39], s55 offen offset:3072 sc1
  v_mfma_f32_32x32x16_bf16 v[128:143], a[8:11], v[4:7], v[128:143]
  s_waitcnt vmcnt(9)
  v_mfma_f32_32x32x16_bf16 v[144:159], a[20:23], v[8:11], v[144:159]
  s_add_u32 s55, s55, 4096
  buffer_load_dwordx4 v[48:51], v255, s[36:39], s55 offen offset:0 sc1
  v_mfma_f32_32x32x16_bf16 v[128:143], a[16:19], v[8:11], v[128:143]
  s_waitcnt vmcnt(9)
  v_mfma_f32_32x32x16_bf16 v[144:159], a[28:31], v[12:15], v[144:159]
  buffer_load_dwordx4 v[52:55], v255, s[36:39], s55 offen offset:1024 sc1
  v_mfma_f32_32x32x16_bf16 v[128:143], a[24:27], v[12:15], v[128:143]
  s_waitcnt vmcnt(9)
  v_mfma_f32_32x32x16_bf16 v[144:159], a[36:39], v[16:19], v[144:159]
  buffer_load_dwordx4 v[56:59], v255, s[36:39], s55 offen offset:2048 sc1
  v_mfma_f32_32x32x16_bf16 v[128:143], a[32:35], v[16:19], v[128:143]
  s_waitcnt vmcnt(9)
  v_mfma_f32_32x32x16_bf16 v[144:159], a[44:47], v[20:23], v[144:159]
  buffer_load_dwordx4 v[60:63], v255, s[36:39], s55 offen offset:3072 sc1
  v_mfma_f32_32x32x16_bf16 v[128:143], a[40:43], v[20:23], v[128:143]
  s_waitcnt vmcnt(9)
  v_mfma_f32_32x32x16_bf16 v[144:159], a[52:55], v[24:27], v[144:159]
  s_add_u32 s55, s55, 4096
  buffer_load_dwordx4 v[64:67], v255, s[36:39], s55 offen offset:0 sc1
  v_mfma_f32_32x32x16_bf16 v[128:143], a[48:51], v[24:27], v[128:143]
  s_waitcnt vmcnt(9)
  v_mfma_f32_32x32x16_bf16 v[144:159], a[60:63], v[28:31], v[144:159]
  buffer_load_dwordx4 v[68:71], v255, s[36:39], s55 offen offset:1024 sc1
  v_mfma_f32_32x32x16_bf16 v[128:143], a[56:59], v[28:31], v[128:143]
  s_waitcnt vmcnt(9)
  v_mfma_f32_32x32x16_bf16 v[144:159], a[68:71], v[32:35], v[144:159]
  buffer_load_dwordx4 v[72:75], v255, s[36:39], s55 offen offset:2048 sc1
  v_mfma_f32_32x32x16_bf16 v[128:143], a[64:67], v[32:35], v[128:143]
  s_waitcnt vmcnt(9)
  v_mfma_f32_32x32x16_bf16 v[144:159], a[76:79], v[36:39], v[144:159]
  buffer_load_dwordx4 v[76:79], v255, s[36:39], s55 offen offset:3072 sc1
  v_mfma_f32_32x32x16_bf16 v[128:143], a[72:75], v[36:39], v[128:143]
  s_waitcnt vmcnt(9)
  v_mfma_f32_32x32x16_bf16 v[144:159], a[84:87], v[40:43], v[144:159]
  s_add_u32 s55, s55, 4096
  buffer_load_dwordx4 v[80:83], v255, s[36:39], s55 offen offset:0 sc1
  v_mfma_f32_32x32x16_bf16 v[128:143], a[80:83], v[40:43], v[128:143]
  s_waitcnt vmcnt(9)
  v_mfma_f32_32x32x16_bf16 v[144:159], a[92:95], v[44:47], v[144:159]
  buffer_load_dwordx4 v[84:87], v255, s[36:39], s55 offen offset:1024 sc1
  v_mfma_f32_32x32x16_bf16 v[128:143], a[88:91], v[44:47], v[128:143]
  s_waitcnt vmcnt(9)
  v_mfma_f32_32x32x16_bf16 v[144:159], a[100:103], v[48:51], v[144:159]
  buffer_load_dwordx4 v[88:91], v255, s[36:39], s55 offen offset:2048 sc1
  v_mfma_f32_32x32x16_bf16 v[128:143], a[96:99], v[48:51], v[128:143]
  s_waitcnt vmcnt(9)
  v_mfma_f32_32x32x16_bf16 v[144:159], a[108:111], v[52:55], v[144:159]
  buffer_load_dwordx4 v[92:95], v255, s[36:39], s55 offen offset:3072 sc1
  v_mfma_f32_32x32x16_bf16 v[128:143], a[104:107], v[52:55], v[128:143]
  s_waitcnt vmcnt(9)
  v_mfma_f32_32x32x16_bf16 v[144:159], a[116:119], v[56:59], v[144:159]
  s_add_u32 s55, s55, 4096
  buffer_load_dwordx4 v[96:99], v255, s[36:39], s55 offen offset:0 sc1
  v_mfma_f32_32x32x16_bf16 v[128:143], a[112:115], v[56:59], v[128:143]
  s_waitcnt vmcnt(9)
  v_mfma_f32_32x32x16_bf16 v[144:159], a[124:127], v[60:63], v[144:159]
  buffer_load_dwordx4 v[100:103], v255, s[36:39], s55 offen offset:1024 sc1
  v_mfma_f32_32x32x16_bf16 v[128:143], a[120:123], v[60:63], v[128:143]
  s_waitcnt vmcnt(9)
  v_mfma_f32_32x32x16_bf16 v[144:159], a[132:135], v[64:67], v[144:159]
  buffer_load_dwordx4 v[104:107], v255, s[36:39], s55 offen offset:2048 sc1
  v_mfma_f32_32x32x16_bf16 v[128:143], a[128:131], v[64:67], v[128:143]
  s_waitcnt vmcnt(9)
  v_mfma_f32_32x32x16_bf16 v[144:159], a[140:143], v[68:71], v[144:159]
  buffer_load_dwordx4 v[108:111], v255, s[36:39], s55 offen offset:3072 sc1
  v_mfma_f32_32x32x16_bf16 v[128:143], a[136:139], v[68:71], v[128:143]
  s_waitcnt vmcnt(9)
  v_mfma_f32_32x32x16_bf16 v[144:159], a[148:151], v[72:75], v[144:159]
  buffer_load_dwordx4 v[112:115], v255, s[36:39], s59 offen offset:0 sc1
  v_mfma_f32_32x32x16_bf16 v[128:143], a[144:147], v[72:75], v[128:143]
  s_waitcnt vmcnt(9)
  v_mfma_f32_32x32x16_bf16 v[144:159], a[156:159], v[76:79], v[144:159]
  buffer_load_dwordx4 v[116:119], v255, s[36:39], s59 offen offset:1024 sc1
  v_mfma_f32_32x32x16_bf16 v[128:143], a[152:155], v[76:79], v[128:143]
  s_waitcnt vmcnt(9)
  v_mfma_f32_32x32x16_bf16 v[144:159], a[164:167], v[80:83], v[144:159]
  buffer_load_dwordx4 v[120:123], v255, s[36:39], s59 offen offset:2048 sc1
  v_mfma_f32_32x32x16_bf16 v[128:143], a[160:163], v[80:83], v[128:143]
  s_waitcnt vmcnt(9)
  v_mfma_f32_32x32x16_bf16 v[144:159], a[172:175], v[84:87], v[144:159]
  buffer_load_dwordx4 v[124:127], v255, s[36:39], s59 offen offset:3072 sc1
  v_mfma_f32_32x32x16_bf16 v[128:143], a[168:171], v[84:87], v[128:143]
  s_waitcnt vmcnt(9)
  v_mfma_f32_32x32x16_bf16 v[144:159], a[180:183], v[88:91], v[144:159]
  s_add_u32 s59, s59, 4096
  buffer_load_dwordx4 v[0:3], v255, s[36:39], s59 offen offset:0 sc1
  v_mfma_f32_32x32x16_bf16 v[128:143], a[176:179], v[88:91], v[128:143]
  s_waitcnt vmcnt(9)
  v_mfma_f32_32x32x16_bf16 v[144:159], a[188:191], v[92:95], v[144:159]
  buffer_load_dwordx4 v[4:7], v255, s[36:39], s59 offen offset:1024 sc1
  v_mfma_f32_32x32x16_bf16 v[128:143], a[184:187], v[92:95], v[128:143]
  s_waitcnt vmcnt(9)
  v_mfma_f32_32x32x16_bf16 v[144:159], a[196:199], v[96:99], v[144:159]
  buffer_load_dwordx4 v[8:11], v255, s[36:39], s59 offen offset:2048 sc1
  v_mfma_f32_32x32x16_bf16 v[128:143], a[192:195], v[96:99], v[128:143]
  s_waitcnt vmcnt(9)
  v_mfma_f32_32x32x16_bf16 v[144:159], a[204:207], v[100:103], v[144:159]
  buffer_load_dwordx4 v[12:15], v255, s[36:39], s59 offen offset:3072 sc1
  v_mfma_f32_32x32x16_bf16 v[128:143], a[200:203], v[100:103], v[128:143]
  s_waitcnt vmcnt(9)
  v_mfma_f32_32x32x16_bf16 v[144:159], a[212:215], v[104:107], v[144:159]
  s_add_u32 s59, s59, 4096
  buffer_load_dwordx4 v[16:19], v255, s[36:39], s59 offen offset:0 sc1
  v_mfma_f32_32x32x16_bf16 v[128:143], a[208:211], v[104:107], v[128:143]
  s_waitcnt vmcnt(9)
  v_mfma_f32_32x32x16_bf16 v[144:159], a[220:223], v[108:111], v[144:159]
  buffer_load_dwordx4 v[20:23], v255, s[36:39], s59 offen offset:1024 sc1
  v_mfma_f32_32x32x16_bf16 v[128:143], a[216:219], v[108:111], v[128:143]
  s_waitcnt vmcnt(9)
  v_mfma_f32_32x32x16_bf16 v[176:191], a[4:7], v[112:115], 0
  buffer_load_dwordx4 v[24:27], v255, s[36:39], s59 offen offset:2048 sc1
  v_mfma_f32_32x32x16_bf16 v[160:175], a[0:3], v[112:115], v[160:175]
  s_waitcnt vmcnt(9)
  v_mfma_f32_32x32x16_bf16 v[176:191], a[12:15], v[116:119], v[176:191]
  buffer_load_dwordx4 v[28:31], v255, s[36:39], s59 offen offset:3072 sc1
  v_mfma_f32_32x32x16_bf16 v[160:175], a[8:11], v[116:119], v[160:175]
  s_waitcnt vmcnt(9)
  v_mfma_f32_32x32x16_bf16 v[176:191], a[20:23], v[120:123], v[176:191]
  s_add_u32 s59, s59, 4096
  buffer_load_dwordx4 v[32:35], v255, s[36:39], s59 offen offset:0 sc1
  v_mfma_f32_32x32x16_bf16 v[160:175], a[16:19], v[120:123], v[160:175]
  ds_write_b128 v209, v[128:131] offset:0
  ds_write_b128 v209, v[132:135] offset:1024
  ds_write_b128 v209, v[136:139] offset:2048
  ds_write_b128 v209, v[140:143] offset:3072
  s_waitcnt vmcnt(9)
  v_mfma_f32_32x32x16_bf16 v[176:191], a[28:31], v[124:127], v[176:191]
  buffer_load_dwordx4 v[36:39], v255, s[36:39], s59 offen offset:1024 sc1
  v_mfma_f32_32x32x16_bf16 v[160:175], a[24:27], v[124:127], v[160:175]
  s_waitcnt vmcnt(9)
  v_mfma_f32_32x32x16_bf16 v[176:191], a[36:39], v[0:3], v[176:191]
  buffer_load_dwordx4 v[40:43], v255, s[36:39], s59 offen offset:2048 sc1
  v_mfma_f32_32x32x16_bf16 v[160:175], a[32:35], v[0:3], v[160:175]
  ds_write_b128 v210, v[144:147] offset:0
  ds_write_b128 v210, v[148:151] offset:1024
  ds_write_b128 v210, v[152:155] offset:2048
  ds_write_b128 v210, v[156:159] offset:3072
  s_waitcnt vmcnt(9)
  v_mfma_f32_32x32x16_bf16 v[176:191], a[44:47], v[4:7], v[176:191]
  buffer_load_dwordx4 v[44:47], v255, s[36:39], s59 offen offset:3072 sc1
  v_mfma_f32_32x32x16_bf16 v[160:175], a[40:43], v[4:7], v[160:175]
  s_waitcnt vmcnt(9)
  v_mfma_f32_32x32x16_bf16 v[176:191], a[52:55], v[8:11], v[176:191]
  s_add_u32 s59, s59, 4096
  buffer_load_dwordx4 v[48:51], v255, s[36:39], s59 offen offset:0 sc1
  v_mfma_f32_32x32x16_bf16 v[160:175], a[48:51], v[8:11], v[160:175]
  s_waitcnt vmcnt(9)
  v_mfma_f32_32x32x16_bf16 v[176:191], a[60:63], v[12:15], v[176:191]
  buffer_load_dwordx4 v[52:55], v255, s[36:39], s59 offen offset:1024 sc1
  v_mfma_f32_32x32x16_bf16 v[160:175], a[56:59], v[12:15], v[160:175]
  s_waitcnt vmcnt(9)
  v_mfma_f32_32x32x16_bf16 v[176:191], a[68:71], v[16:19], v[176:191]
  buffer_load_dwordx4 v[56:59], v255, s[36:39], s59 offen offset:2048 sc1
  v_mfma_f32_32x32x16_bf16 v[160:175], a[64:67], v[16:19], v[160:175]
  s_waitcnt vmcnt(9)
  v_mfma_f32_32x32x16_bf16 v[176:191], a[76:79], v[20:23], v[176:191]
  buffer_load_dwordx4 v[60:63], v255, s[36:39], s59 offen offset:3072 sc1
  v_mfma_f32_32x32x16_bf16 v[160:175], a[72:75], v[20:23], v[160:175]
  s_waitcnt vmcnt(9)
  v_mfma_f32_32x32x16_bf16 v[176:191], a[84:87], v[24:27], v[176:191]
  s_add_u32 s59, s59, 4096
  buffer_load_dwordx4 v[64:67], v255, s[36:39], s59 offen offset:0 sc1
  v_mfma_f32_32x32x16_bf16 v[160:175], a[80:83], v[24:27], v[160:175]
  s_waitcnt vmcnt(9)
  v_mfma_f32_32x32x16_bf16 v[176:191], a[92:95], v[28:31], v[176:191]
  buffer_load_dwordx4 v[68:71], v255, s[36:39], s59 offen offset:1024 sc1
  v_mfma_f32_32x32x16_bf16 v[160:175], a[88:91], v[28:31], v[160:175]
  s_waitcnt vmcnt(9)
  v_mfma_f32_32x32x16_bf16 v[176:191], a[100:103], v[32:35], v[176:191]
  buffer_load_dwordx4 v[72:75], v255, s[36:39], s59 offen offset:2048 sc1
  v_mfma_f32_32x32x16_bf16 v[160:175], a[96:99], v[32:35], v[160:175]
  s_waitcnt vmcnt(9)
  v_mfma_f32_32x32x16_bf16 v[176:191], a[108:111], v[36:39], v[176:191]
  buffer_load_dwordx4 v[76:79], v255, s[36:39], s59 offen offset:3072 sc1
  v_mfma_f32_32x32x16_bf16 v[160:175], a[104:107], v[36:39], v[160:175]
  s_waitcnt vmcnt(9)
  v_mfma_f32_32x32x16_bf16 v[176:191], a[116:119], v[40:43], v[176:191]
  s_add_u32 s59, s59, 4096
  buffer_load_dwordx4 v[80:83], v255, s[36:39], s59 offen offset:0 sc1
  v_mfma_f32_32x32x16_bf16 v[160:175], a[112:115], v[40:43], v[160:175]
  s_waitcnt vmcnt(9)
  v_mfma_f32_32x32x16_bf16 v[176:191], a[124:127], v[44:47], v[176:191]
  buffer_load_dwordx4 v[84:87], v255, s[36:39], s59 offen offset:1024 sc1
  v_mfma_f32_32x32x16_bf16 v[160:175], a[120:123], v[44:47], v[160:175]
  s_waitcnt vmcnt(9)
  v_mfma_f32_32x32x16_bf16 v[176:191], a[132:135], v[48:51], v[176:191]
  buffer_load_dwordx4 v[88:91], v255, s[36:39], s59 offen offset:2048 sc1
  v_mfma_f32_32x32x16_bf16 v[160:175], a[128:131], v[48:51], v[160:175]
  s_waitcnt vmcnt(9)
  v_mfma_f32_32x32x16_bf16 v[176:191], a[140:143], v[52:55], v[176:191]
  buffer_load_dwordx4 v[92:95], v255, s[36:39], s59 offen offset:3072 sc1
  v_mfma_f32_32x32x16_bf16 v[160:175], a[136:139], v[52:55], v[160:175]
  s_waitcnt vmcnt(9)
  v_mfma_f32_32x32x16_bf16 v[176:191], a[148:151], v[56:59], v[176:191]
  v_mfma_f32_32x32x16_bf16 v[160:175], a[144:147], v[56:59], v[160:175]
  s_waitcnt vmcnt(8)
  v_mfma_f32_32x32x16_bf16 v[176:191], a[156:159], v[60:63], v[176:191]
  v_mfma_f32_32x32x16_bf16 v[160:175], a[152:155], v[60:63], v[160:175]
  s_waitcnt vmcnt(7)
  v_mfma_f32_32x32x16_bf16 v[176:191], a[164:167], v[64:67], v[176:191]
  v_mfma_f32_32x32x16_bf16 v[160:175], a[160:163], v[64:67], v[160:175]
  s_waitcnt vmcnt(6)
  v_mfma_f32_32x32x16_bf16 v[176:191], a[172:175], v[68:71], v[176:191]
  v_mfma_f32_32x32x16_bf16 v[160:175], a[168:171], v[68:71], v[160:175]
  s_waitcnt vmcnt(5)
  v_mfma_f32_32x32x16_bf16 v[176:191], a[180:183], v[72:75], v[176:191]
  v_mfma_f32_32x32x16_bf16 v[160:175], a[176:179], v[72:75], v[160:175]
  s_waitcnt vmcnt(4)
  v_mfma_f32_32x32x16_bf16 v[176:191], a[188:191], v[76:79], v[176:191]
  v_mfma_f32_32x32x16_bf16 v[160:175], a[184:187], v[76:79], v[160:175]
  s_waitcnt vmcnt(3)
  v_mfma_f32_32x32x16_bf16 v[176:191], a[196:199], v[80:83], v[176:191]
  v_mfma_f32_32x32x16_bf16 v[160:175], a[192:195], v[80:83], v[160:175]
  s_waitcnt vmcnt(2)
  v_mfma_f32_32x32x16_bf16 v[176:191], a[204:207], v[84:87], v[176:191]
  v_mfma_f32_32x32x16_bf16 v[160:175], a[200:203], v[84:87], v[160:175]
  s_waitcnt vmcnt(1)
  v_mfma_f32_32x32x16_bf16 v[176:191], a[212:215], v[88:91], v[176:191]
  v_mfma_f32_32x32x16_bf16 v[160:175], a[208:211], v[88:91], v[160:175]
  s_waitcnt vmcnt(0)
  v_mfma_f32_32x32x16_bf16 v[176:191], a[220:223], v[92:95], v[176:191]
  v_mfma_f32_32x32x16_bf16 v[160:175], a[216:219], v[92:95], v[160:175]
  s_nop 10
  ds_write_b128 v208, v[176:179] offset:0
  ds_write_b128 v208, v[180:183] offset:1024
  ds_write_b128 v208, v[184:187] offset:2048
  ds_write_b128 v208, v[188:191] offset:3072
  s_waitcnt lgkmcnt(0)
  s_barrier
  ds_read_b128 v[0:3], v212 offset:0
  ds_read_b128 v[4:7], v212 offset:1024
  ds_read_b128 v[8:11], v212 offset:2048
  ds_read_b128 v[12:15], v212 offset:3072
  ds_read_b128 v[16:19], v213 offset:0
  ds_read_b128 v[20:23], v213 offset:1024
  ds_read_b128 v[24:27], v213 offset:2048
  ds_read_b128 v[28:31], v213 offset:3072
  ds_read_b128 v[32:35], v214 offset:0
  ds_read_b128 v[36:39], v214 offset:1024
  ds_read_b128 v[40:43], v214 offset:2048
  ds_read_b128 v[44:47], v214 offset:3072
  s_waitcnt lgkmcnt(8)
  v_pk_add_f32 v[160:161], v[160:161], v[0:1]
  v_pk_add_f32 v[162:163], v[162:163], v[2:3]
  v_pk_add_f32 v[164:165], v[164:165], v[4:5]
  v_pk_add_f32 v[166:167], v[166:167], v[6:7]
  v_pk_add_f32 v[168:169], v[168:169], v[8:9]
  v_pk_add_f32 v[170:171], v[170:171], v[10:11]
  v_pk_add_f32 v[172:173], v[172:173], v[12:13]
  v_pk_add_f32 v[174:175], v[174:175], v[14:15]
  s_waitcnt lgkmcnt(4)
  v_pk_add_f32 v[160:161], v[160:161], v[16:17]
  v_pk_add_f32 v[162:163], v[162:163], v[18:19]
  v_pk_add_f32 v[164:165], v[164:165], v[20:21]
  v_pk_add_f32 v[166:167], v[166:167], v[22:23]
  v_pk_add_f32 v[168:169], v[168:169], v[24:25]
  v_pk_add_f32 v[170:171], v[170:171], v[26:27]
  v_pk_add_f32 v[172:173], v[172:173], v[28:29]
  v_pk_add_f32 v[174:175], v[174:175], v[30:31]
  s_waitcnt lgkmcnt(0)
  v_pk_add_f32 v[160:161], v[160:161], v[32:33]
  v_pk_add_f32 v[162:163], v[162:163], v[34:35]
  v_pk_add_f32 v[164:165], v[164:165], v[36:37]
  v_pk_add_f32 v[166:167], v[166:167], v[38:39]
  v_pk_add_f32 v[168:169], v[168:169], v[40:41]
  v_pk_add_f32 v[170:171], v[170:171], v[42:43]
  v_pk_add_f32 v[172:173], v[172:173], v[44:45]
  v_pk_add_f32 v[174:175], v[174:175], v[46:47]
  s_barrier
  v_cvt_pk_bf16_f32 v216, v160, v161
  v_cvt_pk_bf16_f32 v217, v162, v163
  v_cvt_pk_bf16_f32 v218, v164, v165
  v_cvt_pk_bf16_f32 v219, v166, v167
  v_cvt_pk_bf16_f32 v220, v168, v169
  v_cvt_pk_bf16_f32 v221, v170, v171
  v_cvt_pk_bf16_f32 v222, v172, v173
  v_cvt_pk_bf16_f32 v223, v174, v175
  s_cmp_eq_u32 s46, 0
  s_cbranch_scc1 L_st_27
  buffer_store_dwordx4 v[216:219], v255, s[36:39], s52 offen
  buffer_store_dwordx4 v[220:223], v255, s[36:39], s52 offen offset:1024
  s_branch L_st_27_e
L_st_27:
  buffer_store_dwordx4 v[216:219], v255, s[36:39], s52 offen sc0 sc1
  buffer_store_dwordx4 v[220:223], v255, s[36:39], s52 offen offset:1024 sc0 sc1
L_st_27_e:
  v_pk_add_f32 v[224:225], v[160:161], v[162:163]
  v_pk_mul_f32 v[226:227], v[160:161], v[160:161]
  v_pk_fma_f32 v[226:227], v[162:163], v[162:163], v[226:227]
  v_pk_add_f32 v[224:225], v[224:225], v[164:165]
  v_pk_fma_f32 v[226:227], v[164:165], v[164:165], v[226:227]
  v_pk_add_f32 v[224:225], v[224:225], v[166:167]
  v_pk_fma_f32 v[226:227], v[166:167], v[166:167], v[226:227]
  v_pk_add_f32 v[224:225], v[224:225], v[168:169]
  v_pk_fma_f32 v[226:227], v[168:169], v[168:169], v[226:227]
  v_pk_add_f32 v[224:225], v[224:225], v[170:171]
  v_pk_fma_f32 v[226:227], v[170:171], v[170:171], v[226:227]
  v_pk_add_f32 v[224:225], v[224:225], v[172:173]
  v_pk_fma_f32 v[226:227], v[172:173], v[172:173], v[226:227]
  v_pk_add_f32 v[224:225], v[224:225], v[174:175]
  v_pk_fma_f32 v[226:227], v[174:175], v[174:175], v[226:227]
  v_add_f32 v224, v224, v225
  v_add_f32 v225, v226, v227
  s_nop 1
  v_permlane32_swap_b32 v224, v225
  v_add_f32 v224, v224, v225
  s_cmp_eq_u32 s46, 0
  s_cbranch_scc1 L_st_28
  buffer_store_dword v224, v240, s[36:39], s53 offen
  s_branch L_st_28_e
L_st_28:
  buffer_store_dword v224, v240, s[36:39], s53 offen sc0 sc1
L_st_28_e:
  s_waitcnt vmcnt(0)
  s_or_b32 s70, s44, 4
  v_mov_b32 v236, s70
  v_mov_b32 v237, s45
  v_mov_b32 v238, 0
  s_mov_b64 exec, 1
  s_cmp_eq_u32 s46, 0
  s_cbranch_scc1 L_fs_29
  buffer_store_dwordx2 v[236:237], v238, s[36:39], s54 offen
  s_branch L_fs_29_e
L_fs_29:
  buffer_store_dwordx2 v[236:237], v238, s[36:39], s54 offen sc0 sc1
L_fs_29_e:
  s_mov_b64 exec, -1
  s_and_b32 s74, s40, 1
  s_lshl_b32 s74, s74, 1
  s_lshl_b32 s63, 0x33333333, s74
  s_cmp_lt_u32 s40, 2
  s_cselect_b32 s64, s63, 0
  s_cselect_b32 s65, 0, s63
  s_lshl_b32 s71, s41, 9
  s_add_u32 s71, s71, 0
  s_or_b32 s70, s44, 4
  s_mov_b32 s68, s64
  s_mov_b32 s69, s65
  s_mov_b32 s80, 0
L_poll_30:
  buffer_load_dwordx2 v[236:237], v248, s[36:39], s71 offen sc1
  s_add_u32 s80, s80, 1
  s_cmp_gt_u32 s80, 0x40000
  s_cbranch_scc1 L_poll_30_x
  s_waitcnt vmcnt(0)
  v_subrev_u32 v236, s70, v236
  v_cmp_ge_u32 vcc, 11, v236
  v_cmp_eq_u32 s[66:67], s45, v237
  s_and_b64 vcc, vcc, s[66:67]
  s_andn2_b64 s[66:67], s[68:69], vcc
  s_cbranch_scc1 L_poll_30
L_poll_30_x:
  s_waitcnt vmcnt(0)
  s_lshl_b32 s75, s41, 2
  s_add_u32 s75, s75, s40
  s_mul_i32 s75, s75, 33280
  s_add_u32 s75, s75, 4194304
  s_lshl_b32 s77, s41, 2
  s_add_u32 s77, s77, s40
  s_mul_i32 s77, s77, 4096
  s_add_u32 s77, s77, 65536
  buffer_load_dwordx4 v[208:211], v255, s[36:39], s77 offen offset:0 sc1
  buffer_load_dwordx4 v[212:215], v255, s[36:39], s77 offen offset:1024 sc1
  buffer_load_dwordx4 v[216:219], v255, s[36:39], s77 offen offset:2048 sc1
  buffer_load_dwordx4 v[220:223], v255, s[36:39], s77 offen offset:3072 sc1
  s_mov_b32 s59, s75
  s_and_b32 s56, s42, 7
  s_lshl_b32 s56, s56, 7
  s_mul_i32 s57, s40, 8192
  s_add_u32 s56, s56, s57
  s_add_u32 s56, s56, 0
  s_lshl_b32 s57, s40, 10
  s_add_u32 s57, s57, 131072
  buffer_load_dwordx4 v[0:3], v255, s[36:39], s59 offen offset:0 sc1
  buffer_load_dwordx4 v[4:7], v255, s[36:39], s59 offen offset:1024 sc1
  buffer_load_dwordx4 v[8:11], v255, s[36:39], s59 offen offset:2048 sc1
  buffer_load_dwordx4 v[12:15], v255, s[36:39], s59 offen offset:3072 sc1
  s_add_u32 s59, s59, 4096
  buffer_load_dwordx4 v[16:19], v255, s[36:39], s59 offen offset:0 sc1
  buffer_load_dwordx4 v[20:23], v255, s[36:39], s59 offen offset:1024 sc1
  buffer_load_dwordx4 v[24:27], v255, s[36:39], s59 offen offset:2048 sc1
  buffer_load_dwordx4 v[28:31], v255, s[36:39], s59 offen offset:3072 sc1
  s_add_u32 s59, s59, 4096
  buffer_load_dwordx4 v[32:35], v255, s[36:39], s59 offen offset:0 sc1
  ds_read_b64_tr_b16 v[176:177], v254 offset:0
  ds_read_b64_tr_b16 v[178:179], v254 offset:256
  ds_read_b64_tr_b16 v[180:181], v254 offset:32768
  ds_read_b64_tr_b16 v[182:183], v254 offset:33024
  ds_read_b64_tr_b16 v[184:185], v254 offset:512
  ds_read_b64_tr_b16 v[186:187], v254 offset:768
  ds_read_b64_tr_b16 v[188:189], v254 offset:33280
  ds_read_b64_tr_b16 v[190:191], v254 offset:33536
  ds_read_b64_tr_b16 v[192:193], v254 offset:2048
  ds_read_b64_tr_b16 v[194:195], v254 offset:2304
  ds_read_b64_tr_b16 v[196:197], v254 offset:34816
  ds_read_b64_tr_b16 v[198:199], v254 offset:35072
  s_waitcnt vmcnt(8)
  s_waitcnt lgkmcnt(8)
  v_mfma_f32_32x32x16_bf16 v[128:143], v[176:179], v[0:3], 0
  v_add_f32 v208, v208, v210
  v_add_f32 v209, v209, v211
  ds_read_b64_tr_b16 v[200:201], v254 offset:2560
  ds_read_b64_tr_b16 v[202:203], v254 offset:2816
  ds_read_b64_tr_b16 v[204:205], v254 offset:35328
  ds_read_b64_tr_b16 v[206:207], v254 offset:35584
  v_mfma_f32_32x32x16_bf16 v[144:159], v[0:3], v[180:183], 0
  v_add_f32 v208, v208, v212
  v_add_f32 v209, v209, v213
  v_add_f32 v208, v208, v214
  v_add_f32 v209, v209, v215
  v_add_f32 v208, v208, v216
  buffer_load_dwordx4 v[36:39], v255, s[36:39], s59 offen offset:1024 sc1
  s_waitcnt vmcnt(8)
  s_waitcnt lgkmcnt(8)
  v_mfma_f32_32x32x16_bf16 v[128:143], v[184:187], v[4:7], v[128:143]
  v_add_f32 v209, v209, v217
  v_add_f32 v208, v208, v218
  ds_read_b64_tr_b16 v[176:177], v254 offset:4096
  ds_read_b64_tr_b16 v[178:179], v254 offset:4352
  ds_read_b64_tr_b16 v[180:181], v254 offset:36864
  ds_read_b64_tr_b16 v[182:183], v254 offset:37120
  v_mfma_f32_32x32x16_bf16 v[144:159], v[4:7], v[188:191], v[144:159]
  v_add_f32 v209, v209, v219
  v_add_f32 v208, v208, v220
  v_add_f32 v209, v209, v221
  v_add_f32 v208, v208, v222
  v_add_f32 v209, v209, v223
  buffer_load_dwordx4 v[40:43], v255, s[36:39], s59 offen offset:2048 sc1
  s_waitcnt vmcnt(8)
  s_waitcnt lgkmcnt(8)
  v_mfma_f32_32x32x16_bf16 v[128:143], v[192:195], v[8:11], v[128:143]
  v_permlane32_swap_b32 v208, v209
  ds_read_b64_tr_b16 v[184:185], v254 offset:4608
  ds_read_b64_tr_b16 v[186:187], v254 offset:4864
  ds_read_b64_tr_b16 v[188:189], v254 offset:37376
  ds_read_b64_tr_b16 v[190:191], v254 offset:37632
  v_mfma_f32_32x32x16_bf16 v[144:159], v[8:11], v[196:199], v[144:159]
  v_add_f32 v208, v208, v209
  v_mov_b32 v209, v208
  s_nop 1
  v_permlane32_swap_b32 v208, v209
  v_mul_f32 v208, 0x3b000000, v208
  buffer_load_dwordx4 v[44:47], v255, s[36:39], s59 offen offset:3072 sc1
  s_waitcnt vmcnt(8)
  s_waitcnt lgkmcnt(8)
  v_mfma_f32_32x32x16_bf16 v[128:143], v[200:203], v[12:15], v[128:143]
  v_mul_f32 v209, 0x3b000000, v209
  v_fma_f32 v209, -v208, v208, v209
  ds_read_b64_tr_b16 v[192:193], v254 offset:6144
  ds_read_b64_tr_b16 v[194:195], v254 offset:6400
  ds_read_b64_tr_b16 v[196:197], v254 offset:38912
  ds_read_b64_tr_b16 v[198:199], v254 offset:39168
  v_mfma_f32_32x32x16_bf16 v[144:159], v[12:15], v[204:207], v[144:159]
  v_max_f32 v209, 0, v209
  v_add_f32 v209, 0x3727c5ac, v209
  v_rsq_f32 v233, v209
  s_add_u32 s59, s59, 4096
  buffer_load_dwordx4 v[48:51], v255, s[36:39], s59 offen offset:0 sc1
  s_waitcnt vmcnt(8)
  s_waitcnt lgkmcnt(8)
  v_mfma_f32_32x32x16_bf16 v[128:143], v[176:179], v[16:19], v[128:143]
  v_mul_f32 v232, 0x3fb8aa3b, v233
  v_sub_f32 v234, 0, v208
  ds_read_b64_tr_b16 v[200:201], v254 offset:6656
  ds_read_b64_tr_b16 v[202:203], v254 offset:6912
  ds_read_b64_tr_b16 v[204:205], v254 offset:39424
  ds_read_b64_tr_b16 v[206:207], v254 offset:39680
  v_mfma_f32_32x32x16_bf16 v[144:159], v[16:19], v[180:183], v[144:159]
  v_cvt_pk_bf16_f32 v228, v234, v234
  v_and_b32 v235, 0xffff0000, v228
  v_sub_f32 v235, v234, v235
  v_cvt_pk_bf16_f32 v229, v235, 0
  v_cndmask_b32 v228, 0, v228, s[48:49]
  buffer_load_dwordx4 v[52:55], v255, s[36:39], s59 offen offset:1024 sc1
  s_waitcnt vmcnt(8)
  s_waitcnt lgkmcnt(8)
  v_mfma_f32_32x32x16_bf16 v[128:143], v[184:187], v[20:23], v[128:143]
  v_cndmask_b32 v229, 0, v229, s[48:49]
  v_mov_b32 v230, 0
  ds_read_b64_tr_b16 v[176:177], v254 offset:8192
  ds_read_b64_tr_b16 v[178:179], v254 offset:8448
  ds_read_b64_tr_b16 v[180:181], v254 offset:40960
  ds_read_b64_tr_b16 v[182:183], v254 offset:41216
  v_mfma_f32_32x32x16_bf16 v[144:159], v[20:23], v[188:191], v[144:159]
  v_mov_b32 v231, 0
  buffer_load_dwordx4 v[56:59], v255, s[36:39], s59 offen offset:2048 sc1
  s_waitcnt vmcnt(8)
  s_waitcnt lgkmcnt(8)
  v_mfma_f32_32x32x16_bf16 v[128:143], v[192:195], v[24:27], v[128:143]
  ds_read_b64_tr_b16 v[184:185], v254 offset:8704
  ds_read_b64_tr_b16 v[186:187], v254 offset:8960
  ds_read_b64_tr_b16 v[188:189], v254 offset:41472
  ds_read_b64_tr_b16 v[190:191], v254 offset:41728
  v_mfma_f32_32x32x16_bf16 v[144:159], v[24:27], v[196:199], v[144:159]
  buffer_load_dwordx4 v[60:63], v255, s[36:39], s59 offen offset:3072 sc1
  s_waitcnt vmcnt(8)
  s_waitcnt lgkmcnt(8)
  v_mfma_f32_32x32x16_bf16 v[128:143], v[200:203], v[28:31], v[128:143]
  ds_read_b64_tr_b16 v[192:193], v254 offset:10240
  ds_read_b64_tr_b16 v[194:195], v254 offset:10496
  ds_read_b64_tr_b16 v[196:197], v254 offset:43008
  ds_read_b64_tr_b16 v[198:199], v254 offset:43264
  v_mfma_f32_32x32x16_bf16 v[144:159], v[28:31], v[204:207], v[144:159]
  s_add_u32 s59, s59, 4096
  buffer_load_dwordx4 v[64:67], v255, s[36:39], s59 offen offset:0 sc1
  s_waitcnt vmcnt(8)
  s_waitcnt lgkmcnt(8)
  v_mfma_f32_32x32x16_bf16 v[128:143], v[176:179], v[32:35], v[128:143]
  ds_read_b64_tr_b16 v[200:201], v254 offset:10752
  ds_read_b64_tr_b16 v[202:203], v254 offset:11008
  ds_read_b64_tr_b16 v[204:205], v254 offset:43520
  ds_read_b64_tr_b16 v[206:207], v254 offset:43776
  v_mfma_f32_32x32x16_bf16 v[144:159], v[32:35], v[180:183], v[144:159]
  buffer_load_dwordx4 v[68:71], v255, s[36:39], s59 offen offset:1024 sc1
  s_waitcnt vmcnt(8)
  s_waitcnt lgkmcnt(8)
  v_mfma_f32_32x32x16_bf16 v[128:143], v[184:187], v[36:39], v[128:143]
  ds_read_b64_tr_b16 v[176:177], v254 offset:12288
  ds_read_b64_tr_b16 v[178:179], v254 offset:12544
  ds_read_b64_tr_b16 v[180:181], v254 offset:45056
  ds_read_b64_tr_b16 v[182:183], v254 offset:45312
  v_mfma_f32_32x32x16_bf16 v[144:159], v[36:39], v[188:191], v[144:159]
  buffer_load_dwordx4 v[72:75], v255, s[36:39], s59 offen offset:2048 sc1
  s_waitcnt vmcnt(8)
  s_waitcnt lgkmcnt(8)
  v_mfma_f32_32x32x16_bf16 v[128:143], v[192:195], v[40:43], v[128:143]
  ds_read_b64_tr_b16 v[184:185], v254 offset:12800
  ds_read_b64_tr_b16 v[186:187], v254 offset:13056
  ds_read_b64_tr_b16 v[188:189], v254 offset:45568
  ds_read_b64_tr_b16 v[190:191], v254 offset:45824
  v_mfma_f32_32x32x16_bf16 v[144:159], v[40:43], v[196:199], v[144:159]
  buffer_load_dwordx4 v[76:79], v255, s[36:39], s59 offen offset:3072 sc1
  s_waitcnt vmcnt(8)
  s_waitcnt lgkmcnt(8)
  v_mfma_f32_32x32x16_bf16 v[128:143], v[200:203], v[44:47], v[128:143]
  ds_read_b64_tr_b16 v[192:193], v254 offset:14336
  ds_read_b64_tr_b16 v[194:195], v254 offset:14592
  ds_read_b64_tr_b16 v[196:197], v254 offset:47104
  ds_read_b64_tr_b16 v[198:199], v254 offset:47360
  v_mfma_f32_32x32x16_bf16 v[144:159], v[44:47], v[204:207], v[144:159]
  s_add_u32 s59, s59, 4096
  buffer_load_dwordx4 v[80:83], v255, s[36:39], s59 offen offset:0 sc1
  s_waitcnt vmcnt(8)
  s_waitcnt lgkmcnt(8)
  v_mfma_f32_32x32x16_bf16 v[128:143], v[176:179], v[48:51], v[128:143]
  ds_read_b64_tr_b16 v[200:201], v254 offset:14848
  ds_read_b64_tr_b16 v[202:203], v254 offset:15104
  ds_read_b64_tr_b16 v[204:205], v254 offset:47616
  ds_read_b64_tr_b16 v[206:207], v254 offset:47872
  v_mfma_f32_32x32x16_bf16 v[144:159], v[48:51], v[180:183], v[144:159]
  buffer_load_dwordx4 v[84:87], v255, s[36:39], s59 offen offset:1024 sc1
  s_waitcnt vmcnt(8)
  s_waitcnt lgkmcnt(8)
  v_mfma_f32_32x32x16_bf16 v[128:143], v[184:187], v[52:55], v[128:143]
  ds_read_b64_tr_b16 v[176:177], v254 offset:16384
  ds_read_b64_tr_b16 v[178:179], v254 offset:16640
  ds_read_b64_tr_b16 v[180:181], v254 offset:49152
  ds_read_b64_tr_b16 v[182:183], v254 offset:49408
  v_mfma_f32_32x32x16_bf16 v[144:159], v[52:55], v[188:191], v[144:159]
  buffer_load_dwordx4 v[88:91], v255, s[36:39], s59 offen offset:2048 sc1
  s_waitcnt vmcnt(8)
  s_waitcnt lgkmcnt(8)
  v_mfma_f32_32x32x16_bf16 v[128:143], v[192:195], v[56:59], v[128:143]
  ds_read_b64_tr_b16 v[184:185], v254 offset:16896
  ds_read_b64_tr_b16 v[186:187], v254 offset:17152
  ds_read_b64_tr_b16 v[188:189], v254 offset:49664
  ds_read_b64_tr_b16 v[190:191], v254 offset:49920
  v_mfma_f32_32x32x16_bf16 v[144:159], v[56:59], v[196:199], v[144:159]
  buffer_load_dwordx4 v[92:95], v255, s[36:39], s59 offen offset:3072 sc1
  s_waitcnt vmcnt(8)
  s_waitcnt lgkmcnt(8)
  v_mfma_f32_32x32x16_bf16 v[128:143], v[200:203], v[60:63], v[128:143]
  ds_read_b64_tr_b16 v[192:193], v254 offset:18432
  ds_read_b64_tr_b16 v[194:195], v254 offset:18688
  ds_read_b64_tr_b16 v[196:197], v254 offset:51200
  ds_read_b64_tr_b16 v[198:199], v254 offset:51456
  v_mfma_f32_32x32x16_bf16 v[144:159], v[60:63], v[204:207], v[144:159]
  s_add_u32 s59, s59, 4096
  buffer_load_dwordx4 v[96:99], v255, s[36:39], s59 offen offset:0 sc1
  s_waitcnt vmcnt(8)
  s_waitcnt lgkmcnt(8)
  v_mfma_f32_32x32x16_bf16 v[128:143], v[176:179], v[64:67], v[128:143]
  ds_read_b64_tr_b16 v[200:201], v254 offset:18944
  ds_read_b64_tr_b16 v[202:203], v254 offset:19200
  ds_read_b64_tr_b16 v[204:205], v254 offset:51712
  ds_read_b64_tr_b16 v[206:207], v254 offset:51968
  v_mfma_f32_32x32x16_bf16 v[144:159], v[64:67], v[180:183], v[144:159]
  buffer_load_dwordx4 v[100:103], v255, s[36:39], s59 offen offset:1024 sc1
  s_waitcnt vmcnt(8)
  s_waitcnt lgkmcnt(8)
  v_mfma_f32_32x32x16_bf16 v[128:143], v[184:187], v[68:71], v[128:143]
  ds_read_b64_tr_b16 v[176:177], v254 offset:20480
  ds_read_b64_tr_b16 v[178:179], v254 offset:20736
  ds_read_b64_tr_b16 v[180:181], v254 offset:53248
  ds_read_b64_tr_b16 v[182:183], v254 offset:53504
  v_mfma_f32_32x32x16_bf16 v[144:159], v[68:71], v[188:191], v[144:159]
  buffer_load_dwordx4 v[104:107], v255, s[36:39], s59 offen offset:2048 sc1
  s_waitcnt vmcnt(8)
  s_waitcnt lgkmcnt(8)
  v_mfma_f32_32x32x16_bf16 v[128:143], v[192:195], v[72:75], v[128:143]
  ds_read_b64_tr_b16 v[184:185], v254 offset:20992
  ds_read_b64_tr_b16 v[186:187], v254 offset:21248
  ds_read_b64_tr_b16 v[188:189], v254 offset:53760
  ds_read_b64_tr_b16 v[190:191], v254 offset:54016
  v_mfma_f32_32x32x16_bf16 v[144:159], v[72:75], v[196:199], v[144:159]
  buffer_load_dwordx4 v[108:111], v255, s[36:39], s59 offen offset:3072 sc1
  s_waitcnt vmcnt(8)
  s_waitcnt lgkmcnt(8)
  v_mfma_f32_32x32x16_bf16 v[128:143], v[200:203], v[76:79], v[128:143]
  ds_read_b64_tr_b16 v[192:193], v254 offset:22528
  ds_read_b64_tr_b16 v[194:195], v254 offset:22784
  ds_read_b64_tr_b16 v[196:197], v254 offset:55296
  ds_read_b64_tr_b16 v[198:199], v254 offset:55552
  v_mfma_f32_32x32x16_bf16 v[144:159], v[76:79], v[204:207], v[144:159]
  s_add_u32 s59, s59, 4096
  buffer_load_dwordx4 v[112:115], v255, s[36:39], s59 offen offset:0 sc1
  s_waitcnt vmcnt(8)
  s_waitcnt lgkmcnt(8)
  v_mfma_f32_32x32x16_bf16 v[128:143], v[176:179], v[80:83], v[128:143]
  ds_read_b64_tr_b16 v[200:201], v254 offset:23040
  ds_read_b64_tr_b16 v[202:203], v254 offset:23296
  ds_read_b64_tr_b16 v[204:205], v254 offset:55808
  ds_read_b64_tr_b16 v[206:207], v254 offset:56064
  v_mfma_f32_32x32x16_bf16 v[144:159], v[80:83], v[180:183], v[144:159]
  buffer_load_dwordx4 v[116:119], v255, s[36:39], s59 offen offset:1024 sc1
  s_waitcnt vmcnt(8)
  s_waitcnt lgkmcnt(8)
  v_mfma_f32_32x32x16_bf16 v[128:143], v[184:187], v[84:87], v[128:143]
  ds_read_b64_tr_b16 v[176:177], v254 offset:24576
  ds_read_b64_tr_b16 v[178:179], v254 offset:24832
  ds_read_b64_tr_b16 v[180:181], v254 offset:57344
  ds_read_b64_tr_b16 v[182:183], v254 offset:57600
  v_mfma_f32_32x32x16_bf16 v[144:159], v[84:87], v[188:191], v[144:159]
  buffer_load_dwordx4 v[120:123], v255, s[36:39], s59 offen offset:2048 sc1
  s_waitcnt vmcnt(8)
  s_waitcnt lgkmcnt(8)
  v_mfma_f32_32x32x16_bf16 v[128:143], v[192:195], v[88:91], v[128:143]
  ds_read_b64_tr_b16 v[184:185], v254 offset:25088
  ds_read_b64_tr_b16 v[186:187], v254 offset:25344
  ds_read_b64_tr_b16 v[188:189], v254 offset:57856
  ds_read_b64_tr_b16 v[190:191], v254 offset:58112
  v_mfma_f32_32x32x16_bf16 v[144:159], v[88:91], v[196:199], v[144:159]
  buffer_load_dwordx4 v[124:127], v255, s[36:39], s59 offen offset:3072 sc1
  s_waitcnt vmcnt(8)
  s_waitcnt lgkmcnt(8)
  v_mfma_f32_32x32x16_bf16 v[128:143], v[200:203], v[92:95], v[128:143]
  ds_read_b64_tr_b16 v[192:193], v254 offset:26624
  ds_read_b64_tr_b16 v[194:195], v254 offset:26880
  ds_read_b64_tr_b16 v[196:197], v254 offset:59392
  ds_read_b64_tr_b16 v[198:199], v254 offset:59648
  v_mfma_f32_32x32x16_bf16 v[144:159], v[92:95], v[204:207], v[144:159]
  s_add_u32 s58, s92, 0
  s_and_b32 s58, s58, 7
  s_lshl_b32 s81, s58, 12
  s_add_u32 m0, s81, s57
  s_mul_i32 s58, s58, 32768
  s_add_u32 s58, s58, s56
  buffer_load_dwordx4 v247, s[16:19], s58 offen lds
  s_add_u32 s58, s92, 1
  s_and_b32 s58, s58, 7
  s_lshl_b32 s81, s58, 12
  s_add_u32 m0, s81, s57
  s_mul_i32 s58, s58, 32768
  s_add_u32 s58, s58, s56
  buffer_load_dwordx4 v247, s[16:19], s58 offen lds
  s_waitcnt vmcnt(9)
  s_waitcnt lgkmcnt(8)
  v_mfma_f32_32x32x16_bf16 v[128:143], v[176:179], v[96:99], v[128:143]
  ds_read_b64_tr_b16 v[200:201], v254 offset:27136
  ds_read_b64_tr_b16 v[202:203], v254 offset:27392
  ds_read_b64_tr_b16 v[204:205], v254 offset:59904
  ds_read_b64_tr_b16 v[206:207], v254 offset:60160
  v_mfma_f32_32x32x16_bf16 v[144:159], v[96:99], v[180:183], v[144:159]
  s_add_u32 s58, s92, 2
  s_and_b32 s58, s58, 7
  s_lshl_b32 s81, s58, 12
  s_add_u32 m0, s81, s57
  s_mul_i32 s58, s58, 32768
  s_add_u32 s58, s58, s56
  buffer_load_dwordx4 v247, s[16:19], s58 offen lds
  s_add_u32 s58, s92, 3
  s_and_b32 s58, s58, 7
  s_lshl_b32 s81, s58, 12
  s_add_u32 m0, s81, s57
  s_mul_i32 s58, s58, 32768
  s_add_u32 s58, s58, s56
  buffer_load_dwordx4 v247, s[16:19], s58 offen lds
  v_mfma_f32_32x32x16_bf16 v[128:143], a[240:243], v[228:231], v[128:143]
  v_mfma_f32_32x32x16_bf16 v[144:159], v[228:231], a[242:245], v[144:159]
  s_waitcnt vmcnt(10)
  s_waitcnt lgkmcnt(8)
  v_mfma_f32_32x32x16_bf16 v[128:143], v[184:187], v[100:103], v[128:143]
  ds_read_b64_tr_b16 v[176:177], v254 offset:28672
  ds_read_b64_tr_b16 v[178:179], v254 offset:28928
  ds_read_b64_tr_b16 v[180:181], v254 offset:61440
  ds_read_b64_tr_b16 v[182:183], v254 offset:61696
  v_mfma_f32_32x32x16_bf16 v[144:159], v[100:103], v[188:191], v[144:159]
  s_add_u32 s58, s92, 4
  s_and_b32 s58, s58, 7
  s_lshl_b32 s81, s58, 12
  s_add_u32 m0, s81, s57
  s_mul_i32 s58, s58, 32768
  s_add_u32 s58, s58, s56
  buffer_load_dwordx4 v247, s[16:19], s58 offen lds
  s_add_u32 s58, s92, 5
  s_and_b32 s58, s58, 7
  s_lshl_b32 s81, s58, 12
  s_add_u32 m0, s81, s57
  s_mul_i32 s58, s58, 32768
  s_add_u32 s58, s58, s56
  buffer_load_dwordx4 v247, s[16:19], s58 offen lds
  s_waitcnt vmcnt(11)
  s_waitcnt lgkmcnt(8)
  v_mfma_f32_32x32x16_bf16 v[128:143], v[192:195], v[104:107], v[128:143]
  ds_read_b64_tr_b16 v[184:185], v254 offset:29184
  ds_read_b64_tr_b16 v[186:187], v254 offset:29440
  ds_read_b64_tr_b16 v[188:189], v254 offset:61952
  ds_read_b64_tr_b16 v[190:191], v254 offset:62208
  v_mfma_f32_32x32x16_bf16 v[144:159], v[104:107], v[196:199], v[144:159]
  s_add_u32 s58, s92, 6
  s_and_b32 s58, s58, 7
  s_lshl_b32 s81, s58, 12
  s_add_u32 m0, s81, s57
  s_mul_i32 s58, s58, 32768
  s_add_u32 s58, s58, s56
  buffer_load_dwordx4 v247, s[16:19], s58 offen lds
  s_add_u32 s58, s92, 7
  s_and_b32 s58, s58, 7
  s_lshl_b32 s81, s58, 12
  s_add_u32 m0, s81, s57
  s_mul_i32 s58, s58, 32768
  s_add_u32 s58, s58, s56
  buffer_load_dwordx4 v247, s[16:19], s58 offen lds
  s_waitcnt vmcnt(12)
  s_waitcnt lgkmcnt(8)
  v_mfma_f32_32x32x16_bf16 v[128:143], v[200:203], v[108:111], v[128:143]
  ds_read_b64_tr_b16 v[192:193], v254 offset:30720
  ds_read_b64_tr_b16 v[194:195], v254 offset:30976
  ds_read_b64_tr_b16 v[196:197], v254 offset:63488
  ds_read_b64_tr_b16 v[198:199], v254 offset:63744
  v_mfma_f32_32x32x16_bf16 v[144:159], v[108:111], v[204:207], v[144:159]
  s_waitcnt vmcnt(11)
  s_waitcnt lgkmcnt(8)
  v_mfma_f32_32x32x16_bf16 v[128:143], v[176:179], v[112:115], v[128:143]
  ds_read_b64_tr_b16 v[200:201], v254 offset:31232
  ds_read_b64_tr_b16 v[202:203], v254 offset:31488
  ds_read_b64_tr_b16 v[204:205], v254 offset:64000
  ds_read_b64_tr_b16 v[206:207], v254 offset:64256
  v_mfma_f32_32x32x16_bf16 v[144:159], v[112:115], v[180:183], v[144:159]
  s_waitcnt vmcnt(10)
  s_waitcnt lgkmcnt(8)
  v_mfma_f32_32x32x16_bf16 v[128:143], v[184:187], v[116:119], v[128:143]
  v_mfma_f32_32x32x16_bf16 v[144:159], v[116:119], v[188:191], v[144:159]
  s_waitcnt vmcnt(9)
  s_waitcnt lgkmcnt(4)
  v_mfma_f32_32x32x16_bf16 v[128:143], v[192:195], v[120:123], v[128:143]
  v_mfma_f32_32x32x16_bf16 v[144:159], v[120:123], v[196:199], v[144:159]
  s_waitcnt vmcnt(8)
  s_waitcnt lgkmcnt(0)
  v_mfma_f32_32x32x16_bf16 v[128:143], v[200:203], v[124:127], v[128:143]
  v_mfma_f32_32x32x16_bf16 v[144:159], v[124:127], v[204:207], v[144:159]
  s_nop 10
  v_cvt_pk_bf16_f32 v176, v128, v129
  v_cvt_pk_bf16_f32 v177, v130, v131
  v_cvt_pk_bf16_f32 v178, v132, v133
  v_cvt_pk_bf16_f32 v179, v134, v135
  v_cvt_pk_bf16_f32 v180, v136, v137
  v_cvt_pk_bf16_f32 v181, v138, v139
  v_cvt_pk_bf16_f32 v182, v140, v141
  v_cvt_pk_bf16_f32 v183, v142, v143
  v_mfma_f32_32x32x16_bf16 v[184:199], a[224:227], v[176:179], 0
  s_nop 0
  v_mfma_f32_32x32x16_bf16 v[184:199], a[228:231], v[180:183], v[184:199]
  s_barrier
  s_lshl_b32 s74, s40, 7
  s_add_u32 s74, s74, 118784
  v_and_b32 v234, 31, v244
  v_lshlrev_b32 v234, 2, v234
  v_add_u32 v234, s74, v234
  ds_write_b32 v234, v233
  v_add_u32 v235, s74, v243
  ds_read_b128 v[128:131], v235 offset:0
  ds_read_b128 v[132:135], v235 offset:32
  ds_read_b128 v[136:139], v235 offset:64
  ds_read_b128 v[140:143], v235 offset:96
  v_max3_f32 v200, v184, v185, v186
  v_max3_f32 v201, -v184, -v185, -v186
  v_max3_f32 v200, v200, v187, v188
  v_max3_f32 v201, v201, -v187, -v188
  v_max3_f32 v200, v200, v189, v190
  v_max3_f32 v201, v201, -v189, -v190
  v_max_f32 v200, v200, v191
  v_max_f32 v201, v201, -v191
  v_max3_f32 v202, v192, v193, v194
  v_max3_f32 v203, -v192, -v193, -v194
  v_max3_f32 v202, v202, v195, v196
  v_max3_f32 v203, v203, -v195, -v196
  v_max3_f32 v202, v202, v197, v198
  v_max3_f32 v203, v203, -v197, -v198
  v_max_f32 v202, v202, v199
  v_max_f32 v203, v203, -v199
  v_permlane32_swap_b32 v200, v201
  s_nop 0
  v_permlane32_swap_b32 v202, v203
  v_max_f32 v200, v200, v201
  v_max_f32 v202, v202, v203
  v_mov_b32 v201, v200
  v_mov_b32 v203, v202
  s_nop 0
  v_permlane32_swap_b32 v200, v201
  v_permlane32_swap_b32 v202, v203
  v_pk_mul_f32 v[200:201], v[200:201], v[232:233] op_sel_hi:[1,0]
  v_pk_mul_f32 v[202:203], v[202:203], v[232:233] op_sel_hi:[1,0]
  v_mov_b32 v204, v201
  v_pk_fma_f32 v[208:209], v[184:185], v[232:233], v[204:205] op_sel_hi:[1,0,0] neg_lo:[1,0,1] neg_hi:[1,0,1]
  v_pk_fma_f32 v[184:185], v[184:185], v[232:233], v[200:201] op_sel_hi:[1,0,0] neg_lo:[0,0,1] neg_hi:[0,0,1]
  v_pk_fma_f32 v[210:211], v[186:187], v[232:233], v[204:205] op_sel_hi:[1,0,0] neg_lo:[1,0,1] neg_hi:[1,0,1]
  v_pk_fma_f32 v[186:187], v[186:187], v[232:233], v[200:201] op_sel_hi:[1,0,0] neg_lo:[0,0,1] neg_hi:[0,0,1]
  v_pk_fma_f32 v[212:213], v[188:189], v[232:233], v[204:205] op_sel_hi:[1,0,0] neg_lo:[1,0,1] neg_hi:[1,0,1]
  v_pk_fma_f32 v[188:189], v[188:189], v[232:233], v[200:201] op_sel_hi:[1,0,0] neg_lo:[0,0,1] neg_hi:[0,0,1]
  v_pk_fma_f32 v[214:215], v[190:191], v[232:233], v[204:205] op_sel_hi:[1,0,0] neg_lo:[1,0,1] neg_hi:[1,0,1]
  v_pk_fma_f32 v[190:191], v[190:191], v[232:233], v[200:201] op_sel_hi:[1,0,0] neg_lo:[0,0,1] neg_hi:[0,0,1]
  v_mov_b32 v206, v203
  v_pk_fma_f32 v[216:217], v[192:193], v[232:233], v[206:207] op_sel_hi:[1,0,0] neg_lo:[1,0,1] neg_hi:[1,0,1]
  v_pk_fma_f32 v[192:193], v[192:193], v[232:233], v[202:203] op_sel_hi:[1,0,0] neg_lo:[0,0,1] neg_hi:[0,0,1]
  v_pk_fma_f32 v[218:219], v[194:195], v[232:233], v[206:207] op_sel_hi:[1,0,0] neg_lo:[1,0,1] neg_hi:[1,0,1]
  v_pk_fma_f32 v[194:195], v[194:195], v[232:233], v[202:203] op_sel_hi:[1,0,0] neg_lo:[0,0,1] neg_hi:[0,0,1]
  v_pk_fma_f32 v[220:221], v[196:197], v[232:233], v[206:207] op_sel_hi:[1,0,0] neg_lo:[1,0,1] neg_hi:[1,0,1]
  v_pk_fma_f32 v[196:197], v[196:197], v[232:233], v[202:203] op_sel_hi:[1,0,0] neg_lo:[0,0,1] neg_hi:[0,0,1]
  v_pk_fma_f32 v[222:223], v[198:199], v[232:233], v[206:207] op_sel_hi:[1,0,0] neg_lo:[1,0,1] neg_hi:[1,0,1]
  v_pk_fma_f32 v[198:199], v[198:199], v[232:233], v[202:203] op_sel_hi:[1,0,0] neg_lo:[0,0,1] neg_hi:[0,0,1]
  v_exp_f32 v184, v184
  v_exp_f32 v208, v208
  v_exp_f32 v185, v185
  v_exp_f32 v209, v209
  v_exp_f32 v186, v186
  v_exp_f32 v210, v210
  v_exp_f32 v187, v187
  v_exp_f32 v211, v211
  v_exp_f32 v188, v188
  v_exp_f32 v212, v212
  v_exp_f32 v189, v189
  v_exp_f32 v213, v213
  v_exp_f32 v190, v190
  v_exp_f32 v214, v214
  v_exp_f32 v191, v191
  v_exp_f32 v215, v215
  v_exp_f32 v192, v192
  v_exp_f32 v216, v216
  v_exp_f32 v193, v193
  v_exp_f32 v217, v217
  v_exp_f32 v194, v194
  v_exp_f32 v218, v218
  v_exp_f32 v195, v195
  v_exp_f32 v219, v219
  v_exp_f32 v196, v196
  v_exp_f32 v220, v220
  v_exp_f32 v197, v197
  v_exp_f32 v221, v221
  v_exp_f32 v198, v198
  v_exp_f32 v222, v222
  v_exp_f32 v199, v199
  v_exp_f32 v223, v223
  v_pk_add_f32 v[200:201], v[184:185], v[186:187]
  v_pk_add_f32 v[204:205], v[208:209], v[210:211]
  v_pk_add_f32 v[200:201], v[200:201], v[188:189]
  v_pk_add_f32 v[204:205], v[204:205], v[212:213]
  v_pk_add_f32 v[200:201], v[200:201], v[190:191]
  v_pk_add_f32 v[204:205], v[204:205], v[214:215]
  v_add_f32 v200, v200, v201
  v_add_f32 v201, v204, v205
  v_pk_add_f32 v[202:203], v[192:193], v[194:195]
  v_pk_add_f32 v[206:207], v[216:217], v[218:219]
  v_pk_add_f32 v[202:203], v[202:203], v[196:197]
  v_pk_add_f32 v[206:207], v[206:207], v[220:221]
  v_pk_add_f32 v[202:203], v[202:203], v[198:199]
  v_pk_add_f32 v[206:207], v[206:207], v[222:223]
  v_add_f32 v202, v202, v203
  v_add_f32 v203, v206, v207
  v_permlane32_swap_b32 v200, v201
  s_nop 0
  v_permlane32_swap_b32 v202, v203
  v_add_f32 v200, v200, v201
  v_add_f32 v202, v202, v203
  v_rcp_f32 v200, v200
  v_rcp_f32 v202, v202
  v_mov_b32 v204, v200
  v_mov_b32 v206, v202
  s_nop 0
  v_permlane32_swap_b32 v200, v204
  v_permlane32_swap_b32 v202, v206
  v_pk_mul_f32 v[184:185], v[184:185], v[200:201] op_sel_hi:[1,0]
  v_pk_mul_f32 v[208:209], v[208:209], v[204:205] op_sel_hi:[1,0]
  v_pk_mul_f32 v[186:187], v[186:187], v[200:201] op_sel_hi:[1,0]
  v_pk_mul_f32 v[210:211], v[210:211], v[204:205] op_sel_hi:[1,0]
  v_pk_mul_f32 v[188:189], v[188:189], v[200:201] op_sel_hi:[1,0]
  v_pk_mul_f32 v[212:213], v[212:213], v[204:205] op_sel_hi:[1,0]
  v_pk_mul_f32 v[190:191], v[190:191], v[200:201] op_sel_hi:[1,0]
  v_pk_mul_f32 v[214:215], v[214:215], v[204:205] op_sel_hi:[1,0]
  v_cvt_pk_bf16_f32 v160, v184, v185
  v_cvt_pk_bf16_f32 v164, v208, v209
  v_cvt_pk_bf16_f32 v161, v186, v187
  v_cvt_pk_bf16_f32 v165, v210, v211
  v_cvt_pk_bf16_f32 v162, v188, v189
  v_cvt_pk_bf16_f32 v166, v212, v213
  v_cvt_pk_bf16_f32 v163, v190, v191
  v_cvt_pk_bf16_f32 v167, v214, v215
  v_pk_mul_f32 v[192:193], v[192:193], v[202:203] op_sel_hi:[1,0]
  v_pk_mul_f32 v[216:217], v[216:217], v[206:207] op_sel_hi:[1,0]
  v_pk_mul_f32 v[194:195], v[194:195], v[202:203] op_sel_hi:[1,0]
  v_pk_mul_f32 v[218:219], v[218:219], v[206:207] op_sel_hi:[1,0]
  v_pk_mul_f32 v[196:197], v[196:197], v[202:203] op_sel_hi:[1,0]
  v_pk_mul_f32 v[220:221], v[220:221], v[206:207] op_sel_hi:[1,0]
  v_pk_mul_f32 v[198:199], v[198:199], v[202:203] op_sel_hi:[1,0]
  v_pk_mul_f32 v[222:223], v[222:223], v[206:207] op_sel_hi:[1,0]
  v_cvt_pk_bf16_f32 v168, v192, v193
  v_cvt_pk_bf16_f32 v172, v216, v217
  v_cvt_pk_bf16_f32 v169, v194, v195
  v_cvt_pk_bf16_f32 v173, v218, v219
  v_cvt_pk_bf16_f32 v170, v196, v197
  v_cvt_pk_bf16_f32 v174, v220, v221
  v_cvt_pk_bf16_f32 v171, v198, v199
  v_cvt_pk_bf16_f32 v175, v222, v223
  s_waitcnt lgkmcnt(0)
  v_pk_mul_f32 v[144:145], v[144:145], v[128:129]
  v_pk_mul_f32 v[146:147], v[146:147], v[130:131]
  v_pk_mul_f32 v[148:149], v[148:149], v[132:133]
  v_pk_mul_f32 v[150:151], v[150:151], v[134:135]
  v_pk_mul_f32 v[152:153], v[152:153], v[136:137]
  v_pk_mul_f32 v[154:155], v[154:155], v[138:139]
  v_pk_mul_f32 v[156:157], v[156:157], v[140:141]
  v_pk_mul_f32 v[158:159], v[158:159], v[142:143]
  v_mfma_f32_32x32x16_bf16 v[128:143], v[160:163], a[232:235], 0
  v_mfma_f32_32x32x16_bf16 v[128:143], v[164:167], a[236:239], v[128:143]
  v_mfma_f32_32x32x16_bf16 v[184:199], v[168:171], a[232:235], 0
  v_mfma_f32_32x32x16_bf16 v[184:199], v[172:175], a[236:239], v[184:199]
  v_cvt_pk_bf16_f32 v176, v144, v145
  v_cvt_pk_bf16_f32 v177, v146, v147
  v_cvt_pk_bf16_f32 v178, v148, v149
  v_cvt_pk_bf16_f32 v179, v150, v151
  v_cvt_pk_bf16_f32 v180, v152, v153
  v_cvt_pk_bf16_f32 v181, v154, v155
  v_cvt_pk_bf16_f32 v182, v156, v157
  v_cvt_pk_bf16_f32 v183, v158, v159
  v_cndmask_b32 v200, v176, 0, s[50:51]
  v_cndmask_b32 v176, 0, v176, s[50:51]
  v_cndmask_b32 v201, v177, 0, s[50:51]
  v_cndmask_b32 v177, 0, v177, s[50:51]
  v_cndmask_b32 v202, v178, 0, s[50:51]
  v_cndmask_b32 v178, 0, v178, s[50:51]
  v_cndmask_b32 v203, v179, 0, s[50:51]
  v_cndmask_b32 v179, 0, v179, s[50:51]
  v_cndmask_b32 v204, v180, 0, s[50:51]
  v_cndmask_b32 v180, 0, v180, s[50:51]
  v_cndmask_b32 v205, v181, 0, s[50:51]
  v_cndmask_b32 v181, 0, v181, s[50:51]
  v_cndmask_b32 v206, v182, 0, s[50:51]
  v_cndmask_b32 v182, 0, v182, s[50:51]
  v_cndmask_b32 v207, v183, 0, s[50:51]
  v_cndmask_b32 v183, 0, v183, s[50:51]
  v_cvt_pk_bf16_f32 v144, v128, v129
  v_cvt_pk_bf16_f32 v145, v130, v131
  v_cvt_pk_bf16_f32 v146, v132, v133
  v_cvt_pk_bf16_f32 v147, v134, v135
  v_cvt_pk_bf16_f32 v148, v136, v137
  v_cvt_pk_bf16_f32 v149, v138, v139
  v_cvt_pk_bf16_f32 v150, v140, v141
  v_cvt_pk_bf16_f32 v151, v142, v143
  v_cvt_pk_bf16_f32 v152, v184, v185
  v_cvt_pk_bf16_f32 v153, v186, v187
  v_cvt_pk_bf16_f32 v154, v188, v189
  v_cvt_pk_bf16_f32 v155, v190, v191
  v_cvt_pk_bf16_f32 v156, v192, v193
  v_cvt_pk_bf16_f32 v157, v194, v195
  v_cvt_pk_bf16_f32 v158, v196, v197
  v_cvt_pk_bf16_f32 v159, v198, v199
  v_mfma_f32_32x32x16_bf16 v[160:175], v[144:147], v[176:179], 0
  v_mfma_f32_32x32x16_bf16 v[160:175], v[148:151], v[180:183], v[160:175]
  v_mfma_f32_32x32x16_bf16 v[160:175], v[152:155], v[200:203], v[160:175]
  v_mfma_f32_32x32x16_bf16 v[160:175], v[156:159], v[204:207], v[160:175]
  v_add_f32 v208, v128, v129
  v_add_f32 v210, v130, v131
  v_add_f32 v209, v184, v185
  v_add_f32 v211, v186, v187
  v_add_f32 v208, v208, v132
  v_add_f32 v210, v210, v133
  v_add_f32 v209, v209, v188
  v_add_f32 v211, v211, v189
  v_add_f32 v208, v208, v134
  v_add_f32 v210, v210, v135
  v_add_f32 v209, v209, v190
  v_add_f32 v211, v211, v191
  v_add_f32 v208, v208, v136
  v_add_f32 v210, v210, v137
  v_add_f32 v209, v209, v192
  v_add_f32 v211, v211, v193
  v_add_f32 v208, v208, v138
  v_add_f32 v210, v210, v139
  v_add_f32 v209, v209, v194
  v_add_f32 v211, v211, v195
  v_add_f32 v208, v208, v140
  v_add_f32 v210, v210, v141
  v_add_f32 v209, v209, v196
  v_add_f32 v211, v211, v197
  v_add_f32 v208, v208, v142
  v_add_f32 v210, v210, v143
  v_add_f32 v209, v209, v198
  v_add_f32 v211, v211, v199
  v_add_f32 v208, v208, v210
  v_add_f32 v209, v209, v211
  s_nop 1
  v_permlane32_swap_b32 v208, v209
  v_add_f32 v208, v208, v209
  s_lshl_b32 s74, s40, 12
  s_add_u32 s74, s74, 98304
  v_add_u32 v210, s74, v255
  s_lshl_b32 s74, s40, 8
  s_add_u32 s74, s74, 98304
  v_lshlrev_b32 v211, 2, v244
  v_add_u32 v212, s74, v211
  v_add_u32 v213, 98304, v211
  ds_write_b32 v212, v208 offset:16384
  ds_write_b128 v210, v[160:163] offset:0
  ds_write_b128 v210, v[164:167] offset:1024
  ds_write_b128 v210, v[168:171] offset:2048
  ds_write_b128 v210, v[172:175] offset:3072
  s_lshl_b32 s74, s40, 10
  s_add_u32 s74, s74, 98304
  v_add_u32 v210, s74, v255
  s_waitcnt lgkmcnt(0)
  s_barrier
  ds_read_b128 v[128:131], v210 offset:0
  ds_read_b128 v[132:135], v210 offset:4096
  ds_read_b128 v[136:139], v210 offset:8192
  ds_read_b128 v[140:143], v210 offset:12288
  ds_read_b32 v144, v213 offset:16384
  ds_read_b32 v145, v213 offset:16640
  ds_read_b32 v146, v213 offset:16896
  ds_read_b32 v147, v213 offset:17152
  s_lshl_b32 s74, s42, 4
  s_add_u32 s74, s74, s41
  s_lshl_b32 s75, s74, 11
  s_lshl_b32 s76, s40, 9
  s_add_u32 s75, s75, s76
  s_add_u32 s75, s75, 1572864
  s_lshl_b32 s77, s74, 8
  s_add_u32 s77, s77, 2686976
  s_waitcnt lgkmcnt(0)
  v_pk_add_f32 v[128:129], v[128:129], v[132:133]
  v_pk_add_f32 v[130:131], v[130:131], v[134:135]
  v_pk_add_f32 v[136:137], v[136:137], v[140:141]
  v_pk_add_f32 v[138:139], v[138:139], v[142:143]
  v_pk_add_f32 v[144:145], v[144:145], v[146:147]
  v_pk_add_f32 v[128:129], v[128:129], v[136:137]
  v_pk_add_f32 v[130:131], v[130:131], v[138:139]
  v_add_f32 v144, v144, v145
  v_cvt_pk_bf16_f32 v132, v128, v129
  v_cvt_pk_bf16_f32 v133, v130, v131
  buffer_store_dwordx2 v[132:133], v248, s[36:39], s75 offen sc0 sc1
  s_cmp_eq_u32 s40, 0
  s_cbranch_scc0 L_noz1
  buffer_store_dword v144, v211, s[36:39], s77 offen sc0 sc1
L_noz1:
  s_lshl_b32 s75, s74, 2
  s_add_u32 s75, s75, s40
  s_lshl_b32 s75, s75, 3
  s_add_u32 s75, s75, 24576
  s_waitcnt vmcnt(0)
  s_or_b32 s70, s44, 2
  v_mov_b32 v236, s70
  v_mov_b32 v237, s45
  v_mov_b32 v238, 0
  s_mov_b64 exec, 1
  buffer_store_dwordx2 v[236:237], v238, s[36:39], s75 offen sc0 sc1
  s_mov_b64 exec, -1
  s_waitcnt lgkmcnt(0)
  s_barrier
  s_and_b32 s56, s42, 7
  s_lshl_b32 s56, s56, 7
  s_mul_i32 s57, s40, 8192
  s_add_u32 s56, s56, s57
  s_add_u32 s56, s56, 262144
  s_lshl_b32 s57, s40, 10
  s_add_u32 s57, s57, 98304
  ds_read_b64_tr_b16 v[176:177], v253 offset:0
  ds_read_b64_tr_b16 v[178:179], v253 offset:256
  ds_read_b64_tr_b16 v[180:181], v253 offset:512
  ds_read_b64_tr_b16 v[182:183], v253 offset:768
  ds_read_b64_tr_b16 v[184:185], v253 offset:2048
  ds_read_b64_tr_b16 v[186:187], v253 offset:2304
  s_waitcnt lgkmcnt(4)
  v_mfma_f32_32x32x16_bf16 v[160:175], v[176:179], v[0:3], 0
  ds_read_b64_tr_b16 v[188:189], v253 offset:2560
  ds_read_b64_tr_b16 v[190:191], v253 offset:2816
  s_add_u32 s58, s92, 0
  s_and_b32 s58, s58, 7
  s_lshl_b32 s81, s58, 12
  s_add_u32 m0, s81, s57
  s_mul_i32 s58, s58, 32768
  s_add_u32 s58, s58, s56
  buffer_load_dwordx4 v247, s[16:19], s58 offen lds
  s_waitcnt lgkmcnt(4)
  v_mfma_f32_32x32x16_bf16 v[160:175], v[180:183], v[4:7], v[160:175]
  ds_read_b64_tr_b16 v[176:177], v253 offset:4096
  ds_read_b64_tr_b16 v[178:179], v253 offset:4352
  s_waitcnt lgkmcnt(4)
  v_mfma_f32_32x32x16_bf16 v[160:175], v[184:187], v[8:11], v[160:175]
  s_add_u32 s58, s92, 1
  s_and_b32 s58, s58, 7
  s_lshl_b32 s81, s58, 12
  s_add_u32 m0, s81, s57
  s_mul_i32 s58, s58, 32768
  s_add_u32 s58, s58, s56
  buffer_load_dwordx4 v247, s[16:19], s58 offen lds
  ds_read_b64_tr_b16 v[180:181], v253 offset:4608
  ds_read_b64_tr_b16 v[182:183], v253 offset:4864
  s_waitcnt lgkmcnt(4)
  v_mfma_f32_32x32x16_bf16 v[160:175], v[188:191], v[12:15], v[160:175]
  ds_read_b64_tr_b16 v[184:185], v253 offset:6144
  ds_read_b64_tr_b16 v[186:187], v253 offset:6400
  s_waitcnt lgkmcnt(4)
  v_mfma_f32_32x32x16_bf16 v[160:175], v[176:179], v[16:19], v[160:175]
  s_add_u32 s58, s92, 2
  s_and_b32 s58, s58, 7
  s_lshl_b32 s81, s58, 12
  s_add_u32 m0, s81, s57
  s_mul_i32 s58, s58, 32768
  s_add_u32 s58, s58, s56
  buffer_load_dwordx4 v247, s[16:19], s58 offen lds
  ds_read_b64_tr_b16 v[188:189], v253 offset:6656
  ds_read_b64_tr_b16 v[190:191], v253 offset:6912
  s_waitcnt lgkmcnt(4)
  v_mfma_f32_32x32x16_bf16 v[160:175], v[180:183], v[20:23], v[160:175]
  ds_read_b64_tr_b16 v[176:177], v253 offset:8192
  ds_read_b64_tr_b16 v[178:179], v253 offset:8448
  s_waitcnt lgkmcnt(4)
  v_mfma_f32_32x32x16_bf16 v[160:175], v[184:187], v[24:27], v[160:175]
  s_add_u32 s58, s92, 3
  s_and_b32 s58, s58, 7
  s_lshl_b32 s81, s58, 12
  s_add_u32 m0, s81, s57
  s_mul_i32 s58, s58, 32768
  s_add_u32 s58, s58, s56
  buffer_load_dwordx4 v247, s[16:19], s58 offen lds
  ds_read_b64_tr_b16 v[180:181], v253 offset:8704
  ds_read_b64_tr_b16 v[182:183], v253 offset:8960
  s_waitcnt lgkmcnt(4)
  v_mfma_f32_32x32x16_bf16 v[160:175], v[188:191], v[28:31], v[160:175]
  ds_read_b64_tr_b16 v[184:185], v253 offset:10240
  ds_read_b64_tr_b16 v[186:187], v253 offset:10496
  s_waitcnt lgkmcnt(4)
  v_mfma_f32_32x32x16_bf16 v[160:175], v[176:179], v[32:35], v[160:175]
  s_add_u32 s58, s92, 4
  s_and_b32 s58, s58, 7
  s_lshl_b32 s81, s58, 12
  s_add_u32 m0, s81, s57
  s_mul_i32 s58, s58, 32768
  s_add_u32 s58, s58, s56
  buffer_load_dwordx4 v247, s[16:19], s58 offen lds
  ds_read_b64_tr_b16 v[188:189], v253 offset:10752
  ds_read_b64_tr_b16 v[190:191], v253 offset:11008
  v_mfma_f32_32x32x16_bf16 v[160:175], a[244:247], v[228:231], v[160:175]
  s_waitcnt lgkmcnt(4)
  v_mfma_f32_32x32x16_bf16 v[160:175], v[180:183], v[36:39], v[160:175]
  s_add_u32 s58, s92, 5
  s_and_b32 s58, s58, 7
  s_lshl_b32 s81, s58, 12
  s_add_u32 m0, s81, s57
  s_mul_i32 s58, s58, 32768
  s_add_u32 s58, s58, s56
  buffer_load_dwordx4 v247, s[16:19], s58 offen lds
  ds_read_b64_tr_b16 v[176:177], v253 offset:12288
  ds_read_b64_tr_b16 v[178:179], v253 offset:12544
  s_waitcnt lgkmcnt(4)
  v_mfma_f32_32x32x16_bf16 v[160:175], v[184:187], v[40:43], v[160:175]
  ds_read_b64_tr_b16 v[180:181], v253 offset:12800
  ds_read_b64_tr_b16 v[182:183], v253 offset:13056
  s_waitcnt lgkmcnt(4)
  v_mfma_f32_32x32x16_bf16 v[160:175], v[188:191], v[44:47], v[160:175]
  s_add_u32 s58, s92, 6
  s_and_b32 s58, s58, 7
  s_lshl_b32 s81, s58, 12
  s_add_u32 m0, s81, s57
  s_mul_i32 s58, s58, 32768
  s_add_u32 s58, s58, s56
  buffer_load_dwordx4 v247, s[16:19], s58 offen lds
  ds_read_b64_tr_b16 v[184:185], v253 offset:14336
  ds_read_b64_tr_b16 v[186:187], v253 offset:14592
  s_waitcnt lgkmcnt(4)
  v_mfma_f32_32x32x16_bf16 v[160:175], v[176:179], v[48:51], v[160:175]
  ds_read_b64_tr_b16 v[188:189], v253 offset:14848
  ds_read_b64_tr_b16 v[190:191], v253 offset:15104
  s_waitcnt lgkmcnt(4)
  v_mfma_f32_32x32x16_bf16 v[160:175], v[180:183], v[52:55], v[160:175]
  s_add_u32 s58, s92, 7
  s_and_b32 s58, s58, 7
  s_lshl_b32 s81, s58, 12
  s_add_u32 m0, s81, s57
  s_mul_i32 s58, s58, 32768
  s_add_u32 s58, s58, s56
  buffer_load_dwordx4 v247, s[16:19], s58 offen lds
  ds_read_b64_tr_b16 v[176:177], v253 offset:16384
  ds_read_b64_tr_b16 v[178:179], v253 offset:16640
  s_waitcnt lgkmcnt(4)
  v_mfma_f32_32x32x16_bf16 v[160:175], v[184:187], v[56:59], v[160:175]
  ds_read_b64_tr_b16 v[180:181], v253 offset:16896
  ds_read_b64_tr_b16 v[182:183], v253 offset:17152
  s_waitcnt lgkmcnt(4)
  v_mfma_f32_32x32x16_bf16 v[160:175], v[188:191], v[60:63], v[160:175]
  ds_read_b64_tr_b16 v[184:185], v253 offset:18432
  ds_read_b64_tr_b16 v[186:187], v253 offset:18688
  s_waitcnt lgkmcnt(4)
  v_mfma_f32_32x32x16_bf16 v[160:175], v[176:179], v[64:67], v[160:175]
  ds_read_b64_tr_b16 v[188:189], v253 offset:18944
  ds_read_b64_tr_b16 v[190:191], v253 offset:19200
  s_waitcnt lgkmcnt(4)
  v_mfma_f32_32x32x16_bf16 v[160:175], v[180:183], v[68:71], v[160:175]
  ds_read_b64_tr_b16 v[176:177], v253 offset:20480
  ds_read_b64_tr_b16 v[178:179], v253 offset:20736
  s_waitcnt lgkmcnt(4)
  v_mfma_f32_32x32x16_bf16 v[160:175], v[184:187], v[72:75], v[160:175]
  ds_read_b64_tr_b16 v[180:181], v253 offset:20992
  ds_read_b64_tr_b16 v[182:183], v253 offset:21248
  s_waitcnt lgkmcnt(4)
  v_mfma_f32_32x32x16_bf16 v[160:175], v[188:191], v[76:79], v[160:175]
  ds_read_b64_tr_b16 v[184:185], v253 offset:22528
  ds_read_b64_tr_b16 v[186:187], v253 offset:22784
  s_waitcnt lgkmcnt(4)
  v_mfma_f32_32x32x16_bf16 v[160:175], v[176:179], v[80:83], v[160:175]
  ds_read_b64_tr_b16 v[188:189], v253 offset:23040
  ds_read_b64_tr_b16 v[190:191], v253 offset:23296
  s_waitcnt lgkmcnt(4)
  v_mfma_f32_32x32x16_bf16 v[160:175], v[180:183], v[84:87], v[160:175]
  ds_read_b64_tr_b16 v[176:177], v253 offset:24576
  ds_read_b64_tr_b16 v[178:179], v253 offset:24832
  s_waitcnt lgkmcnt(4)
  v_mfma_f32_32x32x16_bf16 v[160:175], v[184:187], v[88:91], v[160:175]
  ds_read_b64_tr_b16 v[180:181], v253 offset:25088
  ds_read_b64_tr_b16 v[182:183], v253 offset:25344
  s_waitcnt lgkmcnt(4)
  v_mfma_f32_32x32x16_bf16 v[160:175], v[188:191], v[92:95], v[160:175]
  ds_read_b64_tr_b16 v[184:185], v253 offset:26624
  ds_read_b64_tr_b16 v[186:187], v253 offset:26880
  s_waitcnt lgkmcnt(4)
  v_mfma_f32_32x32x16_bf16 v[160:175], v[176:179], v[96:99], v[160:175]
  ds_read_b64_tr_b16 v[188:189], v253 offset:27136
  ds_read_b64_tr_b16 v[190:191], v253 offset:27392
  s_waitcnt lgkmcnt(4)
  v_mfma_f32_32x32x16_bf16 v[160:175], v[180:183], v[100:103], v[160:175]
  ds_read_b64_tr_b16 v[176:177], v253 offset:28672
  ds_read_b64_tr_b16 v[178:179], v253 offset:28928
  s_waitcnt lgkmcnt(4)
  v_mfma_f32_32x32x16_bf16 v[160:175], v[184:187], v[104:107], v[160:175]
  ds_read_b64_tr_b16 v[180:181], v253 offset:29184
  ds_read_b64_tr_b16 v[182:183], v253 offset:29440
  s_waitcnt lgkmcnt(4)
  v_mfma_f32_32x32x16_bf16 v[160:175], v[188:191], v[108:111], v[160:175]
  ds_read_b64_tr_b16 v[184:185], v253 offset:30720
  ds_read_b64_tr_b16 v[186:187], v253 offset:30976
  s_waitcnt lgkmcnt(4)
  v_mfma_f32_32x32x16_bf16 v[160:175], v[176:179], v[112:115], v[160:175]
  ds_read_b64_tr_b16 v[188:189], v253 offset:31232
  ds_read_b64_tr_b16 v[190:191], v253 offset:31488
  s_waitcnt lgkmcnt(4)
  v_mfma_f32_32x32x16_bf16 v[160:175], v[180:183], v[116:119], v[160:175]
  s_waitcnt lgkmcnt(2)
  v_mfma_f32_32x32x16_bf16 v[160:175], v[184:187], v[120:123], v[160:175]
  s_waitcnt lgkmcnt(0)
  v_mfma_f32_32x32x16_bf16 v[160:175], v[188:191], v[124:127], v[160:175]
  s_lshl_b32 s71, s42, 9
  s_add_u32 s71, s71, 24576
  s_lshl_b32 s62, 0x11111111, s40
  s_or_b32 s70, s44, 2
  s_mov_b32 s68, s62
  s_mov_b32 s69, s62
  s_mov_b32 s80, 0
L_poll_31:
  buffer_load_dwordx2 v[236:237], v248, s[36:39], s71 offen sc1
  s_add_u32 s80, s80, 1
  s_cmp_gt_u32 s80, 0x40000
  s_cbranch_scc1 L_poll_31_x
  s_waitcnt vmcnt(0)
  v_subrev_u32 v236, s70, v236
  v_cmp_ge_u32 vcc, 13, v236
  v_cmp_eq_u32 s[66:67], s45, v237
  s_and_b64 vcc, vcc, s[66:67]
  s_andn2_b64 s[66:67], s[68:69], vcc
  s_cbranch_scc1 L_poll_31
L_poll_31_x:
  s_waitcnt vmcnt(0)
  s_lshl_b32 s60, s42, 15
  s_lshl_b32 s75, s40, 9
  s_add_u32 s60, s60, s75
  s_add_u32 s60, s60, 1572864
  v_lshlrev_b32 v224, 2, v244
  s_cmp_eq_u32 s40, 0
  s_cbranch_scc0 L_z_32
  s_lshl_b32 s75, s42, 12
  s_add_u32 s75, s75, 2686976
  buffer_load_dword v208, v224, s[36:39], s75 offen offset:0 sc1
  buffer_load_dword v209, v224, s[36:39], s75 offen offset:256 sc1
  buffer_load_dword v210, v224, s[36:39], s75 offen offset:512 sc1
  buffer_load_dword v211, v224, s[36:39], s75 offen offset:768 sc1
  buffer_load_dword v212, v224, s[36:39], s75 offen offset:1024 sc1
  buffer_load_dword v213, v224, s[36:39], s75 offen offset:1280 sc1
  buffer_load_dword v214, v224, s[36:39], s75 offen offset:1536 sc1
  buffer_load_dword v215, v224, s[36:39], s75 offen offset:1792 sc1
  buffer_load_dword v216, v224, s[36:39], s75 offen offset:2048 sc1
  buffer_load_dword v217, v224, s[36:39], s75 offen offset:2304 sc1
  buffer_load_dword v218, v224, s[36:39], s75 offen offset:2560 sc1
  buffer_load_dword v219, v224, s[36:39], s75 offen offset:2816 sc1
  buffer_load_dword v220, v224, s[36:39], s75 offen offset:3072 sc1
  buffer_load_dword v221, v224, s[36:39], s75 offen offset:3328 sc1
  buffer_load_dword v222, v224, s[36:39], s75 offen offset:3584 sc1
  buffer_load_dword v223, v224, s[36:39], s75 offen offset:3840 sc1
L_z_32:
  s_lshl_b32 s75, s93, 12
  s_add_u32 s61, s60, s75
  s_xor_b32 s75, s75, 16384
  s_add_u32 s60, s60, s75
  s_barrier
  v_cvt_pk_bf16_f32 v0, v160, v161
  v_cvt_pk_bf16_f32 v1, v162, v163
  v_cvt_pk_bf16_f32 v2, v164, v165
  v_cvt_pk_bf16_f32 v3, v166, v167
  buffer_load_dwordx2 v[176:177], v248, s[36:39], s61 offen offset:0 sc1
  v_cvt_pk_bf16_f32 v4, v168, v169
  v_cvt_pk_bf16_f32 v5, v170, v171
  v_cvt_pk_bf16_f32 v6, v172, v173
  v_cvt_pk_bf16_f32 v7, v174, v175
  buffer_load_dwordx2 v[178:179], v248, s[36:39], s61 offen offset:2048 sc1
  v_mfma_f32_32x32x16_bf16 v[8:23], a[224:227], v[0:3], 0
  s_add_u32 s61, s61, 4096
  buffer_load_dwordx2 v[180:181], v248, s[36:39], s61 offen offset:0 sc1
  v_mfma_f32_32x32x16_bf16 v[8:23], a[228:231], v[4:7], v[8:23]
  buffer_load_dwordx2 v[182:183], v248, s[36:39], s61 offen offset:2048 sc1
  s_nop 10
  v_max3_f32 v24, v8, v9, v10
  v_max3_f32 v25, -v8, -v9, -v10
  v_max3_f32 v24, v24, v11, v12
  v_max3_f32 v25, v25, -v11, -v12
  s_add_u32 s61, s61, 4096
  buffer_load_dwordx2 v[184:185], v248, s[36:39], s61 offen offset:0 sc1
  v_max3_f32 v24, v24, v13, v14
  v_max3_f32 v25, v25, -v13, -v14
  v_max_f32 v24, v24, v15
  v_max_f32 v25, v25, -v15
  buffer_load_dwordx2 v[186:187], v248, s[36:39], s61 offen offset:2048 sc1
  v_max3_f32 v26, v16, v17, v18
  v_max3_f32 v27, -v16, -v17, -v18
  v_max3_f32 v26, v26, v19, v20
  v_max3_f32 v27, v27, -v19, -v20
  s_add_u32 s61, s61, 4096
  buffer_load_dwordx2 v[188:189], v248, s[36:39], s61 offen offset:0 sc1
  v_max3_f32 v26, v26, v21, v22
  v_max3_f32 v27, v27, -v21, -v22
  v_max_f32 v26, v26, v23
  v_max_f32 v27, v27, -v23
  buffer_load_dwordx2 v[190:191], v248, s[36:39], s61 offen offset:2048 sc1
  v_permlane32_swap_b32 v24, v25
  v_permlane32_swap_b32 v26, v27
  buffer_load_dwordx2 v[192:193], v248, s[36:39], s60 offen offset:0 sc1
  v_max_f32 v24, v24, v25
  v_max_f32 v26, v26, v27
  v_mov_b32 v25, v24
  v_mov_b32 v27, v26
  buffer_load_dwordx2 v[194:195], v248, s[36:39], s60 offen offset:2048 sc1
  v_permlane32_swap_b32 v24, v25
  v_permlane32_swap_b32 v26, v27
  s_add_u32 s60, s60, 4096
  buffer_load_dwordx2 v[196:197], v248, s[36:39], s60 offen offset:0 sc1
  v_pk_mul_f32 v[24:25], v[24:25], v[232:233] op_sel_hi:[1,0]
  v_pk_mul_f32 v[26:27], v[26:27], v[232:233] op_sel_hi:[1,0]
  v_mov_b32 v28, v25
  v_pk_fma_f32 v[32:33], v[8:9], v[232:233], v[28:29] op_sel_hi:[1,0,0] neg_lo:[1,0,1] neg_hi:[1,0,1]
  buffer_load_dwordx2 v[198:199], v248, s[36:39], s60 offen offset:2048 sc1
  v_pk_fma_f32 v[8:9], v[8:9], v[232:233], v[24:25] op_sel_hi:[1,0,0] neg_lo:[0,0,1] neg_hi:[0,0,1]
  v_pk_fma_f32 v[34:35], v[10:11], v[232:233], v[28:29] op_sel_hi:[1,0,0] neg_lo:[1,0,1] neg_hi:[1,0,1]
  v_pk_fma_f32 v[10:11], v[10:11], v[232:233], v[24:25] op_sel_hi:[1,0,0] neg_lo:[0,0,1] neg_hi:[0,0,1]
  v_pk_fma_f32 v[36:37], v[12:13], v[232:233], v[28:29] op_sel_hi:[1,0,0] neg_lo:[1,0,1] neg_hi:[1,0,1]
  s_add_u32 s60, s60, 4096
  buffer_load_dwordx2 v[200:201], v248, s[36:39], s60 offen offset:0 sc1
  v_pk_fma_f32 v[12:13], v[12:13], v[232:233], v[24:25] op_sel_hi:[1,0,0] neg_lo:[0,0,1] neg_hi:[0,0,1]
  v_pk_fma_f32 v[38:39], v[14:15], v[232:233], v[28:29] op_sel_hi:[1,0,0] neg_lo:[1,0,1] neg_hi:[1,0,1]
  v_pk_fma_f32 v[14:15], v[14:15], v[232:233], v[24:25] op_sel_hi:[1,0,0] neg_lo:[0,0,1] neg_hi:[0,0,1]
  v_mov_b32 v30, v27
  buffer_load_dwordx2 v[202:203], v248, s[36:39], s60 offen offset:2048 sc1
  v_pk_fma_f32 v[40:41], v[16:17], v[232:233], v[30:31] op_sel_hi:[1,0,0] neg_lo:[1,0,1] neg_hi:[1,0,1]
  v_pk_fma_f32 v[16:17], v[16:17], v[232:233], v[26:27] op_sel_hi:[1,0,0] neg_lo:[0,0,1] neg_hi:[0,0,1]
  v_pk_fma_f32 v[42:43], v[18:19], v[232:233], v[30:31] op_sel_hi:[1,0,0] neg_lo:[1,0,1] neg_hi:[1,0,1]
  v_pk_fma_f32 v[18:19], v[18:19], v[232:233], v[26:27] op_sel_hi:[1,0,0] neg_lo:[0,0,1] neg_hi:[0,0,1]
  s_add_u32 s60, s60, 4096
  buffer_load_dwordx2 v[204:205], v248, s[36:39], s60 offen offset:0 sc1
  v_pk_fma_f32 v[44:45], v[20:21], v[232:233], v[30:31] op_sel_hi:[1,0,0] neg_lo:[1,0,1] neg_hi:[1,0,1]
  v_pk_fma_f32 v[20:21], v[20:21], v[232:233], v[26:27] op_sel_hi:[1,0,0] neg_lo:[0,0,1] neg_hi:[0,0,1]
  v_pk_fma_f32 v[46:47], v[22:23], v[232:233], v[30:31] op_sel_hi:[1,0,0] neg_lo:[1,0,1] neg_hi:[1,0,1]
  v_pk_fma_f32 v[22:23], v[22:23], v[232:233], v[26:27] op_sel_hi:[1,0,0] neg_lo:[0,0,1] neg_hi:[0,0,1]
  buffer_load_dwordx2 v[206:207], v248, s[36:39], s60 offen offset:2048 sc1
  v_exp_f32 v8, v8
  v_exp_f32 v32, v32
  v_exp_f32 v9, v9
  v_exp_f32 v33, v33
  v_exp_f32 v10, v10
  v_exp_f32 v34, v34
  v_exp_f32 v11, v11
  v_exp_f32 v35, v35
  v_exp_f32 v12, v12
  v_exp_f32 v36, v36
  v_exp_f32 v13, v13
  v_exp_f32 v37, v37
  v_exp_f32 v14, v14
  v_exp_f32 v38, v38
  v_exp_f32 v15, v15
  v_exp_f32 v39, v39
  v_exp_f32 v16, v16
  v_exp_f32 v40, v40
  v_exp_f32 v17, v17
  v_exp_f32 v41, v41
  v_exp_f32 v18, v18
  v_exp_f32 v42, v42
  v_exp_f32 v19, v19
  v_exp_f32 v43, v43
  v_exp_f32 v20, v20
  v_exp_f32 v44, v44
  v_exp_f32 v21, v21
  v_exp_f32 v45, v45
  v_exp_f32 v22, v22
  v_exp_f32 v46, v46
  v_exp_f32 v23, v23
  v_exp_f32 v47, v47
  v_pk_add_f32 v[24:25], v[8:9], v[10:11]
  v_pk_add_f32 v[28:29], v[32:33], v[34:35]
  v_pk_add_f32 v[24:25], v[24:25], v[12:13]
  v_pk_add_f32 v[28:29], v[28:29], v[36:37]
  v_pk_add_f32 v[24:25], v[24:25], v[14:15]
  v_pk_add_f32 v[28:29], v[28:29], v[38:39]
  v_add_f32 v24, v24, v25
  v_add_f32 v25, v28, v29
  v_pk_add_f32 v[26:27], v[16:17], v[18:19]
  v_pk_add_f32 v[30:31], v[40:41], v[42:43]
  v_pk_add_f32 v[26:27], v[26:27], v[20:21]
  v_pk_add_f32 v[30:31], v[30:31], v[44:45]
  v_pk_add_f32 v[26:27], v[26:27], v[22:23]
  v_pk_add_f32 v[30:31], v[30:31], v[46:47]
  v_add_f32 v26, v26, v27
  v_add_f32 v27, v30, v31
  v_permlane32_swap_b32 v24, v25
  s_nop 0
  v_permlane32_swap_b32 v26, v27
  v_add_f32 v24, v24, v25
  v_add_f32 v26, v26, v27
  v_rcp_f32 v24, v24
  v_rcp_f32 v26, v26
  v_mov_b32 v28, v24
  v_mov_b32 v30, v26
  s_nop 0
  v_permlane32_swap_b32 v24, v28
  v_permlane32_swap_b32 v26, v30
  v_pk_mul_f32 v[8:9], v[8:9], v[24:25] op_sel_hi:[1,0]
  v_pk_mul_f32 v[32:33], v[32:33], v[28:29] op_sel_hi:[1,0]
  v_pk_mul_f32 v[10:11], v[10:11], v[24:25] op_sel_hi:[1,0]
  v_pk_mul_f32 v[34:35], v[34:35], v[28:29] op_sel_hi:[1,0]
  v_pk_mul_f32 v[12:13], v[12:13], v[24:25] op_sel_hi:[1,0]
  v_pk_mul_f32 v[36:37], v[36:37], v[28:29] op_sel_hi:[1,0]
  v_pk_mul_f32 v[14:15], v[14:15], v[24:25] op_sel_hi:[1,0]
  v_pk_mul_f32 v[38:39], v[38:39], v[28:29] op_sel_hi:[1,0]
  v_cvt_pk_bf16_f32 v128, v8, v9
  v_cvt_pk_bf16_f32 v132, v32, v33
  v_cvt_pk_bf16_f32 v129, v10, v11
  v_cvt_pk_bf16_f32 v133, v34, v35
  v_cvt_pk_bf16_f32 v130, v12, v13
  v_cvt_pk_bf16_f32 v134, v36, v37
  v_cvt_pk_bf16_f32 v131, v14, v15
  v_cvt_pk_bf16_f32 v135, v38, v39
  v_pk_mul_f32 v[16:17], v[16:17], v[26:27] op_sel_hi:[1,0]
  v_pk_mul_f32 v[40:41], v[40:41], v[30:31] op_sel_hi:[1,0]
  v_pk_mul_f32 v[18:19], v[18:19], v[26:27] op_sel_hi:[1,0]
  v_pk_mul_f32 v[42:43], v[42:43], v[30:31] op_sel_hi:[1,0]
  v_pk_mul_f32 v[20:21], v[20:21], v[26:27] op_sel_hi:[1,0]
  v_pk_mul_f32 v[44:45], v[44:45], v[30:31] op_sel_hi:[1,0]
  v_pk_mul_f32 v[22:23], v[22:23], v[26:27] op_sel_hi:[1,0]
  v_pk_mul_f32 v[46:47], v[46:47], v[30:31] op_sel_hi:[1,0]
  v_cvt_pk_bf16_f32 v136, v16, v17
  v_cvt_pk_bf16_f32 v140, v40, v41
  v_cvt_pk_bf16_f32 v137, v18, v19
  v_cvt_pk_bf16_f32 v141, v42, v43
  v_cvt_pk_bf16_f32 v138, v20, v21
  v_cvt_pk_bf16_f32 v142, v44, v45
  v_cvt_pk_bf16_f32 v139, v22, v23
  v_cvt_pk_bf16_f32 v143, v46, v47
  s_and_b32 s61, s40, 1
  s_cmp_eq_u32 s61, 0
  s_cselect_b64 vcc, -1, 0
  s_cselect_b32 s76, 32768, 0
  s_add_u32 s76, s76, 98304
  v_cndmask_b32 v160, v249, v250, vcc
  v_cndmask_b32 v161, v250, v249, vcc
  v_add_u32 v160, s76, v160
  v_add_u32 v161, s76, v161
  ds_read_b64_tr_b16 v[0:1], v160 offset:0
  ds_read_b64_tr_b16 v[2:3], v160 offset:1024
  ds_read_b64_tr_b16 v[4:5], v161 offset:0
  ds_read_b64_tr_b16 v[6:7], v161 offset:1024
  ds_read_b64_tr_b16 v[8:9], v160 offset:2048
  ds_read_b64_tr_b16 v[10:11], v160 offset:3072
  ds_read_b64_tr_b16 v[12:13], v161 offset:2048
  ds_read_b64_tr_b16 v[14:15], v161 offset:3072
  ds_read_b64_tr_b16 v[16:17], v160 offset:4096
  ds_read_b64_tr_b16 v[18:19], v160 offset:5120
  ds_read_b64_tr_b16 v[20:21], v161 offset:4096
  ds_read_b64_tr_b16 v[22:23], v161 offset:5120
  ds_read_b64_tr_b16 v[24:25], v160 offset:6144
  ds_read_b64_tr_b16 v[26:27], v160 offset:7168
  ds_read_b64_tr_b16 v[28:29], v161 offset:6144
  ds_read_b64_tr_b16 v[30:31], v161 offset:7168
  ds_read_b64_tr_b16 v[32:33], v160 offset:8192
  ds_read_b64_tr_b16 v[34:35], v160 offset:9216
  ds_read_b64_tr_b16 v[36:37], v161 offset:8192
  ds_read_b64_tr_b16 v[38:39], v161 offset:9216
  ds_read_b64_tr_b16 v[40:41], v160 offset:10240
  ds_read_b64_tr_b16 v[42:43], v160 offset:11264
  ds_read_b64_tr_b16 v[44:45], v161 offset:10240
  ds_read_b64_tr_b16 v[46:47], v161 offset:11264
  ds_read_b64_tr_b16 v[48:49], v160 offset:12288
  ds_read_b64_tr_b16 v[50:51], v160 offset:13312
  ds_read_b64_tr_b16 v[52:53], v161 offset:12288
  ds_read_b64_tr_b16 v[54:55], v161 offset:13312
  ds_read_b64_tr_b16 v[56:57], v160 offset:14336
  ds_read_b64_tr_b16 v[58:59], v160 offset:15360
  ds_read_b64_tr_b16 v[60:61], v161 offset:14336
  ds_read_b64_tr_b16 v[62:63], v161 offset:15360
  ds_read_b64_tr_b16 v[64:65], v160 offset:16384
  ds_read_b64_tr_b16 v[66:67], v160 offset:17408
  ds_read_b64_tr_b16 v[68:69], v161 offset:16384
  ds_read_b64_tr_b16 v[70:71], v161 offset:17408
  ds_read_b64_tr_b16 v[72:73], v160 offset:18432
  ds_read_b64_tr_b16 v[74:75], v160 offset:19456
  ds_read_b64_tr_b16 v[76:77], v161 offset:18432
  ds_read_b64_tr_b16 v[78:79], v161 offset:19456
  ds_read_b64_tr_b16 v[80:81], v160 offset:20480
  ds_read_b64_tr_b16 v[82:83], v160 offset:21504
  ds_read_b64_tr_b16 v[84:85], v161 offset:20480
  ds_read_b64_tr_b16 v[86:87], v161 offset:21504
  ds_read_b64_tr_b16 v[88:89], v160 offset:22528
  ds_read_b64_tr_b16 v[90:91], v160 offset:23552
  ds_read_b64_tr_b16 v[92:93], v161 offset:22528
  ds_read_b64_tr_b16 v[94:95], v161 offset:23552
  ds_read_b64_tr_b16 v[96:97], v160 offset:24576
  ds_read_b64_tr_b16 v[98:99], v160 offset:25600
  ds_read_b64_tr_b16 v[100:101], v161 offset:24576
  ds_read_b64_tr_b16 v[102:103], v161 offset:25600
  ds_read_b64_tr_b16 v[104:105], v160 offset:26624
  ds_read_b64_tr_b16 v[106:107], v160 offset:27648
  ds_read_b64_tr_b16 v[108:109], v161 offset:26624
  ds_read_b64_tr_b16 v[110:111], v161 offset:27648
  ds_read_b64_tr_b16 v[112:113], v160 offset:28672
  ds_read_b64_tr_b16 v[114:115], v160 offset:29696
  ds_read_b64_tr_b16 v[116:117], v161 offset:28672
  ds_read_b64_tr_b16 v[118:119], v161 offset:29696
  ds_read_b64_tr_b16 v[120:121], v160 offset:30720
  ds_read_b64_tr_b16 v[122:123], v160 offset:31744
  ds_read_b64_tr_b16 v[124:125], v161 offset:30720
  ds_read_b64_tr_b16 v[126:127], v161 offset:31744
  s_waitcnt lgkmcnt(0)
  s_barrier
  s_lshl_b32 s56, s42, 8
  s_mul_i32 s57, s40, 28672
  s_add_u32 s56, s56, s57
  s_add_u32 s56, s56, 0
  s_lshl_b32 s57, s40, 10
  s_add_u32 s57, s57, 98304
  s_add_u32 s58, s93, 0
  s_and_b32 s58, s58, 7
  s_lshl_b32 s81, s58, 12
  s_add_u32 m0, s81, s57
  s_mul_i32 s58, s58, 114688
  s_add_u32 s58, s58, s56
  buffer_load_dwordx4 v246, s[20:23], s58 offen lds
  s_add_u32 s58, s93, 1
  s_and_b32 s58, s58, 7
  s_lshl_b32 s81, s58, 12
  s_add_u32 m0, s81, s57
  s_mul_i32 s58, s58, 114688
  s_add_u32 s58, s58, s56
  buffer_load_dwordx4 v246, s[20:23], s58 offen lds
  s_add_u32 s58, s93, 2
  s_and_b32 s58, s58, 7
  s_lshl_b32 s81, s58, 12
  s_add_u32 m0, s81, s57
  s_mul_i32 s58, s58, 114688
  s_add_u32 s58, s58, s56
  buffer_load_dwordx4 v246, s[20:23], s58 offen lds
  s_add_u32 s58, s93, 3
  s_and_b32 s58, s58, 7
  s_lshl_b32 s81, s58, 12
  s_add_u32 m0, s81, s57
  s_mul_i32 s58, s58, 114688
  s_add_u32 s58, s58, s56
  buffer_load_dwordx4 v246, s[20:23], s58 offen lds
  s_add_u32 s58, s93, 4
  s_and_b32 s58, s58, 7
  s_lshl_b32 s81, s58, 12
  s_add_u32 m0, s81, s57
  s_mul_i32 s58, s58, 114688
  s_add_u32 s58, s58, s56
  buffer_load_dwordx4 v246, s[20:23], s58 offen lds
  s_add_u32 s58, s93, 5
  s_and_b32 s58, s58, 7
  s_lshl_b32 s81, s58, 12
  s_add_u32 m0, s81, s57
  s_mul_i32 s58, s58, 114688
  s_add_u32 s58, s58, s56
  buffer_load_dwordx4 v246, s[20:23], s58 offen lds
  s_add_u32 s58, s93, 6
  s_and_b32 s58, s58, 7
  s_lshl_b32 s81, s58, 12
  s_add_u32 m0, s81, s57
  s_mul_i32 s58, s58, 114688
  s_add_u32 s58, s58, s56
  buffer_load_dwordx4 v246, s[20:23], s58 offen lds
  s_add_u32 s58, s93, 7
  s_and_b32 s58, s58, 7
  s_lshl_b32 s81, s58, 12
  s_add_u32 m0, s81, s57
  s_mul_i32 s58, s58, 114688
  s_add_u32 s58, s58, s56
  buffer_load_dwordx4 v246, s[20:23], s58 offen lds
  v_mov_b32 v224, 0x00003f80
  v_mov_b32 v225, 0x3f800000
  v_mov_b32 v144, 0
  v_mov_b32 v145, 0
  v_mov_b32 v146, 0
  v_mov_b32 v147, 0
  s_waitcnt vmcnt(23)
  v_dot2c_f32_bf16 v144, v176, v224
  v_dot2c_f32_bf16 v145, v176, v225
  v_dot2c_f32_bf16 v146, v177, v224
  v_dot2c_f32_bf16 v147, v177, v225
  s_waitcnt vmcnt(22)
  v_dot2c_f32_bf16 v144, v178, v224
  v_dot2c_f32_bf16 v145, v178, v225
  v_dot2c_f32_bf16 v146, v179, v224
  v_dot2c_f32_bf16 v147, v179, v225
  s_waitcnt vmcnt(21)
  v_dot2c_f32_bf16 v144, v180, v224
  v_dot2c_f32_bf16 v145, v180, v225
  v_dot2c_f32_bf16 v146, v181, v224
  v_dot2c_f32_bf16 v147, v181, v225
  s_waitcnt vmcnt(20)
  v_dot2c_f32_bf16 v144, v182, v224
  v_dot2c_f32_bf16 v145, v182, v225
  v_dot2c_f32_bf16 v146, v183, v224
  v_dot2c_f32_bf16 v147, v183, v225
  s_waitcnt vmcnt(19)
  v_dot2c_f32_bf16 v144, v184, v224
  v_dot2c_f32_bf16 v145, v184, v225
  v_dot2c_f32_bf16 v146, v185, v224
  v_dot2c_f32_bf16 v147, v185, v225
  s_waitcnt vmcnt(18)
  v_dot2c_f32_bf16 v144, v186, v224
  v_dot2c_f32_bf16 v145, v186, v225
  v_dot2c_f32_bf16 v146, v187, v224
  v_dot2c_f32_bf16 v147, v187, v225
  s_waitcnt vmcnt(17)
  v_dot2c_f32_bf16 v144, v188, v224
  v_dot2c_f32_bf16 v145, v188, v225
  v_dot2c_f32_bf16 v146, v189, v224
  v_dot2c_f32_bf16 v147, v189, v225
  s_waitcnt vmcnt(16)
  v_dot2c_f32_bf16 v144, v190, v224
  v_dot2c_f32_bf16 v145, v190, v225
  v_dot2c_f32_bf16 v146, v191, v224
  v_dot2c_f32_bf16 v147, v191, v225
  s_waitcnt vmcnt(15)
  v_dot2c_f32_bf16 v144, v192, v224
  v_dot2c_f32_bf16 v145, v192, v225
  v_dot2c_f32_bf16 v146, v193, v224
  v_dot2c_f32_bf16 v147, v193, v225
  s_waitcnt vmcnt(14)
  v_dot2c_f32_bf16 v144, v194, v224
  v_dot2c_f32_bf16 v145, v194, v225
  v_dot2c_f32_bf16 v146, v195, v224
  v_dot2c_f32_bf16 v147, v195, v225
  s_waitcnt vmcnt(13)
  v_dot2c_f32_bf16 v144, v196, v224
  v_dot2c_f32_bf16 v145, v196, v225
  v_dot2c_f32_bf16 v146, v197, v224
  v_dot2c_f32_bf16 v147, v197, v225
  s_waitcnt vmcnt(12)
  v_dot2c_f32_bf16 v144, v198, v224
  v_dot2c_f32_bf16 v145, v198, v225
  v_dot2c_f32_bf16 v146, v199, v224
  v_dot2c_f32_bf16 v147, v199, v225
  s_waitcnt vmcnt(11)
  v_dot2c_f32_bf16 v144, v200, v224
  v_dot2c_f32_bf16 v145, v200, v225
  v_dot2c_f32_bf16 v146, v201, v224
  v_dot2c_f32_bf16 v147, v201, v225
  s_waitcnt vmcnt(10)
  v_dot2c_f32_bf16 v144, v202, v224
  v_dot2c_f32_bf16 v145, v202, v225
  v_dot2c_f32_bf16 v146, v203, v224
  v_dot2c_f32_bf16 v147, v203, v225
  s_waitcnt vmcnt(9)
  v_dot2c_f32_bf16 v144, v204, v224
  v_dot2c_f32_bf16 v145, v204, v225
  v_dot2c_f32_bf16 v146, v205, v224
  v_dot2c_f32_bf16 v147, v205, v225
  s_waitcnt vmcnt(8)
  v_dot2c_f32_bf16 v144, v206, v224
  v_dot2c_f32_bf16 v145, v206, v225
  v_dot2c_f32_bf16 v146, v207, v224
  v_dot2c_f32_bf16 v147, v207, v225
  s_nop 0
  v_cvt_pk_bf16_f32 v226, v144, v145
  s_nop 0
  v_cvt_pk_bf16_f32 v227, v146, v147
  s_lshl_b32 s74, s40, 9
  s_add_u32 s74, s74, 131072
  v_add_u32 v234, s74, v248
  ds_write_b64 v234, v[226:227]
  s_cmp_eq_u32 s40, 0
  s_cbranch_scc0 L_z2_33
  v_pk_add_f32 v[208:209], v[208:209], v[216:217]
  v_pk_add_f32 v[210:211], v[210:211], v[218:219]
  v_pk_add_f32 v[212:213], v[212:213], v[220:221]
  v_pk_add_f32 v[214:215], v[214:215], v[222:223]
  v_pk_add_f32 v[208:209], v[208:209], v[212:213]
  v_pk_add_f32 v[210:211], v[210:211], v[214:215]
  v_pk_add_f32 v[208:209], v[208:209], v[210:211]
  v_add_f32 v208, v208, v209
  v_bfe_u32 v148, v244, 4, 2
  v_bfe_u32 v149, v244, 2, 1
  v_lshl_add_u32 v148, v148, 1, v149
  v_and_b32 v149, 3, v244
  v_bfe_u32 v150, v244, 3, 1
  v_lshl_add_u32 v149, v150, 2, v149
  v_lshl_add_u32 v148, v148, 3, v149
  v_lshlrev_b32 v148, 1, v148
  v_add_u32 v148, 131072, v148
  v_cvt_pk_bf16_f32 v208, v208, v208
  ds_write_b16 v148, v208 offset:4096
L_z2_33:
  s_waitcnt lgkmcnt(0)
  s_barrier
  v_add_u32 v234, 131072, v248
  v_add_u32 v235, 131072, v243
  ds_read_b64 v[144:145], v234 offset:0
  ds_read_b64 v[146:147], v234 offset:512
  ds_read_b64 v[148:149], v234 offset:1024
  ds_read_b64 v[150:151], v234 offset:1536
  ds_read_b128 v[152:155], v235 offset:4096
  ds_read_b128 v[156:159], v235 offset:4128
  ds_read_b128 v[160:163], v235 offset:4160
  ds_read_b128 v[164:167], v235 offset:4192
  s_lshl_b32 s75, s41, 2
  s_add_u32 s75, s75, s40
  s_mul_i32 s75, s75, 115200
  s_lshl_b32 s76, s42, 11
  s_add_u32 s75, s75, s76
  s_add_u32 s55, s75, 6815744
  s_lshl_b32 s54, s42, 2
  s_add_u32 s54, s54, s40
  s_lshl_b32 s54, s54, 3
  s_lshl_b32 s74, s41, 9
  s_add_u32 s54, s54, s74
  s_add_u32 s54, s54, 0
  s_waitcnt lgkmcnt(0)
  v_cndmask_b32 v168, v152, v144, s[50:51]
  v_cndmask_b32 v176, v144, v160, s[50:51]
  v_cndmask_b32 v169, v153, v145, s[50:51]
  v_cndmask_b32 v177, v145, v161, s[50:51]
  v_cndmask_b32 v170, v154, v146, s[50:51]
  v_cndmask_b32 v178, v146, v162, s[50:51]
  v_cndmask_b32 v171, v155, v147, s[50:51]
  v_cndmask_b32 v179, v147, v163, s[50:51]
  v_cndmask_b32 v172, v156, v148, s[50:51]
  v_cndmask_b32 v180, v148, v164, s[50:51]
  v_cndmask_b32 v173, v157, v149, s[50:51]
  v_cndmask_b32 v181, v149, v165, s[50:51]
  v_cndmask_b32 v174, v158, v150, s[50:51]
  v_cndmask_b32 v182, v150, v166, s[50:51]
  v_cndmask_b32 v175, v159, v151, s[50:51]
  v_cndmask_b32 v183, v151, v167, s[50:51]
  v_mfma_f32_32x32x16_bf16 v[184:199], v[168:171], v[128:131], 0
  v_mfma_f32_32x32x16_bf16 v[200:215], v[176:179], v[136:139], 0
  v_mfma_f32_32x32x16_bf16 v[184:199], v[172:175], v[132:135], v[184:199]
  v_mfma_f32_32x32x16_bf16 v[200:215], v[180:183], v[140:143], v[200:215]
  s_nop 10
  v_add_f32 v216, 0x358637bd, v192
  v_add_f32 v218, 0x358637bd, v200
  v_rcp_f32 v216, v216
  v_rcp_f32 v218, v218
  v_pk_mul_f32 v[184:185], v[184:185], v[216:217] op_sel_hi:[1,0]
  v_pk_mul_f32 v[208:209], v[208:209], v[218:219] op_sel_hi:[1,0]
  v_pk_mul_f32 v[186:187], v[186:187], v[216:217] op_sel_hi:[1,0]
  v_pk_mul_f32 v[210:211], v[210:211], v[218:219] op_sel_hi:[1,0]
  v_pk_mul_f32 v[188:189], v[188:189], v[216:217] op_sel_hi:[1,0]
  v_pk_mul_f32 v[212:213], v[212:213], v[218:219] op_sel_hi:[1,0]
  v_pk_mul_f32 v[190:191], v[190:191], v[216:217] op_sel_hi:[1,0]
  v_pk_mul_f32 v[214:215], v[214:215], v[218:219] op_sel_hi:[1,0]
  v_cvt_pk_bf16_f32 v220, v184, v185
  v_cvt_pk_bf16_f32 v224, v208, v209
  v_cvt_pk_bf16_f32 v221, v186, v187
  v_cvt_pk_bf16_f32 v225, v210, v211
  v_cvt_pk_bf16_f32 v222, v188, v189
  v_cvt_pk_bf16_f32 v226, v212, v213
  v_cvt_pk_bf16_f32 v223, v190, v191
  v_cvt_pk_bf16_f32 v227, v214, v215
  s_cmp_eq_u32 s46, 0
  s_cbranch_scc1 L_st_34
  buffer_store_dwordx4 v[220:223], v255, s[36:39], s55 offen
  buffer_store_dwordx4 v[224:227], v255, s[36:39], s55 offen offset:1024
  s_branch L_st_34_e
L_st_34:
  buffer_store_dwordx4 v[220:223], v255, s[36:39], s55 offen sc0 sc1
  buffer_store_dwordx4 v[224:227], v255, s[36:39], s55 offen offset:1024 sc0 sc1
L_st_34_e:
  s_waitcnt vmcnt(0)
  s_or_b32 s70, s44, 5
  v_mov_b32 v236, s70
  v_mov_b32 v237, s45
  v_mov_b32 v238, 0
  s_mov_b64 exec, 1
  s_cmp_eq_u32 s46, 0
  s_cbranch_scc1 L_fs_35
  buffer_store_dwordx2 v[236:237], v238, s[36:39], s54 offen
  s_branch L_fs_35_e
L_fs_35:
  buffer_store_dwordx2 v[236:237], v238, s[36:39], s54 offen sc0 sc1
L_fs_35_e:
  s_mov_b64 exec, -1
  s_lshr_b32 s60, s42, 3
  s_lshl_b32 s60, s60, 1
  s_lshr_b32 s74, s40, 1
  s_add_u32 s60, s60, s74
  s_and_b32 s61, s40, 1
  s_and_b32 s62, s42, 7
  s_lshl_b32 s62, s62, 1
  s_add_u32 s62, s62, s61
  s_lshl_b32 s75, s41, 2
  s_add_u32 s75, s75, s60
  s_mul_i32 s75, s75, 33280
  s_lshl_b32 s76, s62, 11
  s_add_u32 s75, s75, s76
  s_add_u32 s75, s75, 4194304
  buffer_load_dwordx4 v[136:139], v255, s[36:39], s75 offen sc1
  buffer_load_dwordx4 v[140:143], v255, s[36:39], s75 offen offset:1024 sc1
  v_and_b32 v226, 3, v244
  v_bfe_u32 v227, v244, 3, 1
  v_lshl_add_u32 v226, v227, 2, v226
  v_bfe_u32 v227, v244, 2, 1
  v_lshrrev_b32 v228, 5, v244
  v_xor_b32 v227, v227, v228
  v_lshl_add_u32 v226, v227, 3, v226
  v_bfe_u32 v227, v244, 4, 1
  v_lshl_add_u32 v228, v227, 3, v226
  v_and_b32 v229, 1, v228
  v_lshlrev_b32 v229, 4, v229
  s_movk_i32 s74, 0x3f80
  v_lshlrev_b32 v229, v229, s74
  v_lshrrev_b32 v230, 1, v228
  v_cmp_eq_u32 vcc, 0, v230
  s_nop 1
  v_cndmask_b32 v128, 0, v229, vcc
  v_cmp_eq_u32 vcc, 1, v230
  s_nop 1
  v_cndmask_b32 v129, 0, v229, vcc
  v_cmp_eq_u32 vcc, 2, v230
  s_nop 1
  v_cndmask_b32 v130, 0, v229, vcc
  v_cmp_eq_u32 vcc, 3, v230
  s_nop 1
  v_cndmask_b32 v131, 0, v229, vcc
  v_xor_b32 v227, 1, v227
  v_lshl_add_u32 v228, v227, 3, v226
  v_and_b32 v229, 1, v228
  v_lshlrev_b32 v229, 4, v229
  s_movk_i32 s74, 0x3f80
  v_lshlrev_b32 v229, v229, s74
  v_lshrrev_b32 v230, 1, v228
  v_cmp_eq_u32 vcc, 0, v230
  s_nop 1
  v_cndmask_b32 v132, 0, v229, vcc
  v_cmp_eq_u32 vcc, 1, v230
  s_nop 1
  v_cndmask_b32 v133, 0, v229, vcc
  v_cmp_eq_u32 vcc, 2, v230
  s_nop 1
  v_cndmask_b32 v134, 0, v229, vcc
  v_cmp_eq_u32 vcc, 3, v230
  s_nop 1
  v_cndmask_b32 v135, 0, v229, vcc
  s_lshl_b32 s52, s41, 2
  s_add_u32 s52, s52, s60
  s_mul_i32 s52, s52, 33280
  s_lshl_b32 s76, s62, 11
  s_add_u32 s52, s52, s76
  s_add_u32 s52, s52, 4194304
  s_lshl_b32 s53, s41, 2
  s_add_u32 s53, s53, s60
  s_mul_i32 s53, s53, 4096
  s_bfe_u32 s76, s62, 0x20001
  s_lshl_b32 s76, s76, 10
  s_add_u32 s53, s53, s76
  s_lshr_b32 s76, s62, 3
  s_lshl_b32 s76, s76, 9
  s_add_u32 s53, s53, s76
  s_and_b32 s76, s62, 1
  s_lshl_b32 s76, s76, 3
  s_add_u32 s53, s53, s76
  s_add_u32 s53, s53, 65536
  v_and_b32 v240, 31, v244
  v_lshlrev_b32 v240, 4, v240
  v_lshrrev_b32 v241, 2, v243
  v_add_u32 v240, v240, v241
  s_lshl_b32 s54, s42, 2
  s_add_u32 s54, s54, s40
  s_lshl_b32 s54, s54, 3
  s_lshl_b32 s74, s41, 9
  s_add_u32 s54, s54, s74
  s_add_u32 s54, s54, 0
  s_lshl_b32 s63, 0x11111111, s60
  s_cmp_eq_u32 s61, 0
  s_cselect_b32 s64, s63, 0
  s_cselect_b32 s65, 0, s63
  s_lshl_b32 s71, s41, 9
  s_add_u32 s71, s71, 0
  s_or_b32 s70, s44, 5
  s_mov_b32 s68, s64
  s_mov_b32 s69, s65
  s_mov_b32 s80, 0
L_poll_36:
  buffer_load_dwordx2 v[236:237], v248, s[36:39], s71 offen sc1
  s_add_u32 s80, s80, 1
  s_cmp_gt_u32 s80, 0x40000
  s_cbranch_scc1 L_poll_36_x
  s_waitcnt vmcnt(0)
  v_subrev_u32 v236, s70, v236
  v_cmp_ge_u32 vcc, 10, v236
  v_cmp_eq_u32 s[66:67], s45, v237
  s_and_b64 vcc, vcc, s[66:67]
  s_andn2_b64 s[66:67], s[68:69], vcc
  s_cbranch_scc1 L_poll_36
L_poll_36_x:
  s_waitcnt vmcnt(0)
  s_lshl_b32 s75, s41, 2
  s_add_u32 s75, s75, s60
  s_mul_i32 s75, s75, 115200
  s_lshl_b32 s76, s61, 14
  s_add_u32 s75, s75, s76
  s_add_u32 s59, s75, 6815744
  buffer_load_dwordx4 v[144:147], v255, s[36:39], s59 offen offset:0 sc1
  buffer_load_dwordx4 v[148:151], v255, s[36:39], s59 offen offset:1024 sc1
  buffer_load_dwordx4 v[152:155], v255, s[36:39], s59 offen offset:2048 sc1
  buffer_load_dwordx4 v[156:159], v255, s[36:39], s59 offen offset:3072 sc1
  s_add_u32 s59, s59, 4096
  buffer_load_dwordx4 v[160:163], v255, s[36:39], s59 offen offset:0 sc1
  buffer_load_dwordx4 v[164:167], v255, s[36:39], s59 offen offset:1024 sc1
  buffer_load_dwordx4 v[168:171], v255, s[36:39], s59 offen offset:2048 sc1
  buffer_load_dwordx4 v[172:175], v255, s[36:39], s59 offen offset:3072 sc1
  s_add_u32 s59, s59, 4096
  buffer_load_dwordx4 v[176:179], v255, s[36:39], s59 offen offset:0 sc1
  buffer_load_dwordx4 v[180:183], v255, s[36:39], s59 offen offset:1024 sc1
  v_mfma_f32_32x32x16_bf16 v[208:223], v[128:131], v[136:139], 0
  v_mfma_f32_32x32x16_bf16 v[208:223], v[132:135], v[140:143], v[208:223]
  s_lshl_b32 s74, s40, 12
  s_add_u32 s75, s74, 131072
  v_add_u32 v128, s75, v255
  s_xor_b32 s74, s74, 4096
  s_add_u32 s75, s74, 131072
  v_add_u32 v129, s75, v255
  v_lshlrev_b32 v130, 7, v244
  s_waitcnt vmcnt(9)
  v_mfma_f32_32x32x16_bf16 v[224:239], v[4:7], v[144:147], 0
  buffer_load_dwordx4 v[184:187], v255, s[36:39], s59 offen offset:2048 sc1
  v_mfma_f32_32x32x16_bf16 v[208:223], v[0:3], v[144:147], v[208:223]
  s_waitcnt vmcnt(9)
  v_mfma_f32_32x32x16_bf16 v[224:239], v[12:15], v[148:151], v[224:239]
  buffer_load_dwordx4 v[188:191], v255, s[36:39], s59 offen offset:3072 sc1
  v_mfma_f32_32x32x16_bf16 v[208:223], v[8:11], v[148:151], v[208:223]
  s_waitcnt vmcnt(9)
  v_mfma_f32_32x32x16_bf16 v[224:239], v[20:23], v[152:155], v[224:239]
  s_add_u32 s59, s59, 4096
  buffer_load_dwordx4 v[192:195], v255, s[36:39], s59 offen offset:0 sc1
  v_mfma_f32_32x32x16_bf16 v[208:223], v[16:19], v[152:155], v[208:223]
  s_waitcnt vmcnt(9)
  v_mfma_f32_32x32x16_bf16 v[224:239], v[28:31], v[156:159], v[224:239]
  buffer_load_dwordx4 v[196:199], v255, s[36:39], s59 offen offset:1024 sc1
  v_mfma_f32_32x32x16_bf16 v[208:223], v[24:27], v[156:159], v[208:223]
  s_waitcnt vmcnt(9)
  v_mfma_f32_32x32x16_bf16 v[224:239], v[36:39], v[160:163], v[224:239]
  buffer_load_dwordx4 v[200:203], v255, s[36:39], s59 offen offset:2048 sc1
  v_mfma_f32_32x32x16_bf16 v[208:223], v[32:35], v[160:163], v[208:223]
  s_waitcnt vmcnt(9)
  v_mfma_f32_32x32x16_bf16 v[224:239], v[44:47], v[164:167], v[224:239]
  buffer_load_dwordx4 v[204:207], v255, s[36:39], s59 offen offset:3072 sc1
  v_mfma_f32_32x32x16_bf16 v[208:223], v[40:43], v[164:167], v[208:223]
  s_waitcnt vmcnt(9)
  v_mfma_f32_32x32x16_bf16 v[224:239], v[52:55], v[168:171], v[224:239]
  v_mfma_f32_32x32x16_bf16 v[208:223], v[48:51], v[168:171], v[208:223]
  s_waitcnt vmcnt(8)
  v_mfma_f32_32x32x16_bf16 v[224:239], v[60:63], v[172:175], v[224:239]
  v_mfma_f32_32x32x16_bf16 v[208:223], v[56:59], v[172:175], v[208:223]
  s_waitcnt vmcnt(7)
  v_mfma_f32_32x32x16_bf16 v[224:239], v[68:71], v[176:179], v[224:239]
  v_mfma_f32_32x32x16_bf16 v[208:223], v[64:67], v[176:179], v[208:223]
  s_waitcnt vmcnt(6)
  v_mfma_f32_32x32x16_bf16 v[224:239], v[76:79], v[180:183], v[224:239]
  v_mfma_f32_32x32x16_bf16 v[208:223], v[72:75], v[180:183], v[208:223]
  s_waitcnt vmcnt(5)
  v_mfma_f32_32x32x16_bf16 v[224:239], v[84:87], v[184:187], v[224:239]
  v_mfma_f32_32x32x16_bf16 v[208:223], v[80:83], v[184:187], v[208:223]
  s_waitcnt vmcnt(4)
  v_mfma_f32_32x32x16_bf16 v[224:239], v[92:95], v[188:191], v[224:239]
  v_mfma_f32_32x32x16_bf16 v[208:223], v[88:91], v[188:191], v[208:223]
  s_waitcnt vmcnt(3)
  v_mfma_f32_32x32x16_bf16 v[224:239], v[100:103], v[192:195], v[224:239]
  v_mfma_f32_32x32x16_bf16 v[208:223], v[96:99], v[192:195], v[208:223]
  s_waitcnt vmcnt(2)
  v_mfma_f32_32x32x16_bf16 v[224:239], v[108:111], v[196:199], v[224:239]
  v_mfma_f32_32x32x16_bf16 v[208:223], v[104:107], v[196:199], v[208:223]
  s_waitcnt vmcnt(1)
  v_mfma_f32_32x32x16_bf16 v[224:239], v[116:119], v[200:203], v[224:239]
  v_mfma_f32_32x32x16_bf16 v[208:223], v[112:115], v[200:203], v[208:223]
  s_waitcnt vmcnt(0)
  v_mfma_f32_32x32x16_bf16 v[224:239], v[124:127], v[204:207], v[224:239]
  v_mfma_f32_32x32x16_bf16 v[208:223], v[120:123], v[204:207], v[208:223]
  s_nop 10
  ds_write_b128 v128, v[224:227] offset:0
  ds_write_b128 v128, v[228:231] offset:1024
  ds_write_b128 v128, v[232:235] offset:2048
  ds_write_b128 v128, v[236:239] offset:3072
  s_waitcnt lgkmcnt(0)
  s_barrier
  ds_read_b128 v[144:147], v129 offset:0
  ds_read_b128 v[148:151], v129 offset:1024
  ds_read_b128 v[152:155], v129 offset:2048
  ds_read_b128 v[156:159], v129 offset:3072
  s_waitcnt lgkmcnt(0)
  v_pk_add_f32 v[208:209], v[208:209], v[144:145]
  v_pk_add_f32 v[210:211], v[210:211], v[146:147]
  v_pk_add_f32 v[212:213], v[212:213], v[148:149]
  v_pk_add_f32 v[214:215], v[214:215], v[150:151]
  v_pk_add_f32 v[216:217], v[216:217], v[152:153]
  v_pk_add_f32 v[218:219], v[218:219], v[154:155]
  v_pk_add_f32 v[220:221], v[220:221], v[156:157]
  v_pk_add_f32 v[222:223], v[222:223], v[158:159]
  v_cvt_pk_bf16_f32 v160, v208, v209
  v_cvt_pk_bf16_f32 v161, v210, v211
  v_cvt_pk_bf16_f32 v162, v212, v213
  v_cvt_pk_bf16_f32 v163, v214, v215
  v_cvt_pk_bf16_f32 v164, v216, v217
  v_cvt_pk_bf16_f32 v165, v218, v219
  v_cvt_pk_bf16_f32 v166, v220, v221
  v_cvt_pk_bf16_f32 v167, v222, v223
  s_cmp_eq_u32 s46, 0
  s_cbranch_scc1 L_st_38
  buffer_store_dwordx4 v[160:163], v255, s[36:39], s52 offen
  buffer_store_dwordx4 v[164:167], v255, s[36:39], s52 offen offset:1024
  s_branch L_st_38_e
L_st_38:
  buffer_store_dwordx4 v[160:163], v255, s[36:39], s52 offen sc0 sc1
  buffer_store_dwordx4 v[164:167], v255, s[36:39], s52 offen offset:1024 sc0 sc1
L_st_38_e:
  v_pk_add_f32 v[168:169], v[208:209], v[210:211]
  v_pk_mul_f32 v[170:171], v[208:209], v[208:209]
  v_pk_fma_f32 v[170:171], v[210:211], v[210:211], v[170:171]
  v_pk_add_f32 v[168:169], v[168:169], v[212:213]
  v_pk_fma_f32 v[170:171], v[212:213], v[212:213], v[170:171]
  v_pk_add_f32 v[168:169], v[168:169], v[214:215]
  v_pk_fma_f32 v[170:171], v[214:215], v[214:215], v[170:171]
  v_pk_add_f32 v[168:169], v[168:169], v[216:217]
  v_pk_fma_f32 v[170:171], v[216:217], v[216:217], v[170:171]
  v_pk_add_f32 v[168:169], v[168:169], v[218:219]
  v_pk_fma_f32 v[170:171], v[218:219], v[218:219], v[170:171]
  v_pk_add_f32 v[168:169], v[168:169], v[220:221]
  v_pk_fma_f32 v[170:171], v[220:221], v[220:221], v[170:171]
  v_pk_add_f32 v[168:169], v[168:169], v[222:223]
  v_pk_fma_f32 v[170:171], v[222:223], v[222:223], v[170:171]
  v_add_f32 v168, v168, v169
  v_add_f32 v169, v170, v171
  s_nop 1
  v_permlane32_swap_b32 v168, v169
  v_add_f32 v168, v168, v169
  s_cmp_eq_u32 s46, 0
  s_cbranch_scc1 L_st_39
  buffer_store_dword v168, v240, s[36:39], s53 offen
  s_branch L_st_39_e
L_st_39:
  buffer_store_dword v168, v240, s[36:39], s53 offen sc0 sc1
L_st_39_e:
  s_waitcnt vmcnt(0)
  s_or_b32 s70, s44, 6
  v_mov_b32 v236, s70
  v_mov_b32 v237, s45
  v_mov_b32 v238, 0
  s_mov_b64 exec, 1
  s_cmp_eq_u32 s46, 0
  s_cbranch_scc1 L_fs_40
  buffer_store_dwordx2 v[236:237], v238, s[36:39], s54 offen
  s_branch L_fs_40_e
L_fs_40:
  buffer_store_dwordx2 v[236:237], v238, s[36:39], s54 offen sc0 sc1
L_fs_40_e:
  s_mov_b64 exec, -1
  s_barrier
  s_lshl_b32 s56, s42, 8
  s_mul_i32 s57, s40, 28672
  s_add_u32 s56, s56, s57
  s_add_u32 s56, s56, 917504
  s_lshl_b32 s57, s40, 10
  s_add_u32 s57, s57, 131072
  s_add_u32 s58, s93, 0
  s_and_b32 s58, s58, 7
  s_lshl_b32 s81, s58, 12
  s_add_u32 m0, s81, s57
  s_mul_i32 s58, s58, 114688
  s_add_u32 s58, s58, s56
  buffer_load_dwordx4 v246, s[20:23], s58 offen lds
  s_add_u32 s58, s93, 1
  s_and_b32 s58, s58, 7
  s_lshl_b32 s81, s58, 12
  s_add_u32 m0, s81, s57
  s_mul_i32 s58, s58, 114688
  s_add_u32 s58, s58, s56
  buffer_load_dwordx4 v246, s[20:23], s58 offen lds
  s_add_u32 s58, s93, 2
  s_and_b32 s58, s58, 7
  s_lshl_b32 s81, s58, 12
  s_add_u32 m0, s81, s57
  s_mul_i32 s58, s58, 114688
  s_add_u32 s58, s58, s56
  buffer_load_dwordx4 v246, s[20:23], s58 offen lds
  s_add_u32 s58, s93, 3
  s_and_b32 s58, s58, 7
  s_lshl_b32 s81, s58, 12
  s_add_u32 m0, s81, s57
  s_mul_i32 s58, s58, 114688
  s_add_u32 s58, s58, s56
  buffer_load_dwordx4 v246, s[20:23], s58 offen lds
  s_add_u32 s58, s93, 4
  s_and_b32 s58, s58, 7
  s_lshl_b32 s81, s58, 12
  s_add_u32 m0, s81, s57
  s_mul_i32 s58, s58, 114688
  s_add_u32 s58, s58, s56
  buffer_load_dwordx4 v246, s[20:23], s58 offen lds
  s_add_u32 s58, s93, 5
  s_and_b32 s58, s58, 7
  s_lshl_b32 s81, s58, 12
  s_add_u32 m0, s81, s57
  s_mul_i32 s58, s58, 114688
  s_add_u32 s58, s58, s56
  buffer_load_dwordx4 v246, s[20:23], s58 offen lds
  s_add_u32 s58, s93, 6
  s_and_b32 s58, s58, 7
  s_lshl_b32 s81, s58, 12
  s_add_u32 m0, s81, s57
  s_mul_i32 s58, s58, 114688
  s_add_u32 s58, s58, s56
  buffer_load_dwordx4 v246, s[20:23], s58 offen lds
  s_add_u32 s58, s93, 7
  s_and_b32 s58, s58, 7
  s_lshl_b32 s81, s58, 12
  s_add_u32 m0, s81, s57
  s_mul_i32 s58, s58, 114688
  s_add_u32 s58, s58, s56
  buffer_load_dwordx4 v246, s[20:23], s58 offen lds
  s_cmp_ge_u32 s42, 14
  s_cbranch_scc1 L_p3skip1
  v_add_u32 v224, 98304, v252
  v_add_u32 v225, 98304, v251
  v_add_u32 v226, 131072, v252
  v_add_u32 v227, 131072, v251
  s_and_b32 s74, s40, 1
  s_lshl_b32 s74, s74, 1
  s_lshl_b32 s63, 0x33333333, s74
  s_cmp_lt_u32 s40, 2
  s_cselect_b32 s64, s63, 0
  s_cselect_b32 s65, 0, s63
  s_lshl_b32 s71, s41, 9
  s_add_u32 s71, s71, 0
  s_or_b32 s70, s44, 6
  s_mov_b32 s68, s64
  s_mov_b32 s69, s65
  s_mov_b32 s80, 0
L_poll_41:
  buffer_load_dwordx2 v[236:237], v248, s[36:39], s71 offen sc1
  s_add_u32 s80, s80, 1
  s_cmp_gt_u32 s80, 0x40000
  s_cbranch_scc1 L_poll_41_x
  s_waitcnt vmcnt(0)
  v_subrev_u32 v236, s70, v236
  v_cmp_ge_u32 vcc, 9, v236
  v_cmp_eq_u32 s[66:67], s45, v237
  s_and_b64 vcc, vcc, s[66:67]
  s_andn2_b64 s[66:67], s[68:69], vcc
  s_cbranch_scc1 L_poll_41
L_poll_41_x:
  s_waitcnt vmcnt(0)
  s_barrier
  s_lshl_b32 s75, s41, 2
  s_add_u32 s75, s75, s40
  s_mul_i32 s75, s75, 33280
  s_add_u32 s75, s75, 4194304
  s_lshl_b32 s77, s41, 2
  s_add_u32 s77, s77, s40
  s_mul_i32 s77, s77, 4096
  s_add_u32 s77, s77, 65536
  buffer_load_dwordx4 v[160:163], v255, s[36:39], s77 offen offset:0 sc1
  buffer_load_dwordx4 v[164:167], v255, s[36:39], s77 offen offset:1024 sc1
  buffer_load_dwordx4 v[168:171], v255, s[36:39], s77 offen offset:2048 sc1
  buffer_load_dwordx4 v[172:175], v255, s[36:39], s77 offen offset:3072 sc1
  s_mov_b32 s59, s75
  s_lshl_b32 s55, s41, 2
  s_add_u32 s55, s55, s40
  s_mul_i32 s55, s55, 115200
  s_lshl_b32 s76, s42, 13
  s_add_u32 s55, s55, s76
  s_add_u32 s55, s55, 6815744
  buffer_load_dwordx4 v[0:3], v255, s[36:39], s59 offen offset:0 sc1
  buffer_load_dwordx4 v[4:7], v255, s[36:39], s59 offen offset:1024 sc1
  buffer_load_dwordx4 v[8:11], v255, s[36:39], s59 offen offset:2048 sc1
  buffer_load_dwordx4 v[12:15], v255, s[36:39], s59 offen offset:3072 sc1
  s_add_u32 s59, s59, 4096
  buffer_load_dwordx4 v[16:19], v255, s[36:39], s59 offen offset:0 sc1
  buffer_load_dwordx4 v[20:23], v255, s[36:39], s59 offen offset:1024 sc1
  buffer_load_dwordx4 v[24:27], v255, s[36:39], s59 offen offset:2048 sc1
  buffer_load_dwordx4 v[28:31], v255, s[36:39], s59 offen offset:3072 sc1
  s_add_u32 s59, s59, 4096
  buffer_load_dwordx4 v[32:35], v255, s[36:39], s59 offen offset:0 sc1
  ds_read_b64_tr_b16 v[192:193], v224 offset:0
  ds_read_b64_tr_b16 v[194:195], v224 offset:512
  ds_read_b64_tr_b16 v[196:197], v225 offset:0
  ds_read_b64_tr_b16 v[198:199], v225 offset:512
  ds_read_b64_tr_b16 v[200:201], v224 offset:1024
  ds_read_b64_tr_b16 v[202:203], v224 offset:1536
  ds_read_b64_tr_b16 v[204:205], v225 offset:1024
  ds_read_b64_tr_b16 v[206:207], v225 offset:1536
  s_waitcnt vmcnt(8)
  s_waitcnt lgkmcnt(4)
  v_mfma_f32_32x32x16_bf16 v[128:143], v[192:195], v[0:3], 0
  v_add_f32 v160, v160, v162
  v_add_f32 v161, v161, v163
  ds_read_b64_tr_b16 v[208:209], v224 offset:4096
  ds_read_b64_tr_b16 v[210:211], v224 offset:4608
  ds_read_b64_tr_b16 v[212:213], v225 offset:4096
  ds_read_b64_tr_b16 v[214:215], v225 offset:4608
  v_mfma_f32_32x32x16_bf16 v[144:159], v[196:199], v[0:3], 0
  v_add_f32 v160, v160, v164
  v_add_f32 v161, v161, v165
  v_add_f32 v160, v160, v166
  v_add_f32 v161, v161, v167
  v_add_f32 v160, v160, v168
  buffer_load_dwordx4 v[36:39], v255, s[36:39], s59 offen offset:1024 sc1
  s_waitcnt vmcnt(8)
  s_waitcnt lgkmcnt(4)
  v_mfma_f32_32x32x16_bf16 v[128:143], v[200:203], v[4:7], v[128:143]
  v_add_f32 v161, v161, v169
  v_add_f32 v160, v160, v170
  ds_read_b64_tr_b16 v[192:193], v224 offset:5120
  ds_read_b64_tr_b16 v[194:195], v224 offset:5632
  ds_read_b64_tr_b16 v[196:197], v225 offset:5120
  ds_read_b64_tr_b16 v[198:199], v225 offset:5632
  v_mfma_f32_32x32x16_bf16 v[144:159], v[204:207], v[4:7], v[144:159]
  v_add_f32 v161, v161, v171
  v_add_f32 v160, v160, v172
  v_add_f32 v161, v161, v173
  v_add_f32 v160, v160, v174
  v_add_f32 v161, v161, v175
  buffer_load_dwordx4 v[40:43], v255, s[36:39], s59 offen offset:2048 sc1
  s_waitcnt vmcnt(8)
  s_waitcnt lgkmcnt(4)
  v_mfma_f32_32x32x16_bf16 v[128:143], v[208:211], v[8:11], v[128:143]
  v_permlane32_swap_b32 v160, v161
  ds_read_b64_tr_b16 v[200:201], v224 offset:8192
  ds_read_b64_tr_b16 v[202:203], v224 offset:8704
  ds_read_b64_tr_b16 v[204:205], v225 offset:8192
  ds_read_b64_tr_b16 v[206:207], v225 offset:8704
  v_mfma_f32_32x32x16_bf16 v[144:159], v[212:215], v[8:11], v[144:159]
  v_add_f32 v160, v160, v161
  v_mov_b32 v161, v160
  s_nop 1
  v_permlane32_swap_b32 v160, v161
  v_mul_f32 v160, 0x3b000000, v160
  buffer_load_dwordx4 v[44:47], v255, s[36:39], s59 offen offset:3072 sc1
  s_waitcnt vmcnt(8)
  s_waitcnt lgkmcnt(4)
  v_mfma_f32_32x32x16_bf16 v[128:143], v[192:195], v[12:15], v[128:143]
  v_mul_f32 v161, 0x3b000000, v161
  v_fma_f32 v161, -v160, v160, v161
  ds_read_b64_tr_b16 v[208:209], v224 offset:9216
  ds_read_b64_tr_b16 v[210:211], v224 offset:9728
  ds_read_b64_tr_b16 v[212:213], v225 offset:9216
  ds_read_b64_tr_b16 v[214:215], v225 offset:9728
  v_mfma_f32_32x32x16_bf16 v[144:159], v[196:199], v[12:15], v[144:159]
  v_max_f32 v161, 0, v161
  v_add_f32 v161, 0x3727c5ac, v161
  v_rsq_f32 v233, v161
  s_add_u32 s59, s59, 4096
  buffer_load_dwordx4 v[48:51], v255, s[36:39], s59 offen offset:0 sc1
  s_waitcnt vmcnt(8)
  s_waitcnt lgkmcnt(4)
  v_mfma_f32_32x32x16_bf16 v[128:143], v[200:203], v[16:19], v[128:143]
  v_mul_f32 v232, 0x3fb8aa3b, v233
  v_sub_f32 v234, 0, v160
  ds_read_b64_tr_b16 v[192:193], v224 offset:12288
  ds_read_b64_tr_b16 v[194:195], v224 offset:12800
  ds_read_b64_tr_b16 v[196:197], v225 offset:12288
  ds_read_b64_tr_b16 v[198:199], v225 offset:12800
  v_mfma_f32_32x32x16_bf16 v[144:159], v[204:207], v[16:19], v[144:159]
  v_cvt_pk_bf16_f32 v228, v234, v234
  v_and_b32 v235, 0xffff0000, v228
  v_sub_f32 v235, v234, v235
  v_cvt_pk_bf16_f32 v229, v235, 0
  v_cndmask_b32 v228, 0, v228, s[48:49]
  buffer_load_dwordx4 v[52:55], v255, s[36:39], s59 offen offset:1024 sc1
  s_waitcnt vmcnt(8)
  s_waitcnt lgkmcnt(4)
  v_mfma_f32_32x32x16_bf16 v[128:143], v[208:211], v[20:23], v[128:143]
  v_cndmask_b32 v229, 0, v229, s[48:49]
  v_mov_b32 v230, 0
  ds_read_b64_tr_b16 v[200:201], v224 offset:13312
  ds_read_b64_tr_b16 v[202:203], v224 offset:13824
  ds_read_b64_tr_b16 v[204:205], v225 offset:13312
  ds_read_b64_tr_b16 v[206:207], v225 offset:13824
  v_mfma_f32_32x32x16_bf16 v[144:159], v[212:215], v[20:23], v[144:159]
  v_mov_b32 v231, 0
  buffer_load_dwordx4 v[56:59], v255, s[36:39], s59 offen offset:2048 sc1
  s_waitcnt vmcnt(8)
  s_waitcnt lgkmcnt(4)
  v_mfma_f32_32x32x16_bf16 v[128:143], v[192:195], v[24:27], v[128:143]
  ds_read_b64_tr_b16 v[208:209], v224 offset:16384
  ds_read_b64_tr_b16 v[210:211], v224 offset:16896
  ds_read_b64_tr_b16 v[212:213], v225 offset:16384
  ds_read_b64_tr_b16 v[214:215], v225 offset:16896
  v_mfma_f32_32x32x16_bf16 v[144:159], v[196:199], v[24:27], v[144:159]
  buffer_load_dwordx4 v[60:63], v255, s[36:39], s59 offen offset:3072 sc1
  s_waitcnt vmcnt(8)
  s_waitcnt lgkmcnt(4)
  v_mfma_f32_32x32x16_bf16 v[128:143], v[200:203], v[28:31], v[128:143]
  ds_read_b64_tr_b16 v[192:193], v224 offset:17408
  ds_read_b64_tr_b16 v[194:195], v224 offset:17920
  ds_read_b64_tr_b16 v[196:197], v225 offset:17408
  ds_read_b64_tr_b16 v[198:199], v225 offset:17920
  v_mfma_f32_32x32x16_bf16 v[144:159], v[204:207], v[28:31], v[144:159]
  s_add_u32 s59, s59, 4096
  buffer_load_dwordx4 v[64:67], v255, s[36:39], s59 offen offset:0 sc1
  s_waitcnt vmcnt(8)
  s_waitcnt lgkmcnt(4)
  v_mfma_f32_32x32x16_bf16 v[128:143], v[208:211], v[32:35], v[128:143]
  ds_read_b64_tr_b16 v[200:201], v224 offset:20480
  ds_read_b64_tr_b16 v[202:203], v224 offset:20992
  ds_read_b64_tr_b16 v[204:205], v225 offset:20480
  ds_read_b64_tr_b16 v[206:207], v225 offset:20992
  v_mfma_f32_32x32x16_bf16 v[144:159], v[212:215], v[32:35], v[144:159]
  buffer_load_dwordx4 v[68:71], v255, s[36:39], s59 offen offset:1024 sc1
  s_waitcnt vmcnt(8)
  s_waitcnt lgkmcnt(4)
  v_mfma_f32_32x32x16_bf16 v[128:143], v[192:195], v[36:39], v[128:143]
  ds_read_b64_tr_b16 v[208:209], v224 offset:21504
  ds_read_b64_tr_b16 v[210:211], v224 offset:22016
  ds_read_b64_tr_b16 v[212:213], v225 offset:21504
  ds_read_b64_tr_b16 v[214:215], v225 offset:22016
  v_mfma_f32_32x32x16_bf16 v[144:159], v[196:199], v[36:39], v[144:159]
  buffer_load_dwordx4 v[72:75], v255, s[36:39], s59 offen offset:2048 sc1
  s_waitcnt vmcnt(8)
  s_waitcnt lgkmcnt(4)
  v_mfma_f32_32x32x16_bf16 v[128:143], v[200:203], v[40:43], v[128:143]
  ds_read_b64_tr_b16 v[192:193], v224 offset:24576
  ds_read_b64_tr_b16 v[194:195], v224 offset:25088
  ds_read_b64_tr_b16 v[196:197], v225 offset:24576
  ds_read_b64_tr_b16 v[198:199], v225 offset:25088
  v_mfma_f32_32x32x16_bf16 v[144:159], v[204:207], v[40:43], v[144:159]
  buffer_load_dwordx4 v[76:79], v255, s[36:39], s59 offen offset:3072 sc1
  s_waitcnt vmcnt(8)
  s_waitcnt lgkmcnt(4)
  v_mfma_f32_32x32x16_bf16 v[128:143], v[208:211], v[44:47], v[128:143]
  ds_read_b64_tr_b16 v[200:201], v224 offset:25600
  ds_read_b64_tr_b16 v[202:203], v224 offset:26112
  ds_read_b64_tr_b16 v[204:205], v225 offset:25600
  ds_read_b64_tr_b16 v[206:207], v225 offset:26112
  v_mfma_f32_32x32x16_bf16 v[144:159], v[212:215], v[44:47], v[144:159]
  s_add_u32 s59, s59, 4096
  buffer_load_dwordx4 v[80:83], v255, s[36:39], s59 offen offset:0 sc1
  s_waitcnt vmcnt(8)
  s_waitcnt lgkmcnt(4)
  v_mfma_f32_32x32x16_bf16 v[128:143], v[192:195], v[48:51], v[128:143]
  ds_read_b64_tr_b16 v[208:209], v224 offset:28672
  ds_read_b64_tr_b16 v[210:211], v224 offset:29184
  ds_read_b64_tr_b16 v[212:213], v225 offset:28672
  ds_read_b64_tr_b16 v[214:215], v225 offset:29184
  v_mfma_f32_32x32x16_bf16 v[144:159], v[196:199], v[48:51], v[144:159]
  buffer_load_dwordx4 v[84:87], v255, s[36:39], s59 offen offset:1024 sc1
  s_waitcnt vmcnt(8)
  s_waitcnt lgkmcnt(4)
  v_mfma_f32_32x32x16_bf16 v[128:143], v[200:203], v[52:55], v[128:143]
  ds_read_b64_tr_b16 v[192:193], v224 offset:29696
  ds_read_b64_tr_b16 v[194:195], v224 offset:30208
  ds_read_b64_tr_b16 v[196:197], v225 offset:29696
  ds_read_b64_tr_b16 v[198:199], v225 offset:30208
  v_mfma_f32_32x32x16_bf16 v[144:159], v[204:207], v[52:55], v[144:159]
  buffer_load_dwordx4 v[88:91], v255, s[36:39], s59 offen offset:2048 sc1
  s_waitcnt vmcnt(8)
  s_waitcnt lgkmcnt(4)
  v_mfma_f32_32x32x16_bf16 v[128:143], v[208:211], v[56:59], v[128:143]
  v_mfma_f32_32x32x16_bf16 v[144:159], v[212:215], v[56:59], v[144:159]
  buffer_load_dwordx4 v[92:95], v255, s[36:39], s59 offen offset:3072 sc1
  s_waitcnt vmcnt(8)
  s_waitcnt lgkmcnt(0)
  v_mfma_f32_32x32x16_bf16 v[128:143], v[192:195], v[60:63], v[128:143]
  v_mfma_f32_32x32x16_bf16 v[144:159], v[196:199], v[60:63], v[144:159]
  s_add_u32 s59, s59, 4096
  buffer_load_dwordx4 v[96:99], v255, s[36:39], s59 offen offset:0 sc1
  s_barrier
  s_lshl_b32 s56, s42, 8
  s_mul_i32 s57, s40, 28672
  s_add_u32 s56, s56, s57
  s_add_u32 s56, s56, 128
  s_lshl_b32 s57, s40, 10
  s_add_u32 s57, s57, 98304
  ds_read_b64_tr_b16 v[192:193], v226 offset:0
  ds_read_b64_tr_b16 v[194:195], v226 offset:512
  ds_read_b64_tr_b16 v[196:197], v227 offset:0
  ds_read_b64_tr_b16 v[198:199], v227 offset:512
  ds_read_b64_tr_b16 v[200:201], v226 offset:1024
  ds_read_b64_tr_b16 v[202:203], v226 offset:1536
  ds_read_b64_tr_b16 v[204:205], v227 offset:1024
  ds_read_b64_tr_b16 v[206:207], v227 offset:1536
  s_waitcnt vmcnt(8)
  s_waitcnt lgkmcnt(4)
  v_mfma_f32_32x32x16_bf16 v[128:143], v[192:195], v[64:67], v[128:143]
  ds_read_b64_tr_b16 v[208:209], v226 offset:4096
  ds_read_b64_tr_b16 v[210:211], v226 offset:4608
  ds_read_b64_tr_b16 v[212:213], v227 offset:4096
  ds_read_b64_tr_b16 v[214:215], v227 offset:4608
  v_mfma_f32_32x32x16_bf16 v[144:159], v[196:199], v[64:67], v[144:159]
  s_add_u32 s58, s93, 0
  s_and_b32 s58, s58, 7
  s_lshl_b32 s81, s58, 12
  s_add_u32 m0, s81, s57
  s_mul_i32 s58, s58, 114688
  s_add_u32 s58, s58, s56
  buffer_load_dwordx4 v246, s[20:23], s58 offen lds
  s_add_u32 s58, s93, 1
  s_and_b32 s58, s58, 7
  s_lshl_b32 s81, s58, 12
  s_add_u32 m0, s81, s57
  s_mul_i32 s58, s58, 114688
  s_add_u32 s58, s58, s56
  buffer_load_dwordx4 v246, s[20:23], s58 offen lds
  buffer_load_dwordx4 v[100:103], v255, s[36:39], s59 offen offset:1024 sc1
  s_waitcnt vmcnt(10)
  s_waitcnt lgkmcnt(4)
  v_mfma_f32_32x32x16_bf16 v[128:143], v[200:203], v[68:71], v[128:143]
  ds_read_b64_tr_b16 v[192:193], v226 offset:5120
  ds_read_b64_tr_b16 v[194:195], v226 offset:5632
  ds_read_b64_tr_b16 v[196:197], v227 offset:5120
  ds_read_b64_tr_b16 v[198:199], v227 offset:5632
  v_mfma_f32_32x32x16_bf16 v[144:159], v[204:207], v[68:71], v[144:159]
  s_add_u32 s58, s93, 2
  s_and_b32 s58, s58, 7
  s_lshl_b32 s81, s58, 12
  s_add_u32 m0, s81, s57
  s_mul_i32 s58, s58, 114688
  s_add_u32 s58, s58, s56
  buffer_load_dwordx4 v246, s[20:23], s58 offen lds
  s_add_u32 s58, s93, 3
  s_and_b32 s58, s58, 7
  s_lshl_b32 s81, s58, 12
  s_add_u32 m0, s81, s57
  s_mul_i32 s58, s58, 114688
  s_add_u32 s58, s58, s56
  buffer_load_dwordx4 v246, s[20:23], s58 offen lds
  buffer_load_dwordx4 v[104:107], v255, s[36:39], s59 offen offset:2048 sc1
  s_waitcnt vmcnt(12)
  s_waitcnt lgkmcnt(4)
  v_mfma_f32_32x32x16_bf16 v[128:143], v[208:211], v[72:75], v[128:143]
  ds_read_b64_tr_b16 v[200:201], v226 offset:8192
  ds_read_b64_tr_b16 v[202:203], v226 offset:8704
  ds_read_b64_tr_b16 v[204:205], v227 offset:8192
  ds_read_b64_tr_b16 v[206:207], v227 offset:8704
  v_mfma_f32_32x32x16_bf16 v[144:159], v[212:215], v[72:75], v[144:159]
  s_add_u32 s58, s93, 4
  s_and_b32 s58, s58, 7
  s_lshl_b32 s81, s58, 12
  s_add_u32 m0, s81, s57
  s_mul_i32 s58, s58, 114688
  s_add_u32 s58, s58, s56
  buffer_load_dwordx4 v246, s[20:23], s58 offen lds
  s_add_u32 s58, s93, 5
  s_and_b32 s58, s58, 7
  s_lshl_b32 s81, s58, 12
  s_add_u32 m0, s81, s57
  s_mul_i32 s58, s58, 114688
  s_add_u32 s58, s58, s56
  buffer_load_dwordx4 v246, s[20:23], s58 offen lds
  buffer_load_dwordx4 v[108:111], v255, s[36:39], s59 offen offset:3072 sc1
  s_waitcnt vmcnt(14)
  s_waitcnt lgkmcnt(4)
  v_mfma_f32_32x32x16_bf16 v[128:143], v[192:195], v[76:79], v[128:143]
  ds_read_b64_tr_b16 v[208:209], v226 offset:9216
  ds_read_b64_tr_b16 v[210:211], v226 offset:9728
  ds_read_b64_tr_b16 v[212:213], v227 offset:9216
  ds_read_b64_tr_b16 v[214:215], v227 offset:9728
  v_mfma_f32_32x32x16_bf16 v[144:159], v[196:199], v[76:79], v[144:159]
  s_add_u32 s58, s93, 6
  s_and_b32 s58, s58, 7
  s_lshl_b32 s81, s58, 12
  s_add_u32 m0, s81, s57
  s_mul_i32 s58, s58, 114688
  s_add_u32 s58, s58, s56
  buffer_load_dwordx4 v246, s[20:23], s58 offen lds
  s_add_u32 s58, s93, 7
  s_and_b32 s58, s58, 7
  s_lshl_b32 s81, s58, 12
  s_add_u32 m0, s81, s57
  s_mul_i32 s58, s58, 114688
  s_add_u32 s58, s58, s56
  buffer_load_dwordx4 v246, s[20:23], s58 offen lds
  s_add_u32 s59, s59, 4096
  buffer_load_dwordx4 v[112:115], v255, s[36:39], s59 offen offset:0 sc1
  s_waitcnt vmcnt(16)
  s_waitcnt lgkmcnt(4)
  v_mfma_f32_32x32x16_bf16 v[128:143], v[200:203], v[80:83], v[128:143]
  ds_read_b64_tr_b16 v[192:193], v226 offset:12288
  ds_read_b64_tr_b16 v[194:195], v226 offset:12800
  ds_read_b64_tr_b16 v[196:197], v227 offset:12288
  ds_read_b64_tr_b16 v[198:199], v227 offset:12800
  v_mfma_f32_32x32x16_bf16 v[144:159], v[204:207], v[80:83], v[144:159]
  buffer_load_dwordx4 v[116:119], v255, s[36:39], s59 offen offset:1024 sc1
  s_waitcnt vmcnt(16)
  s_waitcnt lgkmcnt(4)
  v_mfma_f32_32x32x16_bf16 v[128:143], v[208:211], v[84:87], v[128:143]
  ds_read_b64_tr_b16 v[200:201], v226 offset:13312
  ds_read_b64_tr_b16 v[202:203], v226 offset:13824
  ds_read_b64_tr_b16 v[204:205], v227 offset:13312
  ds_read_b64_tr_b16 v[206:207], v227 offset:13824
  v_mfma_f32_32x32x16_bf16 v[144:159], v[212:215], v[84:87], v[144:159]
  buffer_load_dwordx4 v[120:123], v255, s[36:39], s59 offen offset:2048 sc1
  s_waitcnt vmcnt(16)
  s_waitcnt lgkmcnt(4)
  v_mfma_f32_32x32x16_bf16 v[128:143], v[192:195], v[88:91], v[128:143]
  ds_read_b64_tr_b16 v[208:209], v226 offset:16384
  ds_read_b64_tr_b16 v[210:211], v226 offset:16896
  ds_read_b64_tr_b16 v[212:213], v227 offset:16384
  ds_read_b64_tr_b16 v[214:215], v227 offset:16896
  v_mfma_f32_32x32x16_bf16 v[144:159], v[196:199], v[88:91], v[144:159]
  buffer_load_dwordx4 v[124:127], v255, s[36:39], s59 offen offset:3072 sc1
  s_waitcnt vmcnt(16)
  s_waitcnt lgkmcnt(4)
  v_mfma_f32_32x32x16_bf16 v[128:143], v[200:203], v[92:95], v[128:143]
  ds_read_b64_tr_b16 v[192:193], v226 offset:17408
  ds_read_b64_tr_b16 v[194:195], v226 offset:17920
  ds_read_b64_tr_b16 v[196:197], v227 offset:17408
  ds_read_b64_tr_b16 v[198:199], v227 offset:17920
  v_mfma_f32_32x32x16_bf16 v[144:159], v[204:207], v[92:95], v[144:159]
  s_waitcnt vmcnt(15)
  s_waitcnt lgkmcnt(4)
  v_mfma_f32_32x32x16_bf16 v[128:143], v[208:211], v[96:99], v[128:143]
  ds_read_b64_tr_b16 v[200:201], v226 offset:20480
  ds_read_b64_tr_b16 v[202:203], v226 offset:20992
  ds_read_b64_tr_b16 v[204:205], v227 offset:20480
  ds_read_b64_tr_b16 v[206:207], v227 offset:20992
  v_mfma_f32_32x32x16_bf16 v[144:159], v[212:215], v[96:99], v[144:159]
  s_waitcnt vmcnt(12)
  s_waitcnt lgkmcnt(4)
  v_mfma_f32_32x32x16_bf16 v[128:143], v[192:195], v[100:103], v[128:143]
  ds_read_b64_tr_b16 v[208:209], v226 offset:21504
  ds_read_b64_tr_b16 v[210:211], v226 offset:22016
  ds_read_b64_tr_b16 v[212:213], v227 offset:21504
  ds_read_b64_tr_b16 v[214:215], v227 offset:22016
  v_mfma_f32_32x32x16_bf16 v[144:159], v[196:199], v[100:103], v[144:159]
  s_waitcnt vmcnt(9)
  s_waitcnt lgkmcnt(4)
  v_mfma_f32_32x32x16_bf16 v[128:143], v[200:203], v[104:107], v[128:143]
  ds_read_b64_tr_b16 v[192:193], v226 offset:24576
  ds_read_b64_tr_b16 v[194:195], v226 offset:25088
  ds_read_b64_tr_b16 v[196:197], v227 offset:24576
  ds_read_b64_tr_b16 v[198:199], v227 offset:25088
  v_mfma_f32_32x32x16_bf16 v[144:159], v[204:207], v[104:107], v[144:159]
  v_mfma_f32_32x32x16_bf16 v[128:143], a[246:249], v[228:231], v[128:143]
  v_mfma_f32_32x32x16_bf16 v[144:159], a[248:251], v[228:231], v[144:159]
  s_waitcnt vmcnt(6)
  s_waitcnt lgkmcnt(4)
  v_mfma_f32_32x32x16_bf16 v[128:143], v[208:211], v[108:111], v[128:143]
  ds_read_b64_tr_b16 v[200:201], v226 offset:25600
  ds_read_b64_tr_b16 v[202:203], v226 offset:26112
  ds_read_b64_tr_b16 v[204:205], v227 offset:25600
  ds_read_b64_tr_b16 v[206:207], v227 offset:26112
  v_mfma_f32_32x32x16_bf16 v[144:159], v[212:215], v[108:111], v[144:159]
  s_waitcnt vmcnt(3)
  s_waitcnt lgkmcnt(4)
  v_mfma_f32_32x32x16_bf16 v[128:143], v[192:195], v[112:115], v[128:143]
  ds_read_b64_tr_b16 v[208:209], v226 offset:28672
  ds_read_b64_tr_b16 v[210:211], v226 offset:29184
  ds_read_b64_tr_b16 v[212:213], v227 offset:28672
  ds_read_b64_tr_b16 v[214:215], v227 offset:29184
  v_mfma_f32_32x32x16_bf16 v[144:159], v[196:199], v[112:115], v[144:159]
  s_waitcnt vmcnt(2)
  s_waitcnt lgkmcnt(4)
  v_mfma_f32_32x32x16_bf16 v[128:143], v[200:203], v[116:119], v[128:143]
  ds_read_b64_tr_b16 v[192:193], v226 offset:29696
  ds_read_b64_tr_b16 v[194:195], v226 offset:30208
  ds_read_b64_tr_b16 v[196:197], v227 offset:29696
  ds_read_b64_tr_b16 v[198:199], v227 offset:30208
  v_mfma_f32_32x32x16_bf16 v[144:159], v[204:207], v[116:119], v[144:159]
  s_waitcnt vmcnt(1)
  s_waitcnt lgkmcnt(4)
  v_mfma_f32_32x32x16_bf16 v[128:143], v[208:211], v[120:123], v[128:143]
  v_mfma_f32_32x32x16_bf16 v[144:159], v[212:215], v[120:123], v[144:159]
  s_waitcnt vmcnt(0)
  s_waitcnt lgkmcnt(0)
  v_mfma_f32_32x32x16_bf16 v[128:143], v[192:195], v[124:127], v[128:143]
  v_mfma_f32_32x32x16_bf16 v[144:159], v[196:199], v[124:127], v[144:159]
  s_waitcnt vmcnt(0)
  s_barrier
  s_lshl_b32 s86, s42, 8
  s_mul_i32 s87, s40, 28672
  s_add_u32 s86, s86, s87
  s_add_u32 s86, s86, 917632
  s_lshl_b32 s87, s40, 10
  s_add_u32 s87, s87, 131072
  ds_read_b64_tr_b16 v[192:193], v224 offset:0
  ds_read_b64_tr_b16 v[194:195], v224 offset:512
  ds_read_b64_tr_b16 v[196:197], v225 offset:0
  ds_read_b64_tr_b16 v[198:199], v225 offset:512
  ds_read_b64_tr_b16 v[200:201], v224 offset:1024
  ds_read_b64_tr_b16 v[202:203], v224 offset:1536
  ds_read_b64_tr_b16 v[204:205], v225 offset:1024
  ds_read_b64_tr_b16 v[206:207], v225 offset:1536
  s_waitcnt lgkmcnt(4)
  v_mfma_f32_32x32x16_bf16 v[160:175], v[192:195], v[0:3], 0
  v_mul_f32 v216, v128, v232
  v_mul_f32 v217, v129, v232
  ds_read_b64_tr_b16 v[208:209], v224 offset:4096
  ds_read_b64_tr_b16 v[210:211], v224 offset:4608
  ds_read_b64_tr_b16 v[212:213], v225 offset:4096
  ds_read_b64_tr_b16 v[214:215], v225 offset:4608
  v_mfma_f32_32x32x16_bf16 v[176:191], v[196:199], v[0:3], 0
  s_add_u32 s88, s93, 0
  s_and_b32 s88, s88, 7
  s_lshl_b32 s81, s88, 12
  s_add_u32 m0, s81, s87
  s_mul_i32 s88, s88, 114688
  s_add_u32 s88, s88, s86
  buffer_load_dwordx4 v246, s[20:23], s88 offen lds
  s_add_u32 s88, s93, 1
  s_and_b32 s88, s88, 7
  s_lshl_b32 s81, s88, 12
  s_add_u32 m0, s81, s87
  s_mul_i32 s88, s88, 114688
  s_add_u32 s88, s88, s86
  buffer_load_dwordx4 v246, s[20:23], s88 offen lds
  s_waitcnt lgkmcnt(4)
  v_mfma_f32_32x32x16_bf16 v[160:175], v[200:203], v[4:7], v[160:175]
  v_mul_f32 v218, v130, v232
  v_mul_f32 v219, v131, v232
  ds_read_b64_tr_b16 v[192:193], v224 offset:5120
  ds_read_b64_tr_b16 v[194:195], v224 offset:5632
  ds_read_b64_tr_b16 v[196:197], v225 offset:5120
  ds_read_b64_tr_b16 v[198:199], v225 offset:5632
  v_mfma_f32_32x32x16_bf16 v[176:191], v[204:207], v[4:7], v[176:191]
  s_add_u32 s88, s93, 2
  s_and_b32 s88, s88, 7
  s_lshl_b32 s81, s88, 12
  s_add_u32 m0, s81, s87
  s_mul_i32 s88, s88, 114688
  s_add_u32 s88, s88, s86
  buffer_load_dwordx4 v246, s[20:23], s88 offen lds
  s_add_u32 s88, s93, 3
  s_and_b32 s88, s88, 7
  s_lshl_b32 s81, s88, 12
  s_add_u32 m0, s81, s87
  s_mul_i32 s88, s88, 114688
  s_add_u32 s88, s88, s86
  buffer_load_dwordx4 v246, s[20:23], s88 offen lds
  s_waitcnt lgkmcnt(4)
  v_mfma_f32_32x32x16_bf16 v[160:175], v[208:211], v[8:11], v[160:175]
  v_exp_f32 v216, -v216
  ds_read_b64_tr_b16 v[200:201], v224 offset:8192
  ds_read_b64_tr_b16 v[202:203], v224 offset:8704
  ds_read_b64_tr_b16 v[204:205], v225 offset:8192
  ds_read_b64_tr_b16 v[206:207], v225 offset:8704
  v_mfma_f32_32x32x16_bf16 v[176:191], v[212:215], v[8:11], v[176:191]
  s_add_u32 s88, s93, 4
  s_and_b32 s88, s88, 7
  s_lshl_b32 s81, s88, 12
  s_add_u32 m0, s81, s87
  s_mul_i32 s88, s88, 114688
  s_add_u32 s88, s88, s86
  buffer_load_dwordx4 v246, s[20:23], s88 offen lds
  s_add_u32 s88, s93, 5
  s_and_b32 s88, s88, 7
  s_lshl_b32 s81, s88, 12
  s_add_u32 m0, s81, s87
  s_mul_i32 s88, s88, 114688
  s_add_u32 s88, s88, s86
  buffer_load_dwordx4 v246, s[20:23], s88 offen lds
  s_waitcnt lgkmcnt(4)
  v_mfma_f32_32x32x16_bf16 v[160:175], v[192:195], v[12:15], v[160:175]
  v_exp_f32 v217, -v217
  ds_read_b64_tr_b16 v[208:209], v224 offset:9216
  ds_read_b64_tr_b16 v[210:211], v224 offset:9728
  ds_read_b64_tr_b16 v[212:213], v225 offset:9216
  ds_read_b64_tr_b16 v[214:215], v225 offset:9728
  v_mfma_f32_32x32x16_bf16 v[176:191], v[196:199], v[12:15], v[176:191]
  s_add_u32 s88, s93, 6
  s_and_b32 s88, s88, 7
  s_lshl_b32 s81, s88, 12
  s_add_u32 m0, s81, s87
  s_mul_i32 s88, s88, 114688
  s_add_u32 s88, s88, s86
  buffer_load_dwordx4 v246, s[20:23], s88 offen lds
  s_add_u32 s88, s93, 7
  s_and_b32 s88, s88, 7
  s_lshl_b32 s81, s88, 12
  s_add_u32 m0, s81, s87
  s_mul_i32 s88, s88, 114688
  s_add_u32 s88, s88, s86
  buffer_load_dwordx4 v246, s[20:23], s88 offen lds
  s_waitcnt lgkmcnt(4)
  v_mfma_f32_32x32x16_bf16 v[160:175], v[200:203], v[16:19], v[160:175]
  v_exp_f32 v218, -v218
  ds_read_b64_tr_b16 v[192:193], v224 offset:12288
  ds_read_b64_tr_b16 v[194:195], v224 offset:12800
  ds_read_b64_tr_b16 v[196:197], v225 offset:12288
  ds_read_b64_tr_b16 v[198:199], v225 offset:12800
  v_mfma_f32_32x32x16_bf16 v[176:191], v[204:207], v[16:19], v[176:191]
  v_exp_f32 v219, -v219
  v_mul_f32 v128, v128, v233
  v_mul_f32 v129, v129, v233
  v_mul_f32 v130, v130, v233
  v_mul_f32 v131, v131, v233
  s_waitcnt lgkmcnt(4)
  v_mfma_f32_32x32x16_bf16 v[160:175], v[208:211], v[20:23], v[160:175]
  v_add_f32 v216, 1.0, v216
  v_add_f32 v217, 1.0, v217
  ds_read_b64_tr_b16 v[200:201], v224 offset:13312
  ds_read_b64_tr_b16 v[202:203], v224 offset:13824
  ds_read_b64_tr_b16 v[204:205], v225 offset:13312
  ds_read_b64_tr_b16 v[206:207], v225 offset:13824
  v_mfma_f32_32x32x16_bf16 v[176:191], v[212:215], v[20:23], v[176:191]
  v_add_f32 v218, 1.0, v218
  v_add_f32 v219, 1.0, v219
  v_rcp_f32 v216, v216
  v_rcp_f32 v217, v217
  s_waitcnt lgkmcnt(4)
  v_mfma_f32_32x32x16_bf16 v[160:175], v[192:195], v[24:27], v[160:175]
  v_rcp_f32 v218, v218
  ds_read_b64_tr_b16 v[208:209], v224 offset:16384
  ds_read_b64_tr_b16 v[210:211], v224 offset:16896
  ds_read_b64_tr_b16 v[212:213], v225 offset:16384
  ds_read_b64_tr_b16 v[214:215], v225 offset:16896
  v_mfma_f32_32x32x16_bf16 v[176:191], v[196:199], v[24:27], v[176:191]
  v_rcp_f32 v219, v219
  v_mul_f32 v128, v128, v216
  v_mul_f32 v129, v129, v217
  v_mul_f32 v130, v130, v218
  v_mul_f32 v131, v131, v219
  s_waitcnt lgkmcnt(4)
  v_mfma_f32_32x32x16_bf16 v[160:175], v[200:203], v[28:31], v[160:175]
  v_cvt_pk_bf16_f32 v128, v128, v129
  v_cvt_pk_bf16_f32 v129, v130, v131
  ds_read_b64_tr_b16 v[192:193], v224 offset:17408
  ds_read_b64_tr_b16 v[194:195], v224 offset:17920
  ds_read_b64_tr_b16 v[196:197], v225 offset:17408
  ds_read_b64_tr_b16 v[198:199], v225 offset:17920
  v_mfma_f32_32x32x16_bf16 v[176:191], v[204:207], v[28:31], v[176:191]
  v_mul_f32 v216, v132, v232
  v_mul_f32 v217, v133, v232
  v_mul_f32 v218, v134, v232
  v_mul_f32 v219, v135, v232
  v_exp_f32 v216, -v216
  s_waitcnt lgkmcnt(4)
  v_mfma_f32_32x32x16_bf16 v[160:175], v[208:211], v[32:35], v[160:175]
  v_exp_f32 v217, -v217
  ds_read_b64_tr_b16 v[200:201], v224 offset:20480
  ds_read_b64_tr_b16 v[202:203], v224 offset:20992
  ds_read_b64_tr_b16 v[204:205], v225 offset:20480
  ds_read_b64_tr_b16 v[206:207], v225 offset:20992
  v_mfma_f32_32x32x16_bf16 v[176:191], v[212:215], v[32:35], v[176:191]
  v_exp_f32 v218, -v218
  v_exp_f32 v219, -v219
  v_mul_f32 v132, v132, v233
  v_mul_f32 v133, v133, v233
  s_waitcnt lgkmcnt(4)
  v_mfma_f32_32x32x16_bf16 v[160:175], v[192:195], v[36:39], v[160:175]
  v_mul_f32 v134, v134, v233
  v_mul_f32 v135, v135, v233
  ds_read_b64_tr_b16 v[208:209], v224 offset:21504
  ds_read_b64_tr_b16 v[210:211], v224 offset:22016
  ds_read_b64_tr_b16 v[212:213], v225 offset:21504
  ds_read_b64_tr_b16 v[214:215], v225 offset:22016
  v_mfma_f32_32x32x16_bf16 v[176:191], v[196:199], v[36:39], v[176:191]
  v_add_f32 v216, 1.0, v216
  v_add_f32 v217, 1.0, v217
  v_add_f32 v218, 1.0, v218
  v_add_f32 v219, 1.0, v219
  v_rcp_f32 v216, v216
  s_waitcnt lgkmcnt(4)
  v_mfma_f32_32x32x16_bf16 v[160:175], v[200:203], v[40:43], v[160:175]
  v_rcp_f32 v217, v217
  ds_read_b64_tr_b16 v[192:193], v224 offset:24576
  ds_read_b64_tr_b16 v[194:195], v224 offset:25088
  ds_read_b64_tr_b16 v[196:197], v225 offset:24576
  ds_read_b64_tr_b16 v[198:199], v225 offset:25088
  v_mfma_f32_32x32x16_bf16 v[176:191], v[204:207], v[40:43], v[176:191]
  v_rcp_f32 v218, v218
  v_rcp_f32 v219, v219
  v_mul_f32 v132, v132, v216
  v_mul_f32 v133, v133, v217
  s_waitcnt lgkmcnt(4)
  v_mfma_f32_32x32x16_bf16 v[160:175], v[208:211], v[44:47], v[160:175]
  v_mul_f32 v134, v134, v218
  v_mul_f32 v135, v135, v219
  ds_read_b64_tr_b16 v[200:201], v224 offset:25600
  ds_read_b64_tr_b16 v[202:203], v224 offset:26112
  ds_read_b64_tr_b16 v[204:205], v225 offset:25600
  ds_read_b64_tr_b16 v[206:207], v225 offset:26112
  v_mfma_f32_32x32x16_bf16 v[176:191], v[212:215], v[44:47], v[176:191]
  v_cvt_pk_bf16_f32 v130, v132, v133
  v_cvt_pk_bf16_f32 v131, v134, v135
  v_mul_f32 v216, v136, v232
  v_mul_f32 v217, v137, v232
  v_mul_f32 v218, v138, v232
  v_mul_f32 v219, v139, v232
  s_waitcnt lgkmcnt(4)
  v_mfma_f32_32x32x16_bf16 v[160:175], v[192:195], v[48:51], v[160:175]
  v_exp_f32 v216, -v216
  ds_read_b64_tr_b16 v[208:209], v224 offset:28672
  ds_read_b64_tr_b16 v[210:211], v224 offset:29184
  ds_read_b64_tr_b16 v[212:213], v225 offset:28672
  ds_read_b64_tr_b16 v[214:215], v225 offset:29184
  v_mfma_f32_32x32x16_bf16 v[176:191], v[196:199], v[48:51], v[176:191]
  v_exp_f32 v217, -v217
  v_exp_f32 v218, -v218
  v_exp_f32 v219, -v219
  s_waitcnt lgkmcnt(4)
  v_mfma_f32_32x32x16_bf16 v[160:175], v[200:203], v[52:55], v[160:175]
  v_mul_f32 v136, v136, v233
  v_mul_f32 v137, v137, v233
  ds_read_b64_tr_b16 v[192:193], v224 offset:29696
  ds_read_b64_tr_b16 v[194:195], v224 offset:30208
  ds_read_b64_tr_b16 v[196:197], v225 offset:29696
  ds_read_b64_tr_b16 v[198:199], v225 offset:30208
  v_mfma_f32_32x32x16_bf16 v[176:191], v[204:207], v[52:55], v[176:191]
  v_mul_f32 v138, v138, v233
  v_mul_f32 v139, v139, v233
  v_add_f32 v216, 1.0, v216
  v_add_f32 v217, 1.0, v217
  v_add_f32 v218, 1.0, v218
  v_add_f32 v219, 1.0, v219
  s_waitcnt lgkmcnt(4)
  v_mfma_f32_32x32x16_bf16 v[160:175], v[208:211], v[56:59], v[160:175]
  v_rcp_f32 v216, v216
  v_rcp_f32 v217, v217
  v_rcp_f32 v218, v218
  v_mfma_f32_32x32x16_bf16 v[176:191], v[212:215], v[56:59], v[176:191]
  v_rcp_f32 v219, v219
  v_mul_f32 v136, v136, v216
  v_mul_f32 v137, v137, v217
  v_mul_f32 v138, v138, v218
  v_mul_f32 v139, v139, v219
  s_waitcnt lgkmcnt(0)
  v_mfma_f32_32x32x16_bf16 v[160:175], v[192:195], v[60:63], v[160:175]
  v_cvt_pk_bf16_f32 v132, v136, v137
  v_cvt_pk_bf16_f32 v133, v138, v139
  v_mul_f32 v216, v140, v232
  v_mul_f32 v217, v141, v232
  v_mul_f32 v218, v142, v232
  v_mul_f32 v219, v143, v232
  v_mfma_f32_32x32x16_bf16 v[176:191], v[196:199], v[60:63], v[176:191]
  s_waitcnt vmcnt(0)
  s_barrier
  ds_read_b64_tr_b16 v[192:193], v226 offset:0
  ds_read_b64_tr_b16 v[194:195], v226 offset:512
  ds_read_b64_tr_b16 v[196:197], v227 offset:0
  ds_read_b64_tr_b16 v[198:199], v227 offset:512
  ds_read_b64_tr_b16 v[200:201], v226 offset:1024
  ds_read_b64_tr_b16 v[202:203], v226 offset:1536
  ds_read_b64_tr_b16 v[204:205], v227 offset:1024
  ds_read_b64_tr_b16 v[206:207], v227 offset:1536
  s_waitcnt lgkmcnt(4)
  v_mfma_f32_32x32x16_bf16 v[160:175], v[192:195], v[64:67], v[160:175]
  v_exp_f32 v216, -v216
  ds_read_b64_tr_b16 v[208:209], v226 offset:4096
  ds_read_b64_tr_b16 v[210:211], v226 offset:4608
  ds_read_b64_tr_b16 v[212:213], v227 offset:4096
  ds_read_b64_tr_b16 v[214:215], v227 offset:4608
  v_mfma_f32_32x32x16_bf16 v[176:191], v[196:199], v[64:67], v[176:191]
  v_exp_f32 v217, -v217
  v_exp_f32 v218, -v218
  v_exp_f32 v219, -v219
  s_waitcnt lgkmcnt(4)
  v_mfma_f32_32x32x16_bf16 v[160:175], v[200:203], v[68:71], v[160:175]
  v_mul_f32 v140, v140, v233
  v_mul_f32 v141, v141, v233
  ds_read_b64_tr_b16 v[192:193], v226 offset:5120
  ds_read_b64_tr_b16 v[194:195], v226 offset:5632
  ds_read_b64_tr_b16 v[196:197], v227 offset:5120
  ds_read_b64_tr_b16 v[198:199], v227 offset:5632
  v_mfma_f32_32x32x16_bf16 v[176:191], v[204:207], v[68:71], v[176:191]
  v_mul_f32 v142, v142, v233
  v_mul_f32 v143, v143, v233
  v_add_f32 v216, 1.0, v216
  v_add_f32 v217, 1.0, v217
  v_add_f32 v218, 1.0, v218
  v_add_f32 v219, 1.0, v219
  s_waitcnt lgkmcnt(4)
  v_mfma_f32_32x32x16_bf16 v[160:175], v[208:211], v[72:75], v[160:175]
  v_rcp_f32 v216, v216
  ds_read_b64_tr_b16 v[200:201], v226 offset:8192
  ds_read_b64_tr_b16 v[202:203], v226 offset:8704
  ds_read_b64_tr_b16 v[204:205], v227 offset:8192
  ds_read_b64_tr_b16 v[206:207], v227 offset:8704
  v_mfma_f32_32x32x16_bf16 v[176:191], v[212:215], v[72:75], v[176:191]
  v_rcp_f32 v217, v217
  v_rcp_f32 v218, v218
  v_rcp_f32 v219, v219
  s_waitcnt lgkmcnt(4)
  v_mfma_f32_32x32x16_bf16 v[160:175], v[192:195], v[76:79], v[160:175]
  v_mul_f32 v140, v140, v216
  v_mul_f32 v141, v141, v217
  ds_read_b64_tr_b16 v[208:209], v226 offset:9216
  ds_read_b64_tr_b16 v[210:211], v226 offset:9728
  ds_read_b64_tr_b16 v[212:213], v227 offset:9216
  ds_read_b64_tr_b16 v[214:215], v227 offset:9728
  v_mfma_f32_32x32x16_bf16 v[176:191], v[196:199], v[76:79], v[176:191]
  v_mul_f32 v142, v142, v218
  v_mul_f32 v143, v143, v219
  v_cvt_pk_bf16_f32 v134, v140, v141
  v_cvt_pk_bf16_f32 v135, v142, v143
  s_add_u32 s56, s55, 0
  s_waitcnt lgkmcnt(4)
  v_mfma_f32_32x32x16_bf16 v[160:175], v[200:203], v[80:83], v[160:175]
  s_cmp_eq_u32 s46, 0
  s_cbranch_scc1 L_st_42
  buffer_store_dwordx4 v[128:131], v255, s[36:39], s56 offen offset:0
  buffer_store_dwordx4 v[132:135], v255, s[36:39], s56 offen offset:1024
  s_branch L_st_42_e
L_st_42:
  buffer_store_dwordx4 v[128:131], v255, s[36:39], s56 offen offset:0 sc0 sc1
  buffer_store_dwordx4 v[132:135], v255, s[36:39], s56 offen offset:1024 sc0 sc1
L_st_42_e:
  ds_read_b64_tr_b16 v[192:193], v226 offset:12288
  ds_read_b64_tr_b16 v[194:195], v226 offset:12800
  ds_read_b64_tr_b16 v[196:197], v227 offset:12288
  ds_read_b64_tr_b16 v[198:199], v227 offset:12800
  v_mfma_f32_32x32x16_bf16 v[176:191], v[204:207], v[80:83], v[176:191]
  v_mul_f32 v216, v144, v232
  v_mul_f32 v217, v145, v232
  v_mul_f32 v218, v146, v232
  v_mul_f32 v219, v147, v232
  v_exp_f32 v216, -v216
  s_waitcnt lgkmcnt(4)
  v_mfma_f32_32x32x16_bf16 v[160:175], v[208:211], v[84:87], v[160:175]
  v_exp_f32 v217, -v217
  ds_read_b64_tr_b16 v[200:201], v226 offset:13312
  ds_read_b64_tr_b16 v[202:203], v226 offset:13824
  ds_read_b64_tr_b16 v[204:205], v227 offset:13312
  ds_read_b64_tr_b16 v[206:207], v227 offset:13824
  v_mfma_f32_32x32x16_bf16 v[176:191], v[212:215], v[84:87], v[176:191]
  v_exp_f32 v218, -v218
  v_exp_f32 v219, -v219
  v_mul_f32 v144, v144, v233
  v_mul_f32 v145, v145, v233
  s_waitcnt lgkmcnt(4)
  v_mfma_f32_32x32x16_bf16 v[160:175], v[192:195], v[88:91], v[160:175]
  v_mul_f32 v146, v146, v233
  v_mul_f32 v147, v147, v233
  ds_read_b64_tr_b16 v[208:209], v226 offset:16384
  ds_read_b64_tr_b16 v[210:211], v226 offset:16896
  ds_read_b64_tr_b16 v[212:213], v227 offset:16384
  ds_read_b64_tr_b16 v[214:215], v227 offset:16896
  v_mfma_f32_32x32x16_bf16 v[176:191], v[196:199], v[88:91], v[176:191]
  v_add_f32 v216, 1.0, v216
  v_add_f32 v217, 1.0, v217
  v_add_f32 v218, 1.0, v218
  v_add_f32 v219, 1.0, v219
  v_rcp_f32 v216, v216
  s_waitcnt lgkmcnt(4)
  v_mfma_f32_32x32x16_bf16 v[160:175], v[200:203], v[92:95], v[160:175]
  v_rcp_f32 v217, v217
  ds_read_b64_tr_b16 v[192:193], v226 offset:17408
  ds_read_b64_tr_b16 v[194:195], v226 offset:17920
  ds_read_b64_tr_b16 v[196:197], v227 offset:17408
  ds_read_b64_tr_b16 v[198:199], v227 offset:17920
  v_mfma_f32_32x32x16_bf16 v[176:191], v[204:207], v[92:95], v[176:191]
  v_rcp_f32 v218, v218
  v_rcp_f32 v219, v219
  v_mul_f32 v144, v144, v216
  v_mul_f32 v145, v145, v217
  s_waitcnt lgkmcnt(4)
  v_mfma_f32_32x32x16_bf16 v[160:175], v[208:211], v[96:99], v[160:175]
  v_mul_f32 v146, v146, v218
  v_mul_f32 v147, v147, v219
  ds_read_b64_tr_b16 v[200:201], v226 offset:20480
  ds_read_b64_tr_b16 v[202:203], v226 offset:20992
  ds_read_b64_tr_b16 v[204:205], v227 offset:20480
  ds_read_b64_tr_b16 v[206:207], v227 offset:20992
  v_mfma_f32_32x32x16_bf16 v[176:191], v[212:215], v[96:99], v[176:191]
  v_cvt_pk_bf16_f32 v144, v144, v145
  v_cvt_pk_bf16_f32 v145, v146, v147
  v_mul_f32 v216, v148, v232
  v_mul_f32 v217, v149, v232
  v_mul_f32 v218, v150, v232
  v_mul_f32 v219, v151, v232
  s_waitcnt lgkmcnt(4)
  v_mfma_f32_32x32x16_bf16 v[160:175], v[192:195], v[100:103], v[160:175]
  v_exp_f32 v216, -v216
  ds_read_b64_tr_b16 v[208:209], v226 offset:21504
  ds_read_b64_tr_b16 v[210:211], v226 offset:22016
  ds_read_b64_tr_b16 v[212:213], v227 offset:21504
  ds_read_b64_tr_b16 v[214:215], v227 offset:22016
  v_mfma_f32_32x32x16_bf16 v[176:191], v[196:199], v[100:103], v[176:191]
  v_exp_f32 v217, -v217
  v_exp_f32 v218, -v218
  v_exp_f32 v219, -v219
  s_waitcnt lgkmcnt(4)
  v_mfma_f32_32x32x16_bf16 v[160:175], v[200:203], v[104:107], v[160:175]
  v_mul_f32 v148, v148, v233
  v_mul_f32 v149, v149, v233
  ds_read_b64_tr_b16 v[192:193], v226 offset:24576
  ds_read_b64_tr_b16 v[194:195], v226 offset:25088
  ds_read_b64_tr_b16 v[196:197], v227 offset:24576
  ds_read_b64_tr_b16 v[198:199], v227 offset:25088
  v_mfma_f32_32x32x16_bf16 v[176:191], v[204:207], v[104:107], v[176:191]
  v_mul_f32 v150, v150, v233
  v_mul_f32 v151, v151, v233
  v_add_f32 v216, 1.0, v216
  v_add_f32 v217, 1.0, v217
  v_add_f32 v218, 1.0, v218
  v_add_f32 v219, 1.0, v219
  v_mfma_f32_32x32x16_bf16 v[160:175], a[250:253], v[228:231], v[160:175]
  v_rcp_f32 v216, v216
  v_rcp_f32 v217, v217
  v_rcp_f32 v218, v218
  v_mfma_f32_32x32x16_bf16 v[176:191], a[252:255], v[228:231], v[176:191]
  v_rcp_f32 v219, v219
  v_mul_f32 v148, v148, v216
  v_mul_f32 v149, v149, v217
  v_mul_f32 v150, v150, v218
  v_mul_f32 v151, v151, v219
  s_waitcnt lgkmcnt(4)
  v_mfma_f32_32x32x16_bf16 v[160:175], v[208:211], v[108:111], v[160:175]
  v_cvt_pk_bf16_f32 v146, v148, v149
  v_cvt_pk_bf16_f32 v147, v150, v151
  ds_read_b64_tr_b16 v[200:201], v226 offset:25600
  ds_read_b64_tr_b16 v[202:203], v226 offset:26112
  ds_read_b64_tr_b16 v[204:205], v227 offset:25600
  ds_read_b64_tr_b16 v[206:207], v227 offset:26112
  v_mfma_f32_32x32x16_bf16 v[176:191], v[212:215], v[108:111], v[176:191]
  v_mul_f32 v216, v152, v232
  v_mul_f32 v217, v153, v232
  v_mul_f32 v218, v154, v232
  v_mul_f32 v219, v155, v232
  v_exp_f32 v216, -v216
  s_waitcnt lgkmcnt(4)
  v_mfma_f32_32x32x16_bf16 v[160:175], v[192:195], v[112:115], v[160:175]
  v_exp_f32 v217, -v217
  ds_read_b64_tr_b16 v[208:209], v226 offset:28672
  ds_read_b64_tr_b16 v[210:211], v226 offset:29184
  ds_read_b64_tr_b16 v[212:213], v227 offset:28672
  ds_read_b64_tr_b16 v[214:215], v227 offset:29184
  v_mfma_f32_32x32x16_bf16 v[176:191], v[196:199], v[112:115], v[176:191]
  v_exp_f32 v218, -v218
  v_exp_f32 v219, -v219
  v_mul_f32 v152, v152, v233
  v_mul_f32 v153, v153, v233
  s_waitcnt lgkmcnt(4)
  v_mfma_f32_32x32x16_bf16 v[160:175], v[200:203], v[116:119], v[160:175]
  v_mul_f32 v154, v154, v233
  v_mul_f32 v155, v155, v233
  ds_read_b64_tr_b16 v[192:193], v226 offset:29696
  ds_read_b64_tr_b16 v[194:195], v226 offset:30208
  ds_read_b64_tr_b16 v[196:197], v227 offset:29696
  ds_read_b64_tr_b16 v[198:199], v227 offset:30208
  v_mfma_f32_32x32x16_bf16 v[176:191], v[204:207], v[116:119], v[176:191]
  v_add_f32 v216, 1.0, v216
  v_add_f32 v217, 1.0, v217
  v_add_f32 v218, 1.0, v218
  v_add_f32 v219, 1.0, v219
  v_rcp_f32 v216, v216
  s_waitcnt lgkmcnt(4)
  v_mfma_f32_32x32x16_bf16 v[160:175], v[208:211], v[120:123], v[160:175]
  v_rcp_f32 v217, v217
  v_rcp_f32 v218, v218
  v_rcp_f32 v219, v219
  v_mfma_f32_32x32x16_bf16 v[176:191], v[212:215], v[120:123], v[176:191]
  v_mul_f32 v152, v152, v216
  v_mul_f32 v153, v153, v217
  v_mul_f32 v154, v154, v218
  v_mul_f32 v155, v155, v219
  v_cvt_pk_bf16_f32 v148, v152, v153
  v_cvt_pk_bf16_f32 v149, v154, v155
  s_waitcnt lgkmcnt(0)
  v_mfma_f32_32x32x16_bf16 v[160:175], v[192:195], v[124:127], v[160:175]
  v_mul_f32 v216, v156, v232
  v_mul_f32 v217, v157, v232
  v_mul_f32 v218, v158, v232
  v_mul_f32 v219, v159, v232
  v_exp_f32 v216, -v216
  v_mfma_f32_32x32x16_bf16 v[176:191], v[196:199], v[124:127], v[176:191]
  v_exp_f32 v217, -v217
  v_exp_f32 v218, -v218
  v_exp_f32 v219, -v219
  v_mul_f32 v156, v156, v233
  v_mul_f32 v157, v157, v233
  v_mul_f32 v158, v158, v233
  v_mul_f32 v159, v159, v233
  v_add_f32 v216, 1.0, v216
  v_add_f32 v217, 1.0, v217
  v_add_f32 v218, 1.0, v218
  v_add_f32 v219, 1.0, v219
  v_rcp_f32 v216, v216
  v_rcp_f32 v217, v217
  v_rcp_f32 v218, v218
  v_rcp_f32 v219, v219
  v_mul_f32 v156, v156, v216
  v_mul_f32 v157, v157, v217
  v_mul_f32 v158, v158, v218
  v_mul_f32 v159, v159, v219
  v_cvt_pk_bf16_f32 v150, v156, v157
  v_cvt_pk_bf16_f32 v151, v158, v159
  s_add_u32 s56, s55, 2048
  s_cmp_eq_u32 s46, 0
  s_cbranch_scc1 L_st_43
  buffer_store_dwordx4 v[144:147], v255, s[36:39], s56 offen offset:0
  buffer_store_dwordx4 v[148:151], v255, s[36:39], s56 offen offset:1024
  s_branch L_st_43_e
L_st_43:
  buffer_store_dwordx4 v[144:147], v255, s[36:39], s56 offen offset:0 sc0 sc1
  buffer_store_dwordx4 v[148:151], v255, s[36:39], s56 offen offset:1024 sc0 sc1
L_st_43_e:
  v_mov_b32 v220, v233
  v_mov_b32 v222, 1.0
  v_mov_b32 v223, 1.0
  v_pk_mul_f32 v[216:217], v[160:161], v[232:233] op_sel_hi:[1,0]
  v_pk_mul_f32 v[218:219], v[162:163], v[232:233] op_sel_hi:[1,0]
  v_exp_f32 v216, -v216
  v_exp_f32 v217, -v217
  v_exp_f32 v218, -v218
  v_exp_f32 v219, -v219
  v_pk_mul_f32 v[160:161], v[160:161], v[220:221] op_sel_hi:[1,0]
  v_pk_mul_f32 v[162:163], v[162:163], v[220:221] op_sel_hi:[1,0]
  v_pk_add_f32 v[216:217], v[216:217], v[222:223]
  v_pk_add_f32 v[218:219], v[218:219], v[222:223]
  v_rcp_f32 v216, v216
  v_rcp_f32 v217, v217
  v_rcp_f32 v218, v218
  v_rcp_f32 v219, v219
  v_pk_mul_f32 v[160:161], v[160:161], v[216:217]
  v_pk_mul_f32 v[162:163], v[162:163], v[218:219]
  v_cvt_pk_bf16_f32 v160, v160, v161
  v_cvt_pk_bf16_f32 v161, v162, v163
  v_pk_mul_f32 v[216:217], v[164:165], v[232:233] op_sel_hi:[1,0]
  v_pk_mul_f32 v[218:219], v[166:167], v[232:233] op_sel_hi:[1,0]
  v_exp_f32 v216, -v216
  v_exp_f32 v217, -v217
  v_exp_f32 v218, -v218
  v_exp_f32 v219, -v219
  v_pk_mul_f32 v[164:165], v[164:165], v[220:221] op_sel_hi:[1,0]
  v_pk_mul_f32 v[166:167], v[166:167], v[220:221] op_sel_hi:[1,0]
  v_pk_add_f32 v[216:217], v[216:217], v[222:223]
  v_pk_add_f32 v[218:219], v[218:219], v[222:223]
  v_rcp_f32 v216, v216
  v_rcp_f32 v217, v217
  v_rcp_f32 v218, v218
  v_rcp_f32 v219, v219
  v_pk_mul_f32 v[164:165], v[164:165], v[216:217]
  v_pk_mul_f32 v[166:167], v[166:167], v[218:219]
  v_cvt_pk_bf16_f32 v162, v164, v165
  v_cvt_pk_bf16_f32 v163, v166, v167
  v_pk_mul_f32 v[216:217], v[168:169], v[232:233] op_sel_hi:[1,0]
  v_pk_mul_f32 v[218:219], v[170:171], v[232:233] op_sel_hi:[1,0]
  v_exp_f32 v216, -v216
  v_exp_f32 v217, -v217
  v_exp_f32 v218, -v218
  v_exp_f32 v219, -v219
  v_pk_mul_f32 v[168:169], v[168:169], v[220:221] op_sel_hi:[1,0]
  v_pk_mul_f32 v[170:171], v[170:171], v[220:221] op_sel_hi:[1,0]
  v_pk_add_f32 v[216:217], v[216:217], v[222:223]
  v_pk_add_f32 v[218:219], v[218:219], v[222:223]
  v_rcp_f32 v216, v216
  v_rcp_f32 v217, v217
  v_rcp_f32 v218, v218
  v_rcp_f32 v219, v219
  v_pk_mul_f32 v[168:169], v[168:169], v[216:217]
  v_pk_mul_f32 v[170:171], v[170:171], v[218:219]
  v_cvt_pk_bf16_f32 v164, v168, v169
  v_cvt_pk_bf16_f32 v165, v170, v171
  v_pk_mul_f32 v[216:217], v[172:173], v[232:233] op_sel_hi:[1,0]
  v_pk_mul_f32 v[218:219], v[174:175], v[232:233] op_sel_hi:[1,0]
  v_exp_f32 v216, -v216
  v_exp_f32 v217, -v217
  v_exp_f32 v218, -v218
  v_exp_f32 v219, -v219
  v_pk_mul_f32 v[172:173], v[172:173], v[220:221] op_sel_hi:[1,0]
  v_pk_mul_f32 v[174:175], v[174:175], v[220:221] op_sel_hi:[1,0]
  v_pk_add_f32 v[216:217], v[216:217], v[222:223]
  v_pk_add_f32 v[218:219], v[218:219], v[222:223]
  v_rcp_f32 v216, v216
  v_rcp_f32 v217, v217
  v_rcp_f32 v218, v218
  v_rcp_f32 v219, v219
  v_pk_mul_f32 v[172:173], v[172:173], v[216:217]
  v_pk_mul_f32 v[174:175], v[174:175], v[218:219]
  v_cvt_pk_bf16_f32 v166, v172, v173
  v_cvt_pk_bf16_f32 v167, v174, v175
  s_add_u32 s56, s55, 4096
  s_cmp_eq_u32 s46, 0
  s_cbranch_scc1 L_st_44
  buffer_store_dwordx4 v[160:163], v255, s[36:39], s56 offen offset:0
  buffer_store_dwordx4 v[164:167], v255, s[36:39], s56 offen offset:1024
  s_branch L_st_44_e
L_st_44:
  buffer_store_dwordx4 v[160:163], v255, s[36:39], s56 offen offset:0 sc0 sc1
  buffer_store_dwordx4 v[164:167], v255, s[36:39], s56 offen offset:1024 sc0 sc1
L_st_44_e:
  v_pk_mul_f32 v[216:217], v[176:177], v[232:233] op_sel_hi:[1,0]
  v_pk_mul_f32 v[218:219], v[178:179], v[232:233] op_sel_hi:[1,0]
  v_exp_f32 v216, -v216
  v_exp_f32 v217, -v217
  v_exp_f32 v218, -v218
  v_exp_f32 v219, -v219
  v_pk_mul_f32 v[176:177], v[176:177], v[220:221] op_sel_hi:[1,0]
  v_pk_mul_f32 v[178:179], v[178:179], v[220:221] op_sel_hi:[1,0]
  v_pk_add_f32 v[216:217], v[216:217], v[222:223]
  v_pk_add_f32 v[218:219], v[218:219], v[222:223]
  v_rcp_f32 v216, v216
  v_rcp_f32 v217, v217
  v_rcp_f32 v218, v218
  v_rcp_f32 v219, v219
  v_pk_mul_f32 v[176:177], v[176:177], v[216:217]
  v_pk_mul_f32 v[178:179], v[178:179], v[218:219]
  v_cvt_pk_bf16_f32 v176, v176, v177
  v_cvt_pk_bf16_f32 v177, v178, v179
  v_pk_mul_f32 v[216:217], v[180:181], v[232:233] op_sel_hi:[1,0]
  v_pk_mul_f32 v[218:219], v[182:183], v[232:233] op_sel_hi:[1,0]
  v_exp_f32 v216, -v216
  v_exp_f32 v217, -v217
  v_exp_f32 v218, -v218
  v_exp_f32 v219, -v219
  v_pk_mul_f32 v[180:181], v[180:181], v[220:221] op_sel_hi:[1,0]
  v_pk_mul_f32 v[182:183], v[182:183], v[220:221] op_sel_hi:[1,0]
  v_pk_add_f32 v[216:217], v[216:217], v[222:223]
  v_pk_add_f32 v[218:219], v[218:219], v[222:223]
  v_rcp_f32 v216, v216
  v_rcp_f32 v217, v217
  v_rcp_f32 v218, v218
  v_rcp_f32 v219, v219
  v_pk_mul_f32 v[180:181], v[180:181], v[216:217]
  v_pk_mul_f32 v[182:183], v[182:183], v[218:219]
  v_cvt_pk_bf16_f32 v178, v180, v181
  v_cvt_pk_bf16_f32 v179, v182, v183
  v_pk_mul_f32 v[216:217], v[184:185], v[232:233] op_sel_hi:[1,0]
  v_pk_mul_f32 v[218:219], v[186:187], v[232:233] op_sel_hi:[1,0]
  v_exp_f32 v216, -v216
  v_exp_f32 v217, -v217
  v_exp_f32 v218, -v218
  v_exp_f32 v219, -v219
  v_pk_mul_f32 v[184:185], v[184:185], v[220:221] op_sel_hi:[1,0]
  v_pk_mul_f32 v[186:187], v[186:187], v[220:221] op_sel_hi:[1,0]
  v_pk_add_f32 v[216:217], v[216:217], v[222:223]
  v_pk_add_f32 v[218:219], v[218:219], v[222:223]
  v_rcp_f32 v216, v216
  v_rcp_f32 v217, v217
  v_rcp_f32 v218, v218
  v_rcp_f32 v219, v219
  v_pk_mul_f32 v[184:185], v[184:185], v[216:217]
  v_pk_mul_f32 v[186:187], v[186:187], v[218:219]
  v_cvt_pk_bf16_f32 v180, v184, v185
  v_cvt_pk_bf16_f32 v181, v186, v187
  v_pk_mul_f32 v[216:217], v[188:189], v[232:233] op_sel_hi:[1,0]
  v_pk_mul_f32 v[218:219], v[190:191], v[232:233] op_sel_hi:[1,0]
  v_exp_f32 v216, -v216
  v_exp_f32 v217, -v217
  v_exp_f32 v218, -v218
  v_exp_f32 v219, -v219
  v_pk_mul_f32 v[188:189], v[188:189], v[220:221] op_sel_hi:[1,0]
  v_pk_mul_f32 v[190:191], v[190:191], v[220:221] op_sel_hi:[1,0]
  v_pk_add_f32 v[216:217], v[216:217], v[222:223]
  v_pk_add_f32 v[218:219], v[218:219], v[222:223]
  v_rcp_f32 v216, v216
  v_rcp_f32 v217, v217
  v_rcp_f32 v218, v218
  v_rcp_f32 v219, v219
  v_pk_mul_f32 v[188:189], v[188:189], v[216:217]
  v_pk_mul_f32 v[190:191], v[190:191], v[218:219]
  v_cvt_pk_bf16_f32 v182, v188, v189
  v_cvt_pk_bf16_f32 v183, v190, v191
  s_add_u32 s56, s55, 6144
  s_cmp_eq_u32 s46, 0
  s_cbranch_scc1 L_st_45
  buffer_store_dwordx4 v[176:179], v255, s[36:39], s56 offen offset:0
  buffer_store_dwordx4 v[180:183], v255, s[36:39], s56 offen offset:1024
  s_branch L_st_45_e
L_st_45:
  buffer_store_dwordx4 v[176:179], v255, s[36:39], s56 offen offset:0 sc0 sc1
  buffer_store_dwordx4 v[180:183], v255, s[36:39], s56 offen offset:1024 sc0 sc1
L_st_45_e:
  s_lshl_b32 s75, s42, 2
  s_add_u32 s75, s75, s40
  s_lshl_b32 s75, s75, 3
  s_lshl_b32 s74, s41, 9
  s_add_u32 s75, s75, s74
  s_add_u32 s75, s75, 0
  s_waitcnt vmcnt(0)
  s_or_b32 s70, s44, 7
  v_mov_b32 v236, s70
  v_mov_b32 v237, s45
  v_mov_b32 v238, 0
  s_mov_b64 exec, 1
  s_cmp_eq_u32 s46, 0
  s_cbranch_scc1 L_fs_46
  buffer_store_dwordx2 v[236:237], v238, s[36:39], s75 offen
  s_branch L_fs_46_e
L_fs_46:
  buffer_store_dwordx2 v[236:237], v238, s[36:39], s75 offen sc0 sc1
L_fs_46_e:
  s_mov_b64 exec, -1
L_p3skip1:
  s_barrier
  s_lshr_b32 s60, s42, 3
  s_lshl_b32 s60, s60, 1
  s_lshr_b32 s74, s40, 1
  s_add_u32 s61, s60, s74
  s_xor_b32 s62, s61, 1
  s_and_b32 s63, s42, 7
  s_lshl_b32 s63, s63, 1
  s_and_b32 s74, s40, 1
  s_add_u32 s63, s63, s74
  s_lshl_b32 s75, s41, 2
  s_add_u32 s75, s75, s61
  s_mul_i32 s75, s75, 33280
  s_lshl_b32 s76, s63, 11
  s_add_u32 s75, s75, s76
  s_add_u32 s75, s75, 4194304
  buffer_load_dwordx4 v[200:203], v255, s[36:39], s75 offen sc1
  buffer_load_dwordx4 v[204:207], v255, s[36:39], s75 offen offset:1024 sc1
  v_and_b32 v226, 3, v244
  v_bfe_u32 v227, v244, 3, 1
  v_lshl_add_u32 v226, v227, 2, v226
  v_bfe_u32 v227, v244, 2, 1
  v_lshrrev_b32 v228, 5, v244
  v_xor_b32 v227, v227, v228
  v_lshl_add_u32 v226, v227, 3, v226
  v_bfe_u32 v227, v244, 4, 1
  v_lshl_add_u32 v228, v227, 3, v226
  v_and_b32 v229, 1, v228
  v_lshlrev_b32 v229, 4, v229
  s_movk_i32 s74, 0x3f80
  v_lshlrev_b32 v229, v229, s74
  v_lshrrev_b32 v230, 1, v228
  v_cmp_eq_u32 vcc, 0, v230
  s_nop 1
  v_cndmask_b32 v192, 0, v229, vcc
  v_cmp_eq_u32 vcc, 1, v230
  s_nop 1
  v_cndmask_b32 v193, 0, v229, vcc
  v_cmp_eq_u32 vcc, 2, v230
  s_nop 1
  v_cndmask_b32 v194, 0, v229, vcc
  v_cmp_eq_u32 vcc, 3, v230
  s_nop 1
  v_cndmask_b32 v195, 0, v229, vcc
  v_xor_b32 v227, 1, v227
  v_lshl_add_u32 v228, v227, 3, v226
  v_and_b32 v229, 1, v228
  v_lshlrev_b32 v229, 4, v229
  s_movk_i32 s74, 0x3f80
  v_lshlrev_b32 v229, v229, s74
  v_lshrrev_b32 v230, 1, v228
  v_cmp_eq_u32 vcc, 0, v230
  s_nop 1
  v_cndmask_b32 v196, 0, v229, vcc
  v_cmp_eq_u32 vcc, 1, v230
  s_nop 1
  v_cndmask_b32 v197, 0, v229, vcc
  v_cmp_eq_u32 vcc, 2, v230
  s_nop 1
  v_cndmask_b32 v198, 0, v229, vcc
  v_cmp_eq_u32 vcc, 3, v230
  s_nop 1
  v_cndmask_b32 v199, 0, v229, vcc
  s_lshl_b32 s52, s41, 2
  s_add_u32 s52, s52, s61
  s_mul_i32 s52, s52, 32768
  s_lshl_b32 s76, s63, 6
  s_add_u32 s52, s52, s76
  v_and_b32 v240, 31, v244
  v_lshlrev_b32 v240, 10, v240
  v_lshl_add_u32 v240, v243, 1, v240
  s_lshl_b32 s54, s42, 2
  s_add_u32 s54, s54, s40
  s_lshl_b32 s54, s54, 3
  s_lshl_b32 s74, s41, 9
  s_add_u32 s54, s54, s74
  s_add_u32 s54, s54, 0
  s_lshl_b32 s55, s41, 2
  s_add_u32 s55, s55, s62
  s_mul_i32 s55, s55, 115200
  s_mul_i32 s76, s40, 28672
  s_add_u32 s55, s55, s76
  s_add_u32 s55, s55, 6815744
  s_lshl_b32 s59, s41, 2
  s_add_u32 s59, s59, s61
  s_mul_i32 s59, s59, 115200
  s_mul_i32 s76, s40, 28672
  s_add_u32 s59, s59, s76
  s_add_u32 s59, s59, 6815744
  s_xor_b32 s74, s40, 1
  s_lshl_b32 s75, s74, 14
  s_lshl_b32 s76, s40, 12
  s_add_u32 s75, s75, s76
  s_add_u32 s75, s75, 98304
  v_add_u32 v208, s75, v255
  s_lshl_b32 s75, s74, 12
  s_lshl_b32 s76, s40, 14
  s_add_u32 s75, s75, s76
  s_add_u32 s75, s75, 98304
  v_add_u32 v212, s75, v255
  s_xor_b32 s74, s40, 2
  s_lshl_b32 s75, s74, 14
  s_lshl_b32 s76, s40, 12
  s_add_u32 s75, s75, s76
  s_add_u32 s75, s75, 98304
  v_add_u32 v209, s75, v255
  s_lshl_b32 s75, s74, 12
  s_lshl_b32 s76, s40, 14
  s_add_u32 s75, s75, s76
  s_add_u32 s75, s75, 98304
  v_add_u32 v213, s75, v255
  s_xor_b32 s74, s40, 3
  s_lshl_b32 s75, s74, 14
  s_lshl_b32 s76, s40, 12
  s_add_u32 s75, s75, s76
  s_add_u32 s75, s75, 98304
  v_add_u32 v210, s75, v255
  s_lshl_b32 s75, s74, 12
  s_lshl_b32 s76, s40, 14
  s_add_u32 s75, s75, s76
  s_add_u32 s75, s75, 98304
  v_add_u32 v214, s75, v255
  s_mul_i32 s74, s40, 7
  s_lshr_b32 s74, s74, 1
  s_lshl_b32 s74, s74, 2
  s_add_u32 s74, s74, s60
  s_mov_b64 s[64:65], 0x3333
  s_lshl_b64 s[64:65], s[64:65], s74
  s_lshl_b32 s71, s41, 9
  s_add_u32 s71, s71, 0
  s_or_b32 s70, s44, 7
  s_mov_b32 s68, s64
  s_mov_b32 s69, s65
  s_mov_b32 s80, 0
L_poll_47:
  buffer_load_dwordx2 v[236:237], v248, s[36:39], s71 offen sc1
  s_add_u32 s80, s80, 1
  s_cmp_gt_u32 s80, 0x40000
  s_cbranch_scc1 L_poll_47_x
  s_waitcnt vmcnt(0)
  v_subrev_u32 v236, s70, v236
  v_cmp_ge_u32 vcc, 8, v236
  v_cmp_eq_u32 s[66:67], s45, v237
  s_and_b64 vcc, vcc, s[66:67]
  s_andn2_b64 s[66:67], s[68:69], vcc
  s_cbranch_scc1 L_poll_47
L_poll_47_x:
  s_waitcnt vmcnt(0)
  buffer_load_dwordx4 v[0:3], v255, s[36:39], s55 offen offset:0 sc1
  buffer_load_dwordx4 v[4:7], v255, s[36:39], s55 offen offset:1024 sc1
  buffer_load_dwordx4 v[8:11], v255, s[36:39], s55 offen offset:2048 sc1
  buffer_load_dwordx4 v[12:15], v255, s[36:39], s55 offen offset:3072 sc1
  s_add_u32 s55, s55, 4096
  buffer_load_dwordx4 v[16:19], v255, s[36:39], s55 offen offset:0 sc1
  buffer_load_dwordx4 v[20:23], v255, s[36:39], s55 offen offset:1024 sc1
  buffer_load_dwordx4 v[24:27], v255, s[36:39], s55 offen offset:2048 sc1
  buffer_load_dwordx4 v[28:31], v255, s[36:39], s55 offen offset:3072 sc1
  s_add_u32 s55, s55, 4096
  buffer_load_dwordx4 v[32:35], v255, s[36:39], s55 offen offset:0 sc1
  buffer_load_dwordx4 v[36:39], v255, s[36:39], s55 offen offset:1024 sc1
  v_mfma_f32_32x32x16_bf16 v[160:175], v[192:195], v[200:203], 0
  v_mfma_f32_32x32x16_bf16 v[160:175], v[196:199], v[204:207], v[160:175]
  s_waitcnt vmcnt(9)
  v_mfma_f32_32x32x16_bf16 v[144:159], a[4:7], v[0:3], 0
  buffer_load_dwordx4 v[40:43], v255, s[36:39], s55 offen offset:2048 sc1
  v_mfma_f32_32x32x16_bf16 v[128:143], a[0:3], v[0:3], 0
  s_waitcnt vmcnt(9)
  v_mfma_f32_32x32x16_bf16 v[144:159], a[12:15], v[4:7], v[144:159]
  buffer_load_dwordx4 v[44:47], v255, s[36:39], s55 offen offset:3072 sc1
  v_mfma_f32_32x32x16_bf16 v[128:143], a[8:11], v[4:7], v[128:143]
  s_waitcnt vmcnt(9)
  v_mfma_f32_32x32x16_bf16 v[144:159], a[20:23], v[8:11], v[144:159]
  s_add_u32 s55, s55, 4096
  buffer_load_dwordx4 v[48:51], v255, s[36:39], s55 offen offset:0 sc1
  v_mfma_f32_32x32x16_bf16 v[128:143], a[16:19], v[8:11], v[128:143]
  s_waitcnt vmcnt(9)
  v_mfma_f32_32x32x16_bf16 v[144:159], a[28:31], v[12:15], v[144:159]
  buffer_load_dwordx4 v[52:55], v255, s[36:39], s55 offen offset:1024 sc1
  v_mfma_f32_32x32x16_bf16 v[128:143], a[24:27], v[12:15], v[128:143]
  s_waitcnt vmcnt(9)
  v_mfma_f32_32x32x16_bf16 v[144:159], a[36:39], v[16:19], v[144:159]
  buffer_load_dwordx4 v[56:59], v255, s[36:39], s55 offen offset:2048 sc1
  v_mfma_f32_32x32x16_bf16 v[128:143], a[32:35], v[16:19], v[128:143]
  s_waitcnt vmcnt(9)
  v_mfma_f32_32x32x16_bf16 v[144:159], a[44:47], v[20:23], v[144:159]
  buffer_load_dwordx4 v[60:63], v255, s[36:39], s55 offen offset:3072 sc1
  v_mfma_f32_32x32x16_bf16 v[128:143], a[40:43], v[20:23], v[128:143]
  s_waitcnt vmcnt(9)
  v_mfma_f32_32x32x16_bf16 v[144:159], a[52:55], v[24:27], v[144:159]
  s_add_u32 s55, s55, 4096
  buffer_load_dwordx4 v[64:67], v255, s[36:39], s55 offen offset:0 sc1
  v_mfma_f32_32x32x16_bf16 v[128:143], a[48:51], v[24:27], v[128:143]
  s_waitcnt vmcnt(9)
  v_mfma_f32_32x32x16_bf16 v[144:159], a[60:63], v[28:31], v[144:159]
  buffer_load_dwordx4 v[68:71], v255, s[36:39], s55 offen offset:1024 sc1
  v_mfma_f32_32x32x16_bf16 v[128:143], a[56:59], v[28:31], v[128:143]
  s_waitcnt vmcnt(9)
  v_mfma_f32_32x32x16_bf16 v[144:159], a[68:71], v[32:35], v[144:159]
  buffer_load_dwordx4 v[72:75], v255, s[36:39], s55 offen offset:2048 sc1
  v_mfma_f32_32x32x16_bf16 v[128:143], a[64:67], v[32:35], v[128:143]
  s_waitcnt vmcnt(9)
  v_mfma_f32_32x32x16_bf16 v[144:159], a[76:79], v[36:39], v[144:159]
  buffer_load_dwordx4 v[76:79], v255, s[36:39], s55 offen offset:3072 sc1
  v_mfma_f32_32x32x16_bf16 v[128:143], a[72:75], v[36:39], v[128:143]
  s_waitcnt vmcnt(9)
  v_mfma_f32_32x32x16_bf16 v[144:159], a[84:87], v[40:43], v[144:159]
  s_add_u32 s55, s55, 4096
  buffer_load_dwordx4 v[80:83], v255, s[36:39], s55 offen offset:0 sc1
  v_mfma_f32_32x32x16_bf16 v[128:143], a[80:83], v[40:43], v[128:143]
  s_waitcnt vmcnt(9)
  v_mfma_f32_32x32x16_bf16 v[144:159], a[92:95], v[44:47], v[144:159]
  buffer_load_dwordx4 v[84:87], v255, s[36:39], s55 offen offset:1024 sc1
  v_mfma_f32_32x32x16_bf16 v[128:143], a[88:91], v[44:47], v[128:143]
  s_waitcnt vmcnt(9)
  v_mfma_f32_32x32x16_bf16 v[144:159], a[100:103], v[48:51], v[144:159]
  buffer_load_dwordx4 v[88:91], v255, s[36:39], s55 offen offset:2048 sc1
  v_mfma_f32_32x32x16_bf16 v[128:143], a[96:99], v[48:51], v[128:143]
  s_waitcnt vmcnt(9)
  v_mfma_f32_32x32x16_bf16 v[144:159], a[108:111], v[52:55], v[144:159]
  buffer_load_dwordx4 v[92:95], v255, s[36:39], s55 offen offset:3072 sc1
  v_mfma_f32_32x32x16_bf16 v[128:143], a[104:107], v[52:55], v[128:143]
  s_waitcnt vmcnt(9)
  v_mfma_f32_32x32x16_bf16 v[144:159], a[116:119], v[56:59], v[144:159]
  s_add_u32 s55, s55, 4096
  buffer_load_dwordx4 v[96:99], v255, s[36:39], s55 offen offset:0 sc1
  v_mfma_f32_32x32x16_bf16 v[128:143], a[112:115], v[56:59], v[128:143]
  s_waitcnt vmcnt(9)
  v_mfma_f32_32x32x16_bf16 v[144:159], a[124:127], v[60:63], v[144:159]
  buffer_load_dwordx4 v[100:103], v255, s[36:39], s55 offen offset:1024 sc1
  v_mfma_f32_32x32x16_bf16 v[128:143], a[120:123], v[60:63], v[128:143]
  s_waitcnt vmcnt(9)
  v_mfma_f32_32x32x16_bf16 v[144:159], a[132:135], v[64:67], v[144:159]
  buffer_load_dwordx4 v[104:107], v255, s[36:39], s55 offen offset:2048 sc1
  v_mfma_f32_32x32x16_bf16 v[128:143], a[128:131], v[64:67], v[128:143]
  s_waitcnt vmcnt(9)
  v_mfma_f32_32x32x16_bf16 v[144:159], a[140:143], v[68:71], v[144:159]
  buffer_load_dwordx4 v[108:111], v255, s[36:39], s55 offen offset:3072 sc1
  v_mfma_f32_32x32x16_bf16 v[128:143], a[136:139], v[68:71], v[128:143]
  s_waitcnt vmcnt(9)
  v_mfma_f32_32x32x16_bf16 v[144:159], a[148:151], v[72:75], v[144:159]
  buffer_load_dwordx4 v[112:115], v255, s[36:39], s59 offen offset:0 sc1
  v_mfma_f32_32x32x16_bf16 v[128:143], a[144:147], v[72:75], v[128:143]
  s_waitcnt vmcnt(9)
  v_mfma_f32_32x32x16_bf16 v[144:159], a[156:159], v[76:79], v[144:159]
  buffer_load_dwordx4 v[116:119], v255, s[36:39], s59 offen offset:1024 sc1
  v_mfma_f32_32x32x16_bf16 v[128:143], a[152:155], v[76:79], v[128:143]
  s_waitcnt vmcnt(9)
  v_mfma_f32_32x32x16_bf16 v[144:159], a[164:167], v[80:83], v[144:159]
  buffer_load_dwordx4 v[120:123], v255, s[36:39], s59 offen offset:2048 sc1
  v_mfma_f32_32x32x16_bf16 v[128:143], a[160:163], v[80:83], v[128:143]
  s_waitcnt vmcnt(9)
  v_mfma_f32_32x32x16_bf16 v[144:159], a[172:175], v[84:87], v[144:159]
  buffer_load_dwordx4 v[124:127], v255, s[36:39], s59 offen offset:3072 sc1
  v_mfma_f32_32x32x16_bf16 v[128:143], a[168:171], v[84:87], v[128:143]
  s_waitcnt vmcnt(9)
  v_mfma_f32_32x32x16_bf16 v[144:159], a[180:183], v[88:91], v[144:159]
  s_add_u32 s59, s59, 4096
  buffer_load_dwordx4 v[0:3], v255, s[36:39], s59 offen offset:0 sc1
  v_mfma_f32_32x32x16_bf16 v[128:143], a[176:179], v[88:91], v[128:143]
  s_waitcnt vmcnt(9)
  v_mfma_f32_32x32x16_bf16 v[144:159], a[188:191], v[92:95], v[144:159]
  buffer_load_dwordx4 v[4:7], v255, s[36:39], s59 offen offset:1024 sc1
  v_mfma_f32_32x32x16_bf16 v[128:143], a[184:187], v[92:95], v[128:143]
  s_waitcnt vmcnt(9)
  v_mfma_f32_32x32x16_bf16 v[144:159], a[196:199], v[96:99], v[144:159]
  buffer_load_dwordx4 v[8:11], v255, s[36:39], s59 offen offset:2048 sc1
  v_mfma_f32_32x32x16_bf16 v[128:143], a[192:195], v[96:99], v[128:143]
  s_waitcnt vmcnt(9)
  v_mfma_f32_32x32x16_bf16 v[144:159], a[204:207], v[100:103], v[144:159]
  buffer_load_dwordx4 v[12:15], v255, s[36:39], s59 offen offset:3072 sc1
  v_mfma_f32_32x32x16_bf16 v[128:143], a[200:203], v[100:103], v[128:143]
  s_waitcnt vmcnt(9)
  v_mfma_f32_32x32x16_bf16 v[144:159], a[212:215], v[104:107], v[144:159]
  s_add_u32 s59, s59, 4096
  buffer_load_dwordx4 v[16:19], v255, s[36:39], s59 offen offset:0 sc1
  v_mfma_f32_32x32x16_bf16 v[128:143], a[208:211], v[104:107], v[128:143]
  s_waitcnt vmcnt(9)
  v_mfma_f32_32x32x16_bf16 v[144:159], a[220:223], v[108:111], v[144:159]
  buffer_load_dwordx4 v[20:23], v255, s[36:39], s59 offen offset:1024 sc1
  v_mfma_f32_32x32x16_bf16 v[128:143], a[216:219], v[108:111], v[128:143]
  s_waitcnt vmcnt(9)
  v_mfma_f32_32x32x16_bf16 v[176:191], a[4:7], v[112:115], 0
  buffer_load_dwordx4 v[24:27], v255, s[36:39], s59 offen offset:2048 sc1
  v_mfma_f32_32x32x16_bf16 v[160:175], a[0:3], v[112:115], v[160:175]
  s_waitcnt vmcnt(9)
  v_mfma_f32_32x32x16_bf16 v[176:191], a[12:15], v[116:119], v[176:191]
  buffer_load_dwordx4 v[28:31], v255, s[36:39], s59 offen offset:3072 sc1
  v_mfma_f32_32x32x16_bf16 v[160:175], a[8:11], v[116:119], v[160:175]
  s_waitcnt vmcnt(9)
  v_mfma_f32_32x32x16_bf16 v[176:191], a[20:23], v[120:123], v[176:191]
  s_add_u32 s59, s59, 4096
  buffer_load_dwordx4 v[32:35], v255, s[36:39], s59 offen offset:0 sc1
  v_mfma_f32_32x32x16_bf16 v[160:175], a[16:19], v[120:123], v[160:175]
  ds_write_b128 v209, v[128:131] offset:0
  ds_write_b128 v209, v[132:135] offset:1024
  ds_write_b128 v209, v[136:139] offset:2048
  ds_write_b128 v209, v[140:143] offset:3072
  s_waitcnt vmcnt(9)
  v_mfma_f32_32x32x16_bf16 v[176:191], a[28:31], v[124:127], v[176:191]
  buffer_load_dwordx4 v[36:39], v255, s[36:39], s59 offen offset:1024 sc1
  v_mfma_f32_32x32x16_bf16 v[160:175], a[24:27], v[124:127], v[160:175]
  s_waitcnt vmcnt(9)
  v_mfma_f32_32x32x16_bf16 v[176:191], a[36:39], v[0:3], v[176:191]
  buffer_load_dwordx4 v[40:43], v255, s[36:39], s59 offen offset:2048 sc1
  v_mfma_f32_32x32x16_bf16 v[160:175], a[32:35], v[0:3], v[160:175]
  ds_write_b128 v210, v[144:147] offset:0
  ds_write_b128 v210, v[148:151] offset:1024
  ds_write_b128 v210, v[152:155] offset:2048
  ds_write_b128 v210, v[156:159] offset:3072
  s_waitcnt vmcnt(9)
  v_mfma_f32_32x32x16_bf16 v[176:191], a[44:47], v[4:7], v[176:191]
  buffer_load_dwordx4 v[44:47], v255, s[36:39], s59 offen offset:3072 sc1
  v_mfma_f32_32x32x16_bf16 v[160:175], a[40:43], v[4:7], v[160:175]
  s_waitcnt vmcnt(9)
  v_mfma_f32_32x32x16_bf16 v[176:191], a[52:55], v[8:11], v[176:191]
  s_add_u32 s59, s59, 4096
  buffer_load_dwordx4 v[48:51], v255, s[36:39], s59 offen offset:0 sc1
  v_mfma_f32_32x32x16_bf16 v[160:175], a[48:51], v[8:11], v[160:175]
  s_waitcnt vmcnt(9)
  v_mfma_f32_32x32x16_bf16 v[176:191], a[60:63], v[12:15], v[176:191]
  buffer_load_dwordx4 v[52:55], v255, s[36:39], s59 offen offset:1024 sc1
  v_mfma_f32_32x32x16_bf16 v[160:175], a[56:59], v[12:15], v[160:175]
  s_waitcnt vmcnt(9)
  v_mfma_f32_32x32x16_bf16 v[176:191], a[68:71], v[16:19], v[176:191]
  buffer_load_dwordx4 v[56:59], v255, s[36:39], s59 offen offset:2048 sc1
  v_mfma_f32_32x32x16_bf16 v[160:175], a[64:67], v[16:19], v[160:175]
  s_waitcnt vmcnt(9)
  v_mfma_f32_32x32x16_bf16 v[176:191], a[76:79], v[20:23], v[176:191]
  buffer_load_dwordx4 v[60:63], v255, s[36:39], s59 offen offset:3072 sc1
  v_mfma_f32_32x32x16_bf16 v[160:175], a[72:75], v[20:23], v[160:175]
  s_waitcnt vmcnt(9)
  v_mfma_f32_32x32x16_bf16 v[176:191], a[84:87], v[24:27], v[176:191]
  s_add_u32 s59, s59, 4096
  buffer_load_dwordx4 v[64:67], v255, s[36:39], s59 offen offset:0 sc1
  v_mfma_f32_32x32x16_bf16 v[160:175], a[80:83], v[24:27], v[160:175]
  s_waitcnt vmcnt(9)
  v_mfma_f32_32x32x16_bf16 v[176:191], a[92:95], v[28:31], v[176:191]
  buffer_load_dwordx4 v[68:71], v255, s[36:39], s59 offen offset:1024 sc1
  v_mfma_f32_32x32x16_bf16 v[160:175], a[88:91], v[28:31], v[160:175]
  s_waitcnt vmcnt(9)
  v_mfma_f32_32x32x16_bf16 v[176:191], a[100:103], v[32:35], v[176:191]
  buffer_load_dwordx4 v[72:75], v255, s[36:39], s59 offen offset:2048 sc1
  v_mfma_f32_32x32x16_bf16 v[160:175], a[96:99], v[32:35], v[160:175]
  s_waitcnt vmcnt(9)
  v_mfma_f32_32x32x16_bf16 v[176:191], a[108:111], v[36:39], v[176:191]
  buffer_load_dwordx4 v[76:79], v255, s[36:39], s59 offen offset:3072 sc1
  v_mfma_f32_32x32x16_bf16 v[160:175], a[104:107], v[36:39], v[160:175]
  s_waitcnt vmcnt(9)
  v_mfma_f32_32x32x16_bf16 v[176:191], a[116:119], v[40:43], v[176:191]
  s_add_u32 s59, s59, 4096
  buffer_load_dwordx4 v[80:83], v255, s[36:39], s59 offen offset:0 sc1
  v_mfma_f32_32x32x16_bf16 v[160:175], a[112:115], v[40:43], v[160:175]
  s_waitcnt vmcnt(9)
  v_mfma_f32_32x32x16_bf16 v[176:191], a[124:127], v[44:47], v[176:191]
  buffer_load_dwordx4 v[84:87], v255, s[36:39], s59 offen offset:1024 sc1
  v_mfma_f32_32x32x16_bf16 v[160:175], a[120:123], v[44:47], v[160:175]
  s_waitcnt vmcnt(9)
  v_mfma_f32_32x32x16_bf16 v[176:191], a[132:135], v[48:51], v[176:191]
  buffer_load_dwordx4 v[88:91], v255, s[36:39], s59 offen offset:2048 sc1
  v_mfma_f32_32x32x16_bf16 v[160:175], a[128:131], v[48:51], v[160:175]
  s_waitcnt vmcnt(9)
  v_mfma_f32_32x32x16_bf16 v[176:191], a[140:143], v[52:55], v[176:191]
  buffer_load_dwordx4 v[92:95], v255, s[36:39], s59 offen offset:3072 sc1
  v_mfma_f32_32x32x16_bf16 v[160:175], a[136:139], v[52:55], v[160:175]
  s_waitcnt vmcnt(9)
  v_mfma_f32_32x32x16_bf16 v[176:191], a[148:151], v[56:59], v[176:191]
  v_mfma_f32_32x32x16_bf16 v[160:175], a[144:147], v[56:59], v[160:175]
  s_waitcnt vmcnt(8)
  v_mfma_f32_32x32x16_bf16 v[176:191], a[156:159], v[60:63], v[176:191]
  v_mfma_f32_32x32x16_bf16 v[160:175], a[152:155], v[60:63], v[160:175]
  s_waitcnt vmcnt(7)
  v_mfma_f32_32x32x16_bf16 v[176:191], a[164:167], v[64:67], v[176:191]
  v_mfma_f32_32x32x16_bf16 v[160:175], a[160:163], v[64:67], v[160:175]
  s_waitcnt vmcnt(6)
  v_mfma_f32_32x32x16_bf16 v[176:191], a[172:175], v[68:71], v[176:191]
  v_mfma_f32_32x32x16_bf16 v[160:175], a[168:171], v[68:71], v[160:175]
  s_waitcnt vmcnt(5)
  v_mfma_f32_32x32x16_bf16 v[176:191], a[180:183], v[72:75], v[176:191]
  v_mfma_f32_32x32x16_bf16 v[160:175], a[176:179], v[72:75], v[160:175]
  s_waitcnt vmcnt(4)
  v_mfma_f32_32x32x16_bf16 v[176:191], a[188:191], v[76:79], v[176:191]
  v_mfma_f32_32x32x16_bf16 v[160:175], a[184:187], v[76:79], v[160:175]
  s_waitcnt vmcnt(3)
  v_mfma_f32_32x32x16_bf16 v[176:191], a[196:199], v[80:83], v[176:191]
  v_mfma_f32_32x32x16_bf16 v[160:175], a[192:195], v[80:83], v[160:175]
  s_waitcnt vmcnt(2)
  v_mfma_f32_32x32x16_bf16 v[176:191], a[204:207], v[84:87], v[176:191]
  v_mfma_f32_32x32x16_bf16 v[160:175], a[200:203], v[84:87], v[160:175]
  s_waitcnt vmcnt(1)
  v_mfma_f32_32x32x16_bf16 v[176:191], a[212:215], v[88:91], v[176:191]
  v_mfma_f32_32x32x16_bf16 v[160:175], a[208:211], v[88:91], v[160:175]
  s_waitcnt vmcnt(0)
  v_mfma_f32_32x32x16_bf16 v[176:191], a[220:223], v[92:95], v[176:191]
  v_mfma_f32_32x32x16_bf16 v[160:175], a[216:219], v[92:95], v[160:175]
  s_nop 10
  ds_write_b128 v208, v[176:179] offset:0
  ds_write_b128 v208, v[180:183] offset:1024
  ds_write_b128 v208, v[184:187] offset:2048
  ds_write_b128 v208, v[188:191] offset:3072
  s_waitcnt lgkmcnt(0)
  s_barrier
  ds_read_b128 v[0:3], v212 offset:0
  ds_read_b128 v[4:7], v212 offset:1024
  ds_read_b128 v[8:11], v212 offset:2048
  ds_read_b128 v[12:15], v212 offset:3072
  ds_read_b128 v[16:19], v213 offset:0
  ds_read_b128 v[20:23], v213 offset:1024
  ds_read_b128 v[24:27], v213 offset:2048
  ds_read_b128 v[28:31], v213 offset:3072
  ds_read_b128 v[32:35], v214 offset:0
  ds_read_b128 v[36:39], v214 offset:1024
  ds_read_b128 v[40:43], v214 offset:2048
  ds_read_b128 v[44:47], v214 offset:3072
  s_waitcnt lgkmcnt(8)
  v_pk_add_f32 v[160:161], v[160:161], v[0:1]
  v_pk_add_f32 v[162:163], v[162:163], v[2:3]
  v_pk_add_f32 v[164:165], v[164:165], v[4:5]
  v_pk_add_f32 v[166:167], v[166:167], v[6:7]
  v_pk_add_f32 v[168:169], v[168:169], v[8:9]
  v_pk_add_f32 v[170:171], v[170:171], v[10:11]
  v_pk_add_f32 v[172:173], v[172:173], v[12:13]
  v_pk_add_f32 v[174:175], v[174:175], v[14:15]
  s_waitcnt lgkmcnt(4)
  v_pk_add_f32 v[160:161], v[160:161], v[16:17]
  v_pk_add_f32 v[162:163], v[162:163], v[18:19]
  v_pk_add_f32 v[164:165], v[164:165], v[20:21]
  v_pk_add_f32 v[166:167], v[166:167], v[22:23]
  v_pk_add_f32 v[168:169], v[168:169], v[24:25]
  v_pk_add_f32 v[170:171], v[170:171], v[26:27]
  v_pk_add_f32 v[172:173], v[172:173], v[28:29]
  v_pk_add_f32 v[174:175], v[174:175], v[30:31]
  s_waitcnt lgkmcnt(0)
  v_pk_add_f32 v[160:161], v[160:161], v[32:33]
  v_pk_add_f32 v[162:163], v[162:163], v[34:35]
  v_pk_add_f32 v[164:165], v[164:165], v[36:37]
  v_pk_add_f32 v[166:167], v[166:167], v[38:39]
  v_pk_add_f32 v[168:169], v[168:169], v[40:41]
  v_pk_add_f32 v[170:171], v[170:171], v[42:43]
  v_pk_add_f32 v[172:173], v[172:173], v[44:45]
  v_pk_add_f32 v[174:175], v[174:175], v[46:47]
  s_barrier
  v_cvt_pk_bf16_f32 v216, v160, v161
  v_cvt_pk_bf16_f32 v217, v162, v163
  v_cvt_pk_bf16_f32 v218, v164, v165
  v_cvt_pk_bf16_f32 v219, v166, v167
  v_cvt_pk_bf16_f32 v220, v168, v169
  v_cvt_pk_bf16_f32 v221, v170, v171
  v_cvt_pk_bf16_f32 v222, v172, v173
  v_cvt_pk_bf16_f32 v223, v174, v175
  buffer_store_dwordx4 v[216:219], v240, s[28:31], s52 offen sc0 sc1
  buffer_store_dwordx4 v[220:223], v240, s[28:31], s52 offen offset:16 sc0 sc1
L_end:
  s_endpgm

.section .rodata,"a"
.p2align 6
.amdhsa_kernel interleave_layers__linear_kernel_hedgehog__dense_activation_silu__prompt_kernel
  .amdhsa_next_free_vgpr 512
  .amdhsa_next_free_sgpr 100
  .amdhsa_accum_offset 256
  .amdhsa_group_segment_fixed_size 0
  .amdhsa_kernarg_size 80
  .amdhsa_user_sgpr_count 2
  .amdhsa_user_sgpr_kernarg_segment_ptr 1
  .amdhsa_system_sgpr_workgroup_id_x 1
.end_amdhsa_kernel
```
